```python
import torch

def _softmax(x, axis=-1):
    return torch.softmax(x, dim=axis)

def _gelu(x):
    return torch.nn.functional.gelu(x, approximate='tanh')

def _silu(x):
    return torch.nn.functional.silu(x)

def _sigmoid(x):
    return torch.sigmoid(x)

def _layernorm(x, axis=-1, eps=1e-05):
    m = x.mean(dim=axis, keepdim=True)
    v = x.var(dim=axis, keepdim=True, unbiased=False)
    return (x - m) / torch.sqrt(v + eps)

def _scatter_add(tgt, idx, src, axis=0):
    return tgt.clone().index_add_(axis, idx, src)

def _segment_sum(src, seg, n):
    out = torch.zeros((n,) + src.shape[1:], dtype=src.dtype)
    return out.index_add_(0, seg, src)

def _pad(x, pw):
    flat = tuple((v for pair in reversed(pw) for v in pair))
    return torch.nn.functional.pad(x, flat)
kernel_name = 'gated_mix__memory_aug_recurrent_mem_tr__dense_activation_silu__prompt'

def setup_inputs():

    _w = lambda a: (lambda t: t.to(torch.bfloat16) if t.is_floating_point() else t)(torch.as_tensor(a))

    def _A_setup():
        B, S, Dm = (1, 2048, 448)
        H, Dh = (16, 256)
        M, seg = (8, 32)
        seg = min(seg, S)
        S = S // seg * seg
        return {'x': _w((lambda *s: torch.randn(*s, dtype=torch.bfloat16) * 0.05)(B, S, Dm)), 'mem0': _w((lambda *s: torch.randn(*s, dtype=torch.bfloat16) * 0.4)(B, M, Dm)), 'Wq': _w((lambda *s: torch.randn(*s, dtype=torch.bfloat16) * 6.4)(Dm, H, Dh) * Dm ** (-0.5)), 'Wk': _w((lambda *s: torch.randn(*s, dtype=torch.bfloat16) * 6.4)(Dm, H, Dh) * Dm ** (-0.5)), 'Wv': _w((lambda *s: torch.randn(*s, dtype=torch.bfloat16) * 0.4)(Dm, H, Dh) * Dm ** (-0.5)), 'Wo': _w((lambda *s: torch.randn(*s, dtype=torch.bfloat16) * 0.4)(H, Dh, Dm) * (H * Dh) ** (-0.5)), 'seg_len': seg}
    _A_in = _A_setup()

    def _B_setup():
        B, S, D, F = (1, 2048, 448, 1792)
        return {'x': _w((lambda *s: torch.randn(*s, dtype=torch.bfloat16) * 0.05)(B, S, D)), 'w1': _w((lambda *s: torch.randn(*s, dtype=torch.bfloat16) * 3.2)(D, F) * D ** (-0.5)), 'w2': _w((lambda *s: torch.randn(*s, dtype=torch.bfloat16) * 0.2)(F, D) * F ** (-0.5))}
    _B_in = _B_setup()
    return {'A_x': _A_in['x'], 'A_mem0': _A_in['mem0'], 'A_Wq': _A_in['Wq'], 'A_Wk': _A_in['Wk'], 'A_Wv': _A_in['Wv'], 'A_Wo': _A_in['Wo'], 'A_seg_len': _A_in['seg_len'], 'B_x': _B_in['x'], 'B_w1': _B_in['w1'], 'B_w2': _B_in['w2'], 'gate_w': _w((lambda *s: torch.randn(*s, dtype=torch.bfloat16) * 0.05)(448) * 16.0)}

def reference(A_x, A_mem0, A_Wq, A_Wk, A_Wv, A_Wo, A_seg_len, B_x, B_w1, B_w2, gate_w):

    def _A_ref(x, mem0, Wq, Wk, Wv, Wo, seg_len):
        B, S, Dm = x.shape
        H, Dh = (Wq.shape[1], Wq.shape[2])
        M = mem0.shape[1]
        scale = Dh ** (-0.5)
        n_seg = S // seg_len
        L = M + seg_len
        idx = torch.arange(L)
        mask = (idx[:, None] < M) | (idx[:, None] >= idx[None, :])
        mem = mem0
        outs = []
        for s in range(n_seg):
            xs = x[:, s * seg_len:(s + 1) * seg_len, :].clone()
            h = torch.concatenate([mem, xs], axis=1)
            q = torch.einsum('btd,dhe->bhte', h, Wq)
            k = torch.einsum('btd,dhe->bhte', h, Wk)
            v = torch.einsum('btd,dhe->bhte', h, Wv)
            scores = torch.einsum('bhqe,bhke->bhqk', q, k) * scale
            scores = torch.where(mask[None, None], scores, -1000000000.0)
            p = _softmax(scores, axis=-1)
            o = torch.einsum('bhqk,bhke->bhqe', p, v)
            o = torch.einsum('bhte,hed->btd', o, Wo)
            mem = o[:, :M, :].clone()
            outs.append(o[:, M:, :])
        return torch.concatenate(outs, axis=1)

    def _B_ref(x, w1, w2):
        h = torch.einsum('bsd,df->bsf', x, w1)
        h = _silu(h)
        out = torch.einsum('bsf,fd->bsd', h, w2)
        return out
    x = A_x
    g = _sigmoid((x * gate_w).sum(-1, keepdims=True))
    a = _A_ref(x, A_mem0, A_Wq, A_Wk, A_Wv, A_Wo, A_seg_len)
    b = _B_ref(x, B_w1, B_w2)
    return g * a + (1 - g) * b
```

```asm
; @launch grid=(256,1,1) block=(256,1,1) lds=135168
.amdgcn_target "amdgcn-amd-amdhsa--gfx950"
.text
.globl gated_mix__memory_aug_recurrent_mem_tr__dense_activation_silu__prompt_kernel
.p2align 8
.type gated_mix__memory_aug_recurrent_mem_tr__dense_activation_silu__prompt_kernel,@function
gated_mix__memory_aug_recurrent_mem_tr__dense_activation_silu__prompt_kernel:
    s_cmp_ge_u32 s2, 256
    s_cbranch_scc1 L_exit
    s_load_dwordx4 s[76:79], s[0:1], 0
    s_load_dwordx8 s[80:87], s[0:1], 16
    s_load_dwordx8 s[64:71], s[0:1], 56
    s_load_dwordx2 s[88:89], s[0:1], 88
    s_load_dwordx4 s[72:75], s[0:1], 96
    s_getreg_b32 s18, hwreg(HW_REG_XCC_ID)
    v_lshrrev_b32 v1, 6, v0
    s_and_b32 s18, s18, 15
    v_readfirstlane_b32 s17, v1
    s_mov_b32 s35, 2000000
    s_waitcnt lgkmcnt(0)
    s_mov_b32 s4, s74
    s_mov_b32 s5, s75
    s_mov_b32 s6, 268435456
    s_mov_b32 s7, 0x00020000
    s_mov_b32 s12, s72
    s_mov_b32 s13, s73
    s_mov_b32 s14, 256
    s_mov_b32 s15, 0x00020000
    s_mov_b32 s60, s78
    s_mov_b32 s61, s79
    s_mov_b32 s62, 7168
    s_mov_b32 s63, 0x00020000
    s_lshl_b32 s36, s2, 2
    s_add_u32 s36, s36, s17
    s_cmp_lg_u32 s36, 1
    s_cbranch_scc1 L_p1
    v_mov_b32 v199, 1
    v_and_b32 v200, 31, v0
    v_lshlrev_b32 v200, 7, v200
    v_mov_b32 v201, 0
    s_mov_b32 s36, 15237120
    buffer_store_dword v201, v200, s[4:7], s36 offen sc1
    v_mov_b32 v200, 128
    s_waitcnt vmcnt(0)
    s_mov_b64 exec, 1
    buffer_atomic_add v199, v200, s[12:15], 0 offen
    s_mov_b64 exec, -1
L_p1:
    s_and_b32 s19, s2, 4
    s_cbranch_scc1 L_doB
    s_and_b32 s44, s2, 3
    s_lshl_b32 s44, s44, 2
    s_bfe_u32 s41, s2, 0x20003
    s_or_b32 s44, s44, s41
    s_bfe_u32 s42, s2, 0x10005
    s_lshr_b32 s43, s2, 6
    s_lshl_b32 s34, s42, 1
    s_add_u32 s34, s34, s43
    s_mov_b32 s8, s80
    s_mov_b32 s9, s81
    s_mov_b32 s10, 3670016
    s_mov_b32 s11, 0x00020000
    s_mov_b32 s24, s82
    s_mov_b32 s25, s83
    s_mov_b32 s26, 3670016
    s_mov_b32 s27, 0x00020000
    s_lshl_b32 s46, s43, 2
    s_add_u32 s46, s46, s17
    v_mbcnt_lo_u32_b32 v207, -1, 0
    v_mbcnt_hi_u32_b32 v207, -1, v207
    v_lshrrev_b32 v205, 5, v207
    v_and_b32 v206, 31, v207
    v_lshrrev_b32 v208, 3, v207
    v_lshrrev_b32 v209, 4, v207
    v_xor_b32 v209, v209, v207
    v_and_b32 v209, 7, v209
    v_lshlrev_b32 v209, 4, v209
    v_lshl_add_u32 v216, v208, 13, v209
    v_and_b32 v214, 3, v208
    v_lshrrev_b32 v208, 2, v208
    v_lshl_add_u32 v214, v208, 3, v214
    v_lshl_add_u32 v214, v214, 13, v209
    v_xor_b32 v215, 64, v214
    s_lshl_b32 s33, s46, 18
    s_lshl_b32 s48, s44, 9
    s_add_u32 s33, s33, s48
    s_lshl_b32 s49, s17, 10
    s_lshl_b32 s20, s17, 12
    s_add_u32 s20, s20, 28672
    s_and_b32 s47, s17, 1
    s_lshl_b32 s47, s47, 6
    v_xor_b32 v216, s47, v216
    s_mul_i32 s45, s42, 7
    s_lshl_b32 s47, s45, 18
    s_add_u32 s47, s47, s48
    s_lshl_b32 s48, s17, 16
    s_add_u32 s47, s47, s48
    v_add_u32 v217, 262144, v216
    v_add_u32 v218, 524288, v216
    v_add_u32 v219, 786432, v216
    v_add_u32 v220, 1048576, v216
    v_add_u32 v221, 1310720, v216
    v_add_u32 v222, 1572864, v216
    s_cmp_ge_u32 s46, 14
    s_cbranch_scc1 KA_side
    s_mov_b32 s32, 0
KA_first:
    s_and_b32 s34, s34, 3
    s_lshl_b32 s48, s34, 7
    s_add_u32 s51, s48, s33
    s_add_u32 m0, s20, 0
    s_add_u32 s48, s51, 0
    buffer_load_dwordx4 v214, s[8:11], s48 offen lds
    s_add_u32 m0, s20, 1024
    s_add_u32 s48, s51, 32768
    buffer_load_dwordx4 v215, s[8:11], s48 offen lds
    s_add_u32 m0, s20, 2048
    s_add_u32 s48, s51, 131072
    buffer_load_dwordx4 v214, s[8:11], s48 offen lds
    s_add_u32 m0, s20, 3072
    s_add_u32 s48, s51, 163840
    buffer_load_dwordx4 v215, s[8:11], s48 offen lds
    s_mul_i32 s48, s34, 128
    s_add_u32 s48, s48, s47
    s_add_u32 m0, s49, 0
    s_nop 0
    buffer_load_dwordx4 v216, s[24:27], s48 offen lds
    s_add_u32 m0, s49, 4096
    s_nop 0
    buffer_load_dwordx4 v217, s[24:27], s48 offen lds
    s_add_u32 m0, s49, 8192
    s_nop 0
    buffer_load_dwordx4 v218, s[24:27], s48 offen lds
    s_add_u32 m0, s49, 12288
    s_nop 0
    buffer_load_dwordx4 v219, s[24:27], s48 offen lds
    s_add_u32 m0, s49, 16384
    s_nop 0
    buffer_load_dwordx4 v220, s[24:27], s48 offen lds
    s_add_u32 m0, s49, 20480
    s_nop 0
    buffer_load_dwordx4 v221, s[24:27], s48 offen lds
    s_add_u32 m0, s49, 24576
    s_nop 0
    buffer_load_dwordx4 v222, s[24:27], s48 offen lds
    s_add_u32 s34, s34, 1
    s_add_u32 s49, s49, 45056
    s_add_u32 s20, s20, 45056
    s_add_u32 s32, s32, 1
    s_cmp_lt_u32 s32, 2
    s_cbranch_scc1 KA_first
    v_mov_b32 v4, 0
    v_mov_b32 v5, 0
    v_mov_b32 v6, 0
    v_mov_b32 v7, 0
    v_mov_b32 v8, 0
    v_mov_b32 v9, 0
    v_mov_b32 v10, 0
    v_mov_b32 v11, 0
    v_mov_b32 v12, 0
    v_mov_b32 v13, 0
    v_mov_b32 v14, 0
    v_mov_b32 v15, 0
    v_mov_b32 v16, 0
    v_mov_b32 v17, 0
    v_mov_b32 v18, 0
    v_mov_b32 v19, 0
    v_mov_b32 v20, 0
    v_mov_b32 v21, 0
    v_mov_b32 v22, 0
    v_mov_b32 v23, 0
    v_mov_b32 v24, 0
    v_mov_b32 v25, 0
    v_mov_b32 v26, 0
    v_mov_b32 v27, 0
    v_mov_b32 v28, 0
    v_mov_b32 v29, 0
    v_mov_b32 v30, 0
    v_mov_b32 v31, 0
    v_mov_b32 v32, 0
    v_mov_b32 v33, 0
    v_mov_b32 v34, 0
    v_mov_b32 v35, 0
    v_mov_b32 v36, 0
    v_mov_b32 v37, 0
    v_mov_b32 v38, 0
    v_mov_b32 v39, 0
    v_mov_b32 v40, 0
    v_mov_b32 v41, 0
    v_mov_b32 v42, 0
    v_mov_b32 v43, 0
    v_mov_b32 v44, 0
    v_mov_b32 v45, 0
    v_mov_b32 v46, 0
    v_mov_b32 v47, 0
    v_mov_b32 v48, 0
    v_mov_b32 v49, 0
    v_mov_b32 v50, 0
    v_mov_b32 v51, 0
    v_mov_b32 v52, 0
    v_mov_b32 v53, 0
    v_mov_b32 v54, 0
    v_mov_b32 v55, 0
    v_mov_b32 v56, 0
    v_mov_b32 v57, 0
    v_mov_b32 v58, 0
    v_mov_b32 v59, 0
    v_mov_b32 v60, 0
    v_mov_b32 v61, 0
    v_mov_b32 v62, 0
    v_mov_b32 v63, 0
    v_mov_b32 v64, 0
    v_mov_b32 v65, 0
    v_mov_b32 v66, 0
    v_mov_b32 v67, 0
    v_mov_b32 v68, 0
    v_mov_b32 v69, 0
    v_mov_b32 v70, 0
    v_mov_b32 v71, 0
    v_mov_b32 v72, 0
    v_mov_b32 v73, 0
    v_mov_b32 v74, 0
    v_mov_b32 v75, 0
    v_mov_b32 v76, 0
    v_mov_b32 v77, 0
    v_mov_b32 v78, 0
    v_mov_b32 v79, 0
    v_mov_b32 v80, 0
    v_mov_b32 v81, 0
    v_mov_b32 v82, 0
    v_mov_b32 v83, 0
    v_mov_b32 v84, 0
    v_mov_b32 v85, 0
    v_mov_b32 v86, 0
    v_mov_b32 v87, 0
    v_mov_b32 v88, 0
    v_mov_b32 v89, 0
    v_mov_b32 v90, 0
    v_mov_b32 v91, 0
    v_mov_b32 v92, 0
    v_mov_b32 v93, 0
    v_mov_b32 v94, 0
    v_mov_b32 v95, 0
    v_mov_b32 v96, 0
    v_mov_b32 v97, 0
    v_mov_b32 v98, 0
    v_mov_b32 v99, 0
    v_mov_b32 v100, 0
    v_mov_b32 v101, 0
    v_mov_b32 v102, 0
    v_mov_b32 v103, 0
    v_mov_b32 v104, 0
    v_mov_b32 v105, 0
    v_mov_b32 v106, 0
    v_mov_b32 v107, 0
    v_mov_b32 v108, 0
    v_mov_b32 v109, 0
    v_mov_b32 v110, 0
    v_mov_b32 v111, 0
    v_mov_b32 v112, 0
    v_mov_b32 v113, 0
    v_mov_b32 v114, 0
    v_mov_b32 v115, 0
    v_bfe_u32 v208, v206, 1, 3
    v_xor_b32 v208, v208, v205
    v_lshlrev_b32 v208, 4, v208
    v_lshl_add_u32 v208, v206, 7, v208
    s_lshl_b32 s48, s17, 12
    s_add_u32 s48, s48, 28672
    v_add_u32 v224, s48, v208
    v_lshrrev_b32 v208, 4, v206
    v_and_b32 v209, 15, v206
    v_lshlrev_b32 v212, 4, v209
    v_lshl_add_u32 v212, v205, 8, v212
    s_lshl_b32 s50, s46, 10
    s_mov_b32 s32, 0
    v_xor_b32 v225, 32, v224
    v_xor_b32 v226, 64, v224
    v_xor_b32 v227, 96, v224
    v_mul_u32_u24 v228, 14336, v208
    v_add_u32 v212, v212, v228
    v_lshl_add_u32 v208, v209, 1, v208
    v_bfe_u32 v209, v208, 1, 3
    v_xor_b32 v209, v209, v205
    v_lshlrev_b32 v209, 4, v209
    v_lshl_add_u32 v228, v208, 7, v209
    s_mul_i32 s48, s44, 14
    s_add_u32 s48, s48, s45
    s_mul_i32 s48, s48, 28672
    s_add_u32 s50, s50, s48
    v_xor_b32 v229, 32, v228
    v_xor_b32 v230, 64, v228
    v_xor_b32 v231, 96, v228
KA_loop:
    s_cmp_eq_u32 s32, 3
    s_cbranch_scc1 KA_w0
    s_waitcnt vmcnt(11)
    s_branch KA_w1
KA_w0:
    s_waitcnt vmcnt(13)
KA_w1:
    s_barrier
    ds_read_b128 v[116:119], v224
    ds_read_b128 v[120:123], v225
    ds_read_b128 v[124:127], v226
    ds_read_b128 v[128:131], v227
    ds_read_b128 v[132:135], v228 offset:0
    ds_read_b128 v[136:139], v228 offset:4096
    ds_read_b128 v[140:143], v228 offset:8192
    ds_read_b128 v[144:147], v228 offset:12288
    ds_read_b128 v[148:151], v228 offset:16384
    ds_read_b128 v[152:155], v228 offset:20480
    s_waitcnt lgkmcnt(5)
    v_mfma_f32_32x32x16_bf16 v[4:19], v[116:119], v[132:135], v[4:19]
    ds_read_b128 v[132:135], v228 offset:24576
    s_waitcnt lgkmcnt(5)
    v_mfma_f32_32x32x16_bf16 v[20:35], v[116:119], v[136:139], v[20:35]
    s_and_b32 s34, s34, 3
    s_lshl_b32 s48, s34, 7
    s_add_u32 s51, s48, s33
    s_add_u32 m0, s20, 0
    ds_read_b128 v[136:139], v229 offset:0
    s_waitcnt lgkmcnt(5)
    v_mfma_f32_32x32x16_bf16 v[36:51], v[116:119], v[140:143], v[36:51]
    s_add_u32 s48, s51, 0
    buffer_load_dwordx4 v214, s[8:11], s48 offen lds
    ds_read_b128 v[140:143], v229 offset:4096
    s_waitcnt lgkmcnt(5)
    v_mfma_f32_32x32x16_bf16 v[52:67], v[116:119], v[144:147], v[52:67]
    s_add_u32 m0, s20, 1024
    ds_read_b128 v[144:147], v229 offset:8192
    s_waitcnt lgkmcnt(5)
    v_mfma_f32_32x32x16_bf16 v[68:83], v[116:119], v[148:151], v[68:83]
    s_add_u32 s48, s51, 32768
    buffer_load_dwordx4 v215, s[8:11], s48 offen lds
    ds_read_b128 v[148:151], v229 offset:12288
    s_waitcnt lgkmcnt(5)
    v_mfma_f32_32x32x16_bf16 v[84:99], v[116:119], v[152:155], v[84:99]
    s_add_u32 m0, s20, 2048
    ds_read_b128 v[152:155], v229 offset:16384
    s_waitcnt lgkmcnt(5)
    v_mfma_f32_32x32x16_bf16 v[100:115], v[116:119], v[132:135], v[100:115]
    s_add_u32 s48, s51, 131072
    buffer_load_dwordx4 v214, s[8:11], s48 offen lds
    ds_read_b128 v[132:135], v229 offset:20480
    s_waitcnt lgkmcnt(5)
    v_mfma_f32_32x32x16_bf16 v[4:19], v[120:123], v[136:139], v[4:19]
    s_add_u32 m0, s20, 3072
    ds_read_b128 v[136:139], v229 offset:24576
    s_waitcnt lgkmcnt(5)
    v_mfma_f32_32x32x16_bf16 v[20:35], v[120:123], v[140:143], v[20:35]
    s_add_u32 s48, s51, 163840
    buffer_load_dwordx4 v215, s[8:11], s48 offen lds
    ds_read_b128 v[140:143], v230 offset:0
    s_waitcnt lgkmcnt(5)
    v_mfma_f32_32x32x16_bf16 v[36:51], v[120:123], v[144:147], v[36:51]
    s_mul_i32 s48, s34, 128
    s_add_u32 s48, s48, s47
    s_add_u32 m0, s49, 0
    ds_read_b128 v[144:147], v230 offset:4096
    s_waitcnt lgkmcnt(5)
    v_mfma_f32_32x32x16_bf16 v[52:67], v[120:123], v[148:151], v[52:67]
    buffer_load_dwordx4 v216, s[24:27], s48 offen lds
    ds_read_b128 v[148:151], v230 offset:8192
    s_waitcnt lgkmcnt(5)
    v_mfma_f32_32x32x16_bf16 v[68:83], v[120:123], v[152:155], v[68:83]
    s_add_u32 m0, s49, 4096
    ds_read_b128 v[152:155], v230 offset:12288
    s_waitcnt lgkmcnt(5)
    v_mfma_f32_32x32x16_bf16 v[84:99], v[120:123], v[132:135], v[84:99]
    buffer_load_dwordx4 v217, s[24:27], s48 offen lds
    ds_read_b128 v[132:135], v230 offset:16384
    s_waitcnt lgkmcnt(5)
    v_mfma_f32_32x32x16_bf16 v[100:115], v[120:123], v[136:139], v[100:115]
    s_add_u32 m0, s49, 8192
    ds_read_b128 v[136:139], v230 offset:20480
    s_waitcnt lgkmcnt(5)
    v_mfma_f32_32x32x16_bf16 v[4:19], v[124:127], v[140:143], v[4:19]
    buffer_load_dwordx4 v218, s[24:27], s48 offen lds
    ds_read_b128 v[140:143], v230 offset:24576
    s_waitcnt lgkmcnt(5)
    v_mfma_f32_32x32x16_bf16 v[20:35], v[124:127], v[144:147], v[20:35]
    s_add_u32 m0, s49, 12288
    ds_read_b128 v[144:147], v231 offset:0
    s_waitcnt lgkmcnt(5)
    v_mfma_f32_32x32x16_bf16 v[36:51], v[124:127], v[148:151], v[36:51]
    buffer_load_dwordx4 v219, s[24:27], s48 offen lds
    ds_read_b128 v[148:151], v231 offset:4096
    s_waitcnt lgkmcnt(5)
    v_mfma_f32_32x32x16_bf16 v[52:67], v[124:127], v[152:155], v[52:67]
    s_add_u32 m0, s49, 16384
    ds_read_b128 v[152:155], v231 offset:8192
    s_waitcnt lgkmcnt(5)
    v_mfma_f32_32x32x16_bf16 v[68:83], v[124:127], v[132:135], v[68:83]
    buffer_load_dwordx4 v220, s[24:27], s48 offen lds
    ds_read_b128 v[132:135], v231 offset:12288
    s_waitcnt lgkmcnt(5)
    v_mfma_f32_32x32x16_bf16 v[84:99], v[124:127], v[136:139], v[84:99]
    s_add_u32 m0, s49, 20480
    ds_read_b128 v[136:139], v231 offset:16384
    s_waitcnt lgkmcnt(5)
    v_mfma_f32_32x32x16_bf16 v[100:115], v[124:127], v[140:143], v[100:115]
    buffer_load_dwordx4 v221, s[24:27], s48 offen lds
    ds_read_b128 v[140:143], v231 offset:20480
    s_waitcnt lgkmcnt(5)
    v_mfma_f32_32x32x16_bf16 v[4:19], v[128:131], v[144:147], v[4:19]
    s_add_u32 m0, s49, 24576
    ds_read_b128 v[144:147], v231 offset:24576
    s_waitcnt lgkmcnt(5)
    v_mfma_f32_32x32x16_bf16 v[20:35], v[128:131], v[148:151], v[20:35]
    buffer_load_dwordx4 v222, s[24:27], s48 offen lds
    s_waitcnt lgkmcnt(4)
    v_mfma_f32_32x32x16_bf16 v[36:51], v[128:131], v[152:155], v[36:51]
    s_add_u32 s34, s34, 1
    s_waitcnt lgkmcnt(3)
    v_mfma_f32_32x32x16_bf16 v[52:67], v[128:131], v[132:135], v[52:67]
    s_waitcnt lgkmcnt(2)
    v_mfma_f32_32x32x16_bf16 v[68:83], v[128:131], v[136:139], v[68:83]
    s_waitcnt lgkmcnt(1)
    v_mfma_f32_32x32x16_bf16 v[84:99], v[128:131], v[140:143], v[84:99]
    s_waitcnt lgkmcnt(0)
    v_mfma_f32_32x32x16_bf16 v[100:115], v[128:131], v[144:147], v[100:115]
    s_cmp_lg_u32 s32, 1
    s_cbranch_scc1 KA_nq
    s_mov_b64 exec, 1
    v_mov_b32 v200, 128
    s_cmp_eq_u32 s43, 3
    s_cselect_b32 s36, 0, s17
    s_cmp_eq_u32 s36, 0
    s_cselect_b32 s36, 0, 2146435072
    buffer_load_dword v201, v200, s[12:15], s36 offen sc1
    s_cmp_eq_u32 s17, 1
    s_cbranch_scc1 LT_1
    s_mov_b32 s36, 2146435072
    buffer_load_dword v202, v200, s[12:15], s36 offen sc1
    s_branch LT_1_e
LT_1:
    s_movk_i32 s36, 96
    s_cmp_eq_u32 s18, 0
    s_cselect_b32 s36, 0, s36
    v_mov_b32 v203, s36
    v_mov_b32 v202, 1
    buffer_atomic_add v202, v203, s[12:15], 0 offen sc0
LT_1_e:
    s_mov_b64 exec, -1
    s_mov_b32 s33, 0x7ff00000
    s_mov_b32 s47, 0x7ff00000
KA_nq:
    s_mov_b32 s48, 45056
    s_cmp_eq_u32 s32, 0
    s_cselect_b32 s48, 4294877184, s48
    s_add_u32 s49, s49, s48
    s_add_u32 s20, s20, s48
    s_mov_b32 s48, 45056
    s_cmp_eq_u32 s32, 2
    s_cselect_b32 s48, 4294877184, s48
    v_add_u32 v224, s48, v224
    v_add_u32 v225, s48, v225
    v_add_u32 v226, s48, v226
    v_add_u32 v227, s48, v227
    v_add_u32 v228, s48, v228
    v_add_u32 v229, s48, v229
    v_add_u32 v230, s48, v230
    v_add_u32 v231, s48, v231
    s_add_u32 s32, s32, 1
    s_cmp_lt_u32 s32, 4
    s_cbranch_scc1 KA_loop
    v_cvt_pk_bf16_f32 v4, v4, v5
    v_cvt_pk_bf16_f32 v5, v6, v7
    v_cvt_pk_bf16_f32 v6, v8, v9
    v_cvt_pk_bf16_f32 v7, v10, v11
    buffer_store_dwordx4 v[4:7], v212, s[4:7], s50 offen offset:0 sc1
    v_cvt_pk_bf16_f32 v12, v12, v13
    v_cvt_pk_bf16_f32 v13, v14, v15
    v_cvt_pk_bf16_f32 v14, v16, v17
    v_cvt_pk_bf16_f32 v15, v18, v19
    buffer_store_dwordx4 v[12:15], v212, s[4:7], s50 offen offset:512 sc1
    s_add_u32 s50, s50, 28672
    v_cvt_pk_bf16_f32 v20, v20, v21
    v_cvt_pk_bf16_f32 v21, v22, v23
    v_cvt_pk_bf16_f32 v22, v24, v25
    v_cvt_pk_bf16_f32 v23, v26, v27
    buffer_store_dwordx4 v[20:23], v212, s[4:7], s50 offen offset:0 sc1
    v_cvt_pk_bf16_f32 v28, v28, v29
    v_cvt_pk_bf16_f32 v29, v30, v31
    v_cvt_pk_bf16_f32 v30, v32, v33
    v_cvt_pk_bf16_f32 v31, v34, v35
    buffer_store_dwordx4 v[28:31], v212, s[4:7], s50 offen offset:512 sc1
    s_add_u32 s50, s50, 28672
    v_cvt_pk_bf16_f32 v36, v36, v37
    v_cvt_pk_bf16_f32 v37, v38, v39
    v_cvt_pk_bf16_f32 v38, v40, v41
    v_cvt_pk_bf16_f32 v39, v42, v43
    buffer_store_dwordx4 v[36:39], v212, s[4:7], s50 offen offset:0 sc1
    v_cvt_pk_bf16_f32 v44, v44, v45
    v_cvt_pk_bf16_f32 v45, v46, v47
    v_cvt_pk_bf16_f32 v46, v48, v49
    v_cvt_pk_bf16_f32 v47, v50, v51
    buffer_store_dwordx4 v[44:47], v212, s[4:7], s50 offen offset:512 sc1
    s_add_u32 s50, s50, 28672
    v_cvt_pk_bf16_f32 v52, v52, v53
    v_cvt_pk_bf16_f32 v53, v54, v55
    v_cvt_pk_bf16_f32 v54, v56, v57
    v_cvt_pk_bf16_f32 v55, v58, v59
    buffer_store_dwordx4 v[52:55], v212, s[4:7], s50 offen offset:0 sc1
    v_cvt_pk_bf16_f32 v60, v60, v61
    v_cvt_pk_bf16_f32 v61, v62, v63
    v_cvt_pk_bf16_f32 v62, v64, v65
    v_cvt_pk_bf16_f32 v63, v66, v67
    buffer_store_dwordx4 v[60:63], v212, s[4:7], s50 offen offset:512 sc1
    s_add_u32 s50, s50, 28672
    v_cvt_pk_bf16_f32 v68, v68, v69
    v_cvt_pk_bf16_f32 v69, v70, v71
    v_cvt_pk_bf16_f32 v70, v72, v73
    v_cvt_pk_bf16_f32 v71, v74, v75
    buffer_store_dwordx4 v[68:71], v212, s[4:7], s50 offen offset:0 sc1
    v_cvt_pk_bf16_f32 v76, v76, v77
    v_cvt_pk_bf16_f32 v77, v78, v79
    v_cvt_pk_bf16_f32 v78, v80, v81
    v_cvt_pk_bf16_f32 v79, v82, v83
    buffer_store_dwordx4 v[76:79], v212, s[4:7], s50 offen offset:512 sc1
    s_add_u32 s50, s50, 28672
    v_cvt_pk_bf16_f32 v84, v84, v85
    v_cvt_pk_bf16_f32 v85, v86, v87
    v_cvt_pk_bf16_f32 v86, v88, v89
    v_cvt_pk_bf16_f32 v87, v90, v91
    buffer_store_dwordx4 v[84:87], v212, s[4:7], s50 offen offset:0 sc1
    v_cvt_pk_bf16_f32 v92, v92, v93
    v_cvt_pk_bf16_f32 v93, v94, v95
    v_cvt_pk_bf16_f32 v94, v96, v97
    v_cvt_pk_bf16_f32 v95, v98, v99
    buffer_store_dwordx4 v[92:95], v212, s[4:7], s50 offen offset:512 sc1
    s_add_u32 s50, s50, 28672
    v_cvt_pk_bf16_f32 v100, v100, v101
    v_cvt_pk_bf16_f32 v101, v102, v103
    v_cvt_pk_bf16_f32 v102, v104, v105
    v_cvt_pk_bf16_f32 v103, v106, v107
    buffer_store_dwordx4 v[100:103], v212, s[4:7], s50 offen offset:0 sc1
    v_cvt_pk_bf16_f32 v108, v108, v109
    v_cvt_pk_bf16_f32 v109, v110, v111
    v_cvt_pk_bf16_f32 v110, v112, v113
    v_cvt_pk_bf16_f32 v111, v114, v115
    buffer_store_dwordx4 v[108:111], v212, s[4:7], s50 offen offset:512 sc1
    s_branch KA_done
KA_side:
    s_and_b32 s34, s34, 3
    s_mul_i32 s48, s34, 128
    s_add_u32 s48, s48, s47
    s_add_u32 m0, s49, 0
    s_nop 0
    buffer_load_dwordx4 v216, s[24:27], s48 offen lds
    s_add_u32 m0, s49, 4096
    s_nop 0
    buffer_load_dwordx4 v217, s[24:27], s48 offen lds
    s_add_u32 m0, s49, 8192
    s_nop 0
    buffer_load_dwordx4 v218, s[24:27], s48 offen lds
    s_add_u32 m0, s49, 12288
    s_nop 0
    buffer_load_dwordx4 v219, s[24:27], s48 offen lds
    s_add_u32 m0, s49, 16384
    s_nop 0
    buffer_load_dwordx4 v220, s[24:27], s48 offen lds
    s_add_u32 m0, s49, 20480
    s_nop 0
    buffer_load_dwordx4 v221, s[24:27], s48 offen lds
    s_add_u32 m0, s49, 24576
    s_nop 0
    buffer_load_dwordx4 v222, s[24:27], s48 offen lds
    s_add_u32 s34, s34, 1
    s_add_u32 s49, s49, 45056
    s_and_b32 s34, s34, 3
    s_mul_i32 s48, s34, 128
    s_add_u32 s48, s48, s47
    s_add_u32 m0, s49, 0
    s_nop 0
    buffer_load_dwordx4 v216, s[24:27], s48 offen lds
    s_add_u32 m0, s49, 4096
    s_nop 0
    buffer_load_dwordx4 v217, s[24:27], s48 offen lds
    s_add_u32 m0, s49, 8192
    s_nop 0
    buffer_load_dwordx4 v218, s[24:27], s48 offen lds
    s_add_u32 m0, s49, 12288
    s_nop 0
    buffer_load_dwordx4 v219, s[24:27], s48 offen lds
    s_add_u32 m0, s49, 16384
    s_nop 0
    buffer_load_dwordx4 v220, s[24:27], s48 offen lds
    s_add_u32 m0, s49, 20480
    s_nop 0
    buffer_load_dwordx4 v221, s[24:27], s48 offen lds
    s_add_u32 m0, s49, 24576
    s_nop 0
    buffer_load_dwordx4 v222, s[24:27], s48 offen lds
    s_add_u32 s34, s34, 1
    s_add_u32 s49, s49, 45056
    s_waitcnt vmcnt(7)
    s_barrier
    s_and_b32 s34, s34, 3
    s_mul_i32 s48, s34, 128
    s_add_u32 s48, s48, s47
    s_add_u32 m0, s49, 0
    s_nop 0
    buffer_load_dwordx4 v216, s[24:27], s48 offen lds
    s_add_u32 m0, s49, 4096
    s_nop 0
    buffer_load_dwordx4 v217, s[24:27], s48 offen lds
    s_add_u32 m0, s49, 8192
    s_nop 0
    buffer_load_dwordx4 v218, s[24:27], s48 offen lds
    s_add_u32 m0, s49, 12288
    s_nop 0
    buffer_load_dwordx4 v219, s[24:27], s48 offen lds
    s_add_u32 m0, s49, 16384
    s_nop 0
    buffer_load_dwordx4 v220, s[24:27], s48 offen lds
    s_add_u32 m0, s49, 20480
    s_nop 0
    buffer_load_dwordx4 v221, s[24:27], s48 offen lds
    s_add_u32 m0, s49, 24576
    s_nop 0
    buffer_load_dwordx4 v222, s[24:27], s48 offen lds
    s_add_u32 s34, s34, 1
    s_sub_u32 s49, s49, 90112
    s_waitcnt vmcnt(7)
    s_barrier
    s_and_b32 s34, s34, 3
    s_mul_i32 s48, s34, 128
    s_add_u32 s48, s48, s47
    s_add_u32 m0, s49, 0
    s_nop 0
    buffer_load_dwordx4 v216, s[24:27], s48 offen lds
    s_add_u32 m0, s49, 4096
    s_nop 0
    buffer_load_dwordx4 v217, s[24:27], s48 offen lds
    s_add_u32 m0, s49, 8192
    s_nop 0
    buffer_load_dwordx4 v218, s[24:27], s48 offen lds
    s_add_u32 m0, s49, 12288
    s_nop 0
    buffer_load_dwordx4 v219, s[24:27], s48 offen lds
    s_add_u32 m0, s49, 16384
    s_nop 0
    buffer_load_dwordx4 v220, s[24:27], s48 offen lds
    s_add_u32 m0, s49, 20480
    s_nop 0
    buffer_load_dwordx4 v221, s[24:27], s48 offen lds
    s_add_u32 m0, s49, 24576
    s_nop 0
    buffer_load_dwordx4 v222, s[24:27], s48 offen lds
    s_add_u32 s34, s34, 1
    s_waitcnt vmcnt(7)
    s_barrier
    s_waitcnt vmcnt(0)
    s_barrier
KA_done:
    s_branch L_tile_done
L_doB:
    s_cmp_lg_u32 s17, 0
    s_cbranch_scc1 L_e1
    s_mov_b64 exec, 1
    v_mov_b32 v201, 128
L_e0:
    buffer_load_dword v200, v201, s[12:15], 0 offen sc1
    s_waitcnt vmcnt(0)
    v_readfirstlane_b32 s36, v200
    s_and_b32 s37, s36, 0xffff
    s_cmp_ge_u32 s37, 1
    s_cbranch_scc1 L_e0_ok
    s_sub_u32 s35, s35, 1
    s_cmp_lg_u32 s35, 0
    s_cbranch_scc1 L_e0
    s_branch L_team_done
L_e0_ok:
    s_mov_b64 exec, -1
L_e1:
    s_barrier
    s_and_b32 s44, s2, 3
    s_lshl_b32 s44, s44, 2
    s_bfe_u32 s41, s2, 0x20003
    s_or_b32 s44, s44, s41
    s_bfe_u32 s42, s2, 0x10005
    s_lshr_b32 s43, s2, 6
    s_lshl_b32 s34, s42, 1
    s_add_u32 s34, s34, s43
    s_mov_b32 s8, s84
    s_mov_b32 s9, s85
    s_mov_b32 s10, 3670016
    s_mov_b32 s11, 0x00020000
    s_mov_b32 s24, s86
    s_mov_b32 s25, s87
    s_mov_b32 s26, 3670016
    s_mov_b32 s27, 0x00020000
    s_lshl_b32 s46, s43, 2
    s_add_u32 s46, s46, s17
    v_mbcnt_lo_u32_b32 v207, -1, 0
    v_mbcnt_hi_u32_b32 v207, -1, v207
    v_lshrrev_b32 v205, 5, v207
    v_and_b32 v206, 31, v207
    v_lshrrev_b32 v208, 3, v207
    v_lshrrev_b32 v209, 4, v207
    v_xor_b32 v209, v209, v207
    v_and_b32 v209, 7, v209
    v_lshlrev_b32 v209, 4, v209
    v_lshl_add_u32 v216, v208, 13, v209
    v_and_b32 v214, 3, v208
    v_lshrrev_b32 v208, 2, v208
    v_lshl_add_u32 v214, v208, 3, v214
    v_lshl_add_u32 v214, v214, 13, v209
    v_xor_b32 v215, 64, v214
    s_lshl_b32 s33, s46, 18
    s_lshl_b32 s48, s44, 9
    s_add_u32 s33, s33, s48
    s_lshl_b32 s49, s17, 10
    s_lshl_b32 s20, s17, 12
    s_add_u32 s20, s20, 28672
    s_lshl_b32 s48, s17, 6
    v_add_u32 v212, s48, v207
    v_add_u32 v208, 0, v212
    v_mul_u32_u24 v209, 2341, v208
    v_lshrrev_b32 v209, 16, v209
    v_mul_u32_u24 v216, 448, v209
    v_lshl_add_u32 v216, v208, 4, v216
    v_add_u32 v208, 256, v212
    v_mul_u32_u24 v209, 2341, v208
    v_lshrrev_b32 v209, 16, v209
    v_mul_u32_u24 v217, 448, v209
    v_lshl_add_u32 v217, v208, 4, v217
    v_add_u32 v208, 512, v212
    v_mul_u32_u24 v209, 2341, v208
    v_lshrrev_b32 v209, 16, v209
    v_mul_u32_u24 v218, 448, v209
    v_lshl_add_u32 v218, v208, 4, v218
    v_add_u32 v208, 768, v212
    v_mul_u32_u24 v209, 2341, v208
    v_lshrrev_b32 v209, 16, v209
    v_mul_u32_u24 v219, 448, v209
    v_lshl_add_u32 v219, v208, 4, v219
    v_add_u32 v208, 1024, v212
    v_mul_u32_u24 v209, 2341, v208
    v_lshrrev_b32 v209, 16, v209
    v_mul_u32_u24 v220, 448, v209
    v_lshl_add_u32 v220, v208, 4, v220
    v_add_u32 v208, 1280, v212
    v_mul_u32_u24 v209, 2341, v208
    v_lshrrev_b32 v209, 16, v209
    v_mul_u32_u24 v221, 448, v209
    v_lshl_add_u32 v221, v208, 4, v221
    v_add_u32 v208, 1536, v212
    v_mul_u32_u24 v209, 2341, v208
    v_lshrrev_b32 v209, 16, v209
    v_mul_u32_u24 v222, 448, v209
    v_lshl_add_u32 v222, v208, 4, v222
    s_mul_i32 s47, s44, 229376
    s_mul_i32 s48, s42, 448
    s_add_u32 s47, s47, s48
    s_cmp_ge_u32 s46, 14
    s_cbranch_scc1 KB_side
    s_mov_b32 s32, 0
KB_first:
    s_and_b32 s34, s34, 3
    s_lshl_b32 s48, s34, 7
    s_add_u32 s51, s48, s33
    s_add_u32 m0, s20, 0
    s_add_u32 s48, s51, 0
    buffer_load_dwordx4 v214, s[8:11], s48 offen lds
    s_add_u32 m0, s20, 1024
    s_add_u32 s48, s51, 32768
    buffer_load_dwordx4 v215, s[8:11], s48 offen lds
    s_add_u32 m0, s20, 2048
    s_add_u32 s48, s51, 131072
    buffer_load_dwordx4 v214, s[8:11], s48 offen lds
    s_add_u32 m0, s20, 3072
    s_add_u32 s48, s51, 163840
    buffer_load_dwordx4 v215, s[8:11], s48 offen lds
    s_mul_i32 s48, s34, 57344
    s_add_u32 s48, s48, s47
    s_add_u32 m0, s49, 0
    s_nop 0
    buffer_load_dwordx4 v216, s[24:27], s48 offen lds
    s_add_u32 m0, s49, 4096
    s_nop 0
    buffer_load_dwordx4 v217, s[24:27], s48 offen lds
    s_add_u32 m0, s49, 8192
    s_nop 0
    buffer_load_dwordx4 v218, s[24:27], s48 offen lds
    s_add_u32 m0, s49, 12288
    s_nop 0
    buffer_load_dwordx4 v219, s[24:27], s48 offen lds
    s_add_u32 m0, s49, 16384
    s_nop 0
    buffer_load_dwordx4 v220, s[24:27], s48 offen lds
    s_add_u32 m0, s49, 20480
    s_nop 0
    buffer_load_dwordx4 v221, s[24:27], s48 offen lds
    s_add_u32 m0, s49, 24576
    s_nop 0
    buffer_load_dwordx4 v222, s[24:27], s48 offen lds
    s_add_u32 s34, s34, 1
    s_add_u32 s49, s49, 45056
    s_add_u32 s20, s20, 45056
    s_add_u32 s32, s32, 1
    s_cmp_lt_u32 s32, 2
    s_cbranch_scc1 KB_first
    v_mov_b32 v4, 0
    v_mov_b32 v5, 0
    v_mov_b32 v6, 0
    v_mov_b32 v7, 0
    v_mov_b32 v8, 0
    v_mov_b32 v9, 0
    v_mov_b32 v10, 0
    v_mov_b32 v11, 0
    v_mov_b32 v12, 0
    v_mov_b32 v13, 0
    v_mov_b32 v14, 0
    v_mov_b32 v15, 0
    v_mov_b32 v16, 0
    v_mov_b32 v17, 0
    v_mov_b32 v18, 0
    v_mov_b32 v19, 0
    v_mov_b32 v20, 0
    v_mov_b32 v21, 0
    v_mov_b32 v22, 0
    v_mov_b32 v23, 0
    v_mov_b32 v24, 0
    v_mov_b32 v25, 0
    v_mov_b32 v26, 0
    v_mov_b32 v27, 0
    v_mov_b32 v28, 0
    v_mov_b32 v29, 0
    v_mov_b32 v30, 0
    v_mov_b32 v31, 0
    v_mov_b32 v32, 0
    v_mov_b32 v33, 0
    v_mov_b32 v34, 0
    v_mov_b32 v35, 0
    v_mov_b32 v36, 0
    v_mov_b32 v37, 0
    v_mov_b32 v38, 0
    v_mov_b32 v39, 0
    v_mov_b32 v40, 0
    v_mov_b32 v41, 0
    v_mov_b32 v42, 0
    v_mov_b32 v43, 0
    v_mov_b32 v44, 0
    v_mov_b32 v45, 0
    v_mov_b32 v46, 0
    v_mov_b32 v47, 0
    v_mov_b32 v48, 0
    v_mov_b32 v49, 0
    v_mov_b32 v50, 0
    v_mov_b32 v51, 0
    v_mov_b32 v52, 0
    v_mov_b32 v53, 0
    v_mov_b32 v54, 0
    v_mov_b32 v55, 0
    v_mov_b32 v56, 0
    v_mov_b32 v57, 0
    v_mov_b32 v58, 0
    v_mov_b32 v59, 0
    v_mov_b32 v60, 0
    v_mov_b32 v61, 0
    v_mov_b32 v62, 0
    v_mov_b32 v63, 0
    v_mov_b32 v64, 0
    v_mov_b32 v65, 0
    v_mov_b32 v66, 0
    v_mov_b32 v67, 0
    v_mov_b32 v68, 0
    v_mov_b32 v69, 0
    v_mov_b32 v70, 0
    v_mov_b32 v71, 0
    v_mov_b32 v72, 0
    v_mov_b32 v73, 0
    v_mov_b32 v74, 0
    v_mov_b32 v75, 0
    v_mov_b32 v76, 0
    v_mov_b32 v77, 0
    v_mov_b32 v78, 0
    v_mov_b32 v79, 0
    v_mov_b32 v80, 0
    v_mov_b32 v81, 0
    v_mov_b32 v82, 0
    v_mov_b32 v83, 0
    v_mov_b32 v84, 0
    v_mov_b32 v85, 0
    v_mov_b32 v86, 0
    v_mov_b32 v87, 0
    v_mov_b32 v88, 0
    v_mov_b32 v89, 0
    v_mov_b32 v90, 0
    v_mov_b32 v91, 0
    v_mov_b32 v92, 0
    v_mov_b32 v93, 0
    v_mov_b32 v94, 0
    v_mov_b32 v95, 0
    v_mov_b32 v96, 0
    v_mov_b32 v97, 0
    v_mov_b32 v98, 0
    v_mov_b32 v99, 0
    v_mov_b32 v100, 0
    v_mov_b32 v101, 0
    v_mov_b32 v102, 0
    v_mov_b32 v103, 0
    v_mov_b32 v104, 0
    v_mov_b32 v105, 0
    v_mov_b32 v106, 0
    v_mov_b32 v107, 0
    v_mov_b32 v108, 0
    v_mov_b32 v109, 0
    v_mov_b32 v110, 0
    v_mov_b32 v111, 0
    v_mov_b32 v112, 0
    v_mov_b32 v113, 0
    v_mov_b32 v114, 0
    v_mov_b32 v115, 0
    v_bfe_u32 v208, v206, 1, 3
    v_xor_b32 v208, v208, v205
    v_lshlrev_b32 v208, 4, v208
    v_lshl_add_u32 v208, v206, 7, v208
    s_lshl_b32 s48, s17, 12
    s_add_u32 s48, s48, 28672
    v_add_u32 v224, s48, v208
    v_lshrrev_b32 v208, 4, v206
    v_and_b32 v209, 15, v206
    v_lshlrev_b32 v212, 4, v209
    v_lshl_add_u32 v212, v205, 8, v212
    s_lshl_b32 s50, s46, 10
    s_mov_b32 s32, 0
    v_xor_b32 v225, 32, v224
    v_xor_b32 v226, 64, v224
    v_xor_b32 v227, 96, v224
    v_mul_u32_u24 v228, 229376, v208
    v_add_u32 v212, v212, v228
    v_bfe_u32 v208, v207, 2, 2
    v_lshl_add_u32 v208, v205, 3, v208
    v_mul_u32_u24 v228, 448, v208
    v_bfe_u32 v208, v207, 4, 1
    v_lshl_add_u32 v228, v208, 5, v228
    v_and_b32 v208, 3, v207
    v_lshl_add_u32 v228, v208, 3, v228
    s_mul_i32 s48, s42, 3211264
    s_add_u32 s50, s50, s48
    s_mul_i32 s48, s44, 14336
    s_add_u32 s50, s50, s48
    s_add_u32 s50, s50, 7340032
KB_loop:
    s_cmp_eq_u32 s32, 3
    s_cbranch_scc1 KB_w0
    s_waitcnt vmcnt(11)
    s_branch KB_w1
KB_w0:
    s_waitcnt vmcnt(13)
KB_w1:
    s_barrier
    ds_read_b128 v[116:119], v224
    ds_read_b128 v[120:123], v225
    ds_read_b128 v[124:127], v226
    ds_read_b128 v[128:131], v227
    ds_read_b64_tr_b16 v[132:133], v228 offset:0
    ds_read_b64_tr_b16 v[134:135], v228 offset:1792
    ds_read_b64_tr_b16 v[136:137], v228 offset:64
    ds_read_b64_tr_b16 v[138:139], v228 offset:1856
    ds_read_b64_tr_b16 v[140:141], v228 offset:128
    ds_read_b64_tr_b16 v[142:143], v228 offset:1920
    ds_read_b64_tr_b16 v[144:145], v228 offset:192
    ds_read_b64_tr_b16 v[146:147], v228 offset:1984
    ds_read_b64_tr_b16 v[148:149], v228 offset:256
    ds_read_b64_tr_b16 v[150:151], v228 offset:2048
    s_waitcnt lgkmcnt(8)
    v_mfma_f32_32x32x16_bf16 v[4:19], v[116:119], v[132:135], v[4:19]
    ds_read_b64_tr_b16 v[132:133], v228 offset:320
    ds_read_b64_tr_b16 v[134:135], v228 offset:2112
    s_waitcnt lgkmcnt(8)
    v_mfma_f32_32x32x16_bf16 v[20:35], v[116:119], v[136:139], v[20:35]
    s_and_b32 s34, s34, 3
    s_lshl_b32 s48, s34, 7
    s_add_u32 s51, s48, s33
    s_add_u32 m0, s20, 0
    ds_read_b64_tr_b16 v[136:137], v228 offset:384
    ds_read_b64_tr_b16 v[138:139], v228 offset:2176
    s_waitcnt lgkmcnt(8)
    v_mfma_f32_32x32x16_bf16 v[36:51], v[116:119], v[140:143], v[36:51]
    s_add_u32 s48, s51, 0
    buffer_load_dwordx4 v214, s[8:11], s48 offen lds
    ds_read_b64_tr_b16 v[140:141], v228 offset:7168
    ds_read_b64_tr_b16 v[142:143], v228 offset:8960
    s_waitcnt lgkmcnt(8)
    v_mfma_f32_32x32x16_bf16 v[52:67], v[116:119], v[144:147], v[52:67]
    s_add_u32 m0, s20, 1024
    ds_read_b64_tr_b16 v[144:145], v228 offset:7232
    ds_read_b64_tr_b16 v[146:147], v228 offset:9024
    s_waitcnt lgkmcnt(8)
    v_mfma_f32_32x32x16_bf16 v[68:83], v[116:119], v[148:151], v[68:83]
    s_add_u32 s48, s51, 32768
    buffer_load_dwordx4 v215, s[8:11], s48 offen lds
    ds_read_b64_tr_b16 v[148:149], v228 offset:7296
    ds_read_b64_tr_b16 v[150:151], v228 offset:9088
    s_waitcnt lgkmcnt(8)
    v_mfma_f32_32x32x16_bf16 v[84:99], v[116:119], v[132:135], v[84:99]
    s_add_u32 m0, s20, 2048
    ds_read_b64_tr_b16 v[132:133], v228 offset:7360
    ds_read_b64_tr_b16 v[134:135], v228 offset:9152
    s_waitcnt lgkmcnt(8)
    v_mfma_f32_32x32x16_bf16 v[100:115], v[116:119], v[136:139], v[100:115]
    s_add_u32 s48, s51, 131072
    buffer_load_dwordx4 v214, s[8:11], s48 offen lds
    ds_read_b64_tr_b16 v[136:137], v228 offset:7424
    ds_read_b64_tr_b16 v[138:139], v228 offset:9216
    s_waitcnt lgkmcnt(8)
    v_mfma_f32_32x32x16_bf16 v[4:19], v[120:123], v[140:143], v[4:19]
    s_add_u32 m0, s20, 3072
    ds_read_b64_tr_b16 v[140:141], v228 offset:7488
    ds_read_b64_tr_b16 v[142:143], v228 offset:9280
    s_waitcnt lgkmcnt(8)
    v_mfma_f32_32x32x16_bf16 v[20:35], v[120:123], v[144:147], v[20:35]
    s_add_u32 s48, s51, 163840
    buffer_load_dwordx4 v215, s[8:11], s48 offen lds
    ds_read_b64_tr_b16 v[144:145], v228 offset:7552
    ds_read_b64_tr_b16 v[146:147], v228 offset:9344
    s_waitcnt lgkmcnt(8)
    v_mfma_f32_32x32x16_bf16 v[36:51], v[120:123], v[148:151], v[36:51]
    s_mul_i32 s48, s34, 57344
    s_add_u32 s48, s48, s47
    s_add_u32 m0, s49, 0
    ds_read_b64_tr_b16 v[148:149], v228 offset:14336
    ds_read_b64_tr_b16 v[150:151], v228 offset:16128
    s_waitcnt lgkmcnt(8)
    v_mfma_f32_32x32x16_bf16 v[52:67], v[120:123], v[132:135], v[52:67]
    buffer_load_dwordx4 v216, s[24:27], s48 offen lds
    ds_read_b64_tr_b16 v[132:133], v228 offset:14400
    ds_read_b64_tr_b16 v[134:135], v228 offset:16192
    s_waitcnt lgkmcnt(8)
    v_mfma_f32_32x32x16_bf16 v[68:83], v[120:123], v[136:139], v[68:83]
    s_add_u32 m0, s49, 4096
    ds_read_b64_tr_b16 v[136:137], v228 offset:14464
    ds_read_b64_tr_b16 v[138:139], v228 offset:16256
    s_waitcnt lgkmcnt(8)
    v_mfma_f32_32x32x16_bf16 v[84:99], v[120:123], v[140:143], v[84:99]
    buffer_load_dwordx4 v217, s[24:27], s48 offen lds
    ds_read_b64_tr_b16 v[140:141], v228 offset:14528
    ds_read_b64_tr_b16 v[142:143], v228 offset:16320
    s_waitcnt lgkmcnt(8)
    v_mfma_f32_32x32x16_bf16 v[100:115], v[120:123], v[144:147], v[100:115]
    s_add_u32 m0, s49, 8192
    ds_read_b64_tr_b16 v[144:145], v228 offset:14592
    ds_read_b64_tr_b16 v[146:147], v228 offset:16384
    s_waitcnt lgkmcnt(8)
    v_mfma_f32_32x32x16_bf16 v[4:19], v[124:127], v[148:151], v[4:19]
    buffer_load_dwordx4 v218, s[24:27], s48 offen lds
    ds_read_b64_tr_b16 v[148:149], v228 offset:14656
    ds_read_b64_tr_b16 v[150:151], v228 offset:16448
    s_waitcnt lgkmcnt(8)
    v_mfma_f32_32x32x16_bf16 v[20:35], v[124:127], v[132:135], v[20:35]
    s_add_u32 m0, s49, 12288
    ds_read_b64_tr_b16 v[132:133], v228 offset:14720
    ds_read_b64_tr_b16 v[134:135], v228 offset:16512
    s_waitcnt lgkmcnt(8)
    v_mfma_f32_32x32x16_bf16 v[36:51], v[124:127], v[136:139], v[36:51]
    buffer_load_dwordx4 v219, s[24:27], s48 offen lds
    ds_read_b64_tr_b16 v[136:137], v228 offset:21504
    ds_read_b64_tr_b16 v[138:139], v228 offset:23296
    s_waitcnt lgkmcnt(8)
    v_mfma_f32_32x32x16_bf16 v[52:67], v[124:127], v[140:143], v[52:67]
    s_add_u32 m0, s49, 16384
    ds_read_b64_tr_b16 v[140:141], v228 offset:21568
    ds_read_b64_tr_b16 v[142:143], v228 offset:23360
    s_waitcnt lgkmcnt(8)
    v_mfma_f32_32x32x16_bf16 v[68:83], v[124:127], v[144:147], v[68:83]
    buffer_load_dwordx4 v220, s[24:27], s48 offen lds
    ds_read_b64_tr_b16 v[144:145], v228 offset:21632
    ds_read_b64_tr_b16 v[146:147], v228 offset:23424
    s_waitcnt lgkmcnt(8)
    v_mfma_f32_32x32x16_bf16 v[84:99], v[124:127], v[148:151], v[84:99]
    s_add_u32 m0, s49, 20480
    ds_read_b64_tr_b16 v[148:149], v228 offset:21696
    ds_read_b64_tr_b16 v[150:151], v228 offset:23488
    s_waitcnt lgkmcnt(8)
    v_mfma_f32_32x32x16_bf16 v[100:115], v[124:127], v[132:135], v[100:115]
    buffer_load_dwordx4 v221, s[24:27], s48 offen lds
    ds_read_b64_tr_b16 v[132:133], v228 offset:21760
    ds_read_b64_tr_b16 v[134:135], v228 offset:23552
    s_waitcnt lgkmcnt(8)
    v_mfma_f32_32x32x16_bf16 v[4:19], v[128:131], v[136:139], v[4:19]
    s_add_u32 m0, s49, 24576
    ds_read_b64_tr_b16 v[136:137], v228 offset:21824
    ds_read_b64_tr_b16 v[138:139], v228 offset:23616
    s_waitcnt lgkmcnt(8)
    v_mfma_f32_32x32x16_bf16 v[20:35], v[128:131], v[140:143], v[20:35]
    buffer_load_dwordx4 v222, s[24:27], s48 offen lds
    ds_read_b64_tr_b16 v[140:141], v228 offset:21888
    ds_read_b64_tr_b16 v[142:143], v228 offset:23680
    s_waitcnt lgkmcnt(8)
    v_mfma_f32_32x32x16_bf16 v[36:51], v[128:131], v[144:147], v[36:51]
    s_add_u32 s34, s34, 1
    s_waitcnt lgkmcnt(6)
    v_mfma_f32_32x32x16_bf16 v[52:67], v[128:131], v[148:151], v[52:67]
    s_waitcnt lgkmcnt(4)
    v_mfma_f32_32x32x16_bf16 v[68:83], v[128:131], v[132:135], v[68:83]
    s_waitcnt lgkmcnt(2)
    v_mfma_f32_32x32x16_bf16 v[84:99], v[128:131], v[136:139], v[84:99]
    s_waitcnt lgkmcnt(0)
    v_mfma_f32_32x32x16_bf16 v[100:115], v[128:131], v[140:143], v[100:115]
    s_cmp_lg_u32 s32, 1
    s_cbranch_scc1 KB_nq
    s_mov_b64 exec, 1
    v_mov_b32 v200, 128
    s_cmp_eq_u32 s43, 3
    s_cselect_b32 s36, 0, s17
    s_cmp_eq_u32 s36, 0
    s_cselect_b32 s36, 0, 2146435072
    buffer_load_dword v201, v200, s[12:15], s36 offen sc1
    s_cmp_eq_u32 s17, 1
    s_cbranch_scc1 LT_2
    s_mov_b32 s36, 2146435072
    buffer_load_dword v202, v200, s[12:15], s36 offen sc1
    s_branch LT_2_e
LT_2:
    s_movk_i32 s36, 96
    s_cmp_eq_u32 s18, 0
    s_cselect_b32 s36, 0, s36
    v_mov_b32 v203, s36
    v_mov_b32 v202, 1
    buffer_atomic_add v202, v203, s[12:15], 0 offen sc0
LT_2_e:
    s_mov_b64 exec, -1
    s_mov_b32 s33, 0x7ff00000
    s_mov_b32 s47, 0x7ff00000
KB_nq:
    s_mov_b32 s48, 45056
    s_cmp_eq_u32 s32, 0
    s_cselect_b32 s48, 4294877184, s48
    s_add_u32 s49, s49, s48
    s_add_u32 s20, s20, s48
    s_mov_b32 s48, 45056
    s_cmp_eq_u32 s32, 2
    s_cselect_b32 s48, 4294877184, s48
    v_add_u32 v224, s48, v224
    v_add_u32 v225, s48, v225
    v_add_u32 v226, s48, v226
    v_add_u32 v227, s48, v227
    v_add_u32 v228, s48, v228
    s_add_u32 s32, s32, 1
    s_cmp_lt_u32 s32, 4
    s_cbranch_scc1 KB_loop
    v_cvt_pk_bf16_f32 v4, v4, v5
    v_cvt_pk_bf16_f32 v5, v6, v7
    v_cvt_pk_bf16_f32 v6, v8, v9
    v_cvt_pk_bf16_f32 v7, v10, v11
    buffer_store_dwordx4 v[4:7], v212, s[4:7], s50 offen offset:0 sc1
    v_cvt_pk_bf16_f32 v12, v12, v13
    v_cvt_pk_bf16_f32 v13, v14, v15
    v_cvt_pk_bf16_f32 v14, v16, v17
    v_cvt_pk_bf16_f32 v15, v18, v19
    buffer_store_dwordx4 v[12:15], v212, s[4:7], s50 offen offset:512 sc1
    s_add_u32 s50, s50, 458752
    v_cvt_pk_bf16_f32 v20, v20, v21
    v_cvt_pk_bf16_f32 v21, v22, v23
    v_cvt_pk_bf16_f32 v22, v24, v25
    v_cvt_pk_bf16_f32 v23, v26, v27
    buffer_store_dwordx4 v[20:23], v212, s[4:7], s50 offen offset:0 sc1
    v_cvt_pk_bf16_f32 v28, v28, v29
    v_cvt_pk_bf16_f32 v29, v30, v31
    v_cvt_pk_bf16_f32 v30, v32, v33
    v_cvt_pk_bf16_f32 v31, v34, v35
    buffer_store_dwordx4 v[28:31], v212, s[4:7], s50 offen offset:512 sc1
    s_add_u32 s50, s50, 458752
    v_cvt_pk_bf16_f32 v36, v36, v37
    v_cvt_pk_bf16_f32 v37, v38, v39
    v_cvt_pk_bf16_f32 v38, v40, v41
    v_cvt_pk_bf16_f32 v39, v42, v43
    buffer_store_dwordx4 v[36:39], v212, s[4:7], s50 offen offset:0 sc1
    v_cvt_pk_bf16_f32 v44, v44, v45
    v_cvt_pk_bf16_f32 v45, v46, v47
    v_cvt_pk_bf16_f32 v46, v48, v49
    v_cvt_pk_bf16_f32 v47, v50, v51
    buffer_store_dwordx4 v[44:47], v212, s[4:7], s50 offen offset:512 sc1
    s_add_u32 s50, s50, 458752
    v_cvt_pk_bf16_f32 v52, v52, v53
    v_cvt_pk_bf16_f32 v53, v54, v55
    v_cvt_pk_bf16_f32 v54, v56, v57
    v_cvt_pk_bf16_f32 v55, v58, v59
    buffer_store_dwordx4 v[52:55], v212, s[4:7], s50 offen offset:0 sc1
    v_cvt_pk_bf16_f32 v60, v60, v61
    v_cvt_pk_bf16_f32 v61, v62, v63
    v_cvt_pk_bf16_f32 v62, v64, v65
    v_cvt_pk_bf16_f32 v63, v66, v67
    buffer_store_dwordx4 v[60:63], v212, s[4:7], s50 offen offset:512 sc1
    s_add_u32 s50, s50, 458752
    v_cvt_pk_bf16_f32 v68, v68, v69
    v_cvt_pk_bf16_f32 v69, v70, v71
    v_cvt_pk_bf16_f32 v70, v72, v73
    v_cvt_pk_bf16_f32 v71, v74, v75
    buffer_store_dwordx4 v[68:71], v212, s[4:7], s50 offen offset:0 sc1
    v_cvt_pk_bf16_f32 v76, v76, v77
    v_cvt_pk_bf16_f32 v77, v78, v79
    v_cvt_pk_bf16_f32 v78, v80, v81
    v_cvt_pk_bf16_f32 v79, v82, v83
    buffer_store_dwordx4 v[76:79], v212, s[4:7], s50 offen offset:512 sc1
    s_add_u32 s50, s50, 458752
    v_cvt_pk_bf16_f32 v84, v84, v85
    v_cvt_pk_bf16_f32 v85, v86, v87
    v_cvt_pk_bf16_f32 v86, v88, v89
    v_cvt_pk_bf16_f32 v87, v90, v91
    buffer_store_dwordx4 v[84:87], v212, s[4:7], s50 offen offset:0 sc1
    v_cvt_pk_bf16_f32 v92, v92, v93
    v_cvt_pk_bf16_f32 v93, v94, v95
    v_cvt_pk_bf16_f32 v94, v96, v97
    v_cvt_pk_bf16_f32 v95, v98, v99
    buffer_store_dwordx4 v[92:95], v212, s[4:7], s50 offen offset:512 sc1
    s_add_u32 s50, s50, 458752
    v_cvt_pk_bf16_f32 v100, v100, v101
    v_cvt_pk_bf16_f32 v101, v102, v103
    v_cvt_pk_bf16_f32 v102, v104, v105
    v_cvt_pk_bf16_f32 v103, v106, v107
    buffer_store_dwordx4 v[100:103], v212, s[4:7], s50 offen offset:0 sc1
    v_cvt_pk_bf16_f32 v108, v108, v109
    v_cvt_pk_bf16_f32 v109, v110, v111
    v_cvt_pk_bf16_f32 v110, v112, v113
    v_cvt_pk_bf16_f32 v111, v114, v115
    buffer_store_dwordx4 v[108:111], v212, s[4:7], s50 offen offset:512 sc1
    s_branch KB_done
KB_side:
    s_and_b32 s34, s34, 3
    s_mul_i32 s48, s34, 57344
    s_add_u32 s48, s48, s47
    s_add_u32 m0, s49, 0
    s_nop 0
    buffer_load_dwordx4 v216, s[24:27], s48 offen lds
    s_add_u32 m0, s49, 4096
    s_nop 0
    buffer_load_dwordx4 v217, s[24:27], s48 offen lds
    s_add_u32 m0, s49, 8192
    s_nop 0
    buffer_load_dwordx4 v218, s[24:27], s48 offen lds
    s_add_u32 m0, s49, 12288
    s_nop 0
    buffer_load_dwordx4 v219, s[24:27], s48 offen lds
    s_add_u32 m0, s49, 16384
    s_nop 0
    buffer_load_dwordx4 v220, s[24:27], s48 offen lds
    s_add_u32 m0, s49, 20480
    s_nop 0
    buffer_load_dwordx4 v221, s[24:27], s48 offen lds
    s_add_u32 m0, s49, 24576
    s_nop 0
    buffer_load_dwordx4 v222, s[24:27], s48 offen lds
    s_add_u32 s34, s34, 1
    s_add_u32 s49, s49, 45056
    s_and_b32 s34, s34, 3
    s_mul_i32 s48, s34, 57344
    s_add_u32 s48, s48, s47
    s_add_u32 m0, s49, 0
    s_nop 0
    buffer_load_dwordx4 v216, s[24:27], s48 offen lds
    s_add_u32 m0, s49, 4096
    s_nop 0
    buffer_load_dwordx4 v217, s[24:27], s48 offen lds
    s_add_u32 m0, s49, 8192
    s_nop 0
    buffer_load_dwordx4 v218, s[24:27], s48 offen lds
    s_add_u32 m0, s49, 12288
    s_nop 0
    buffer_load_dwordx4 v219, s[24:27], s48 offen lds
    s_add_u32 m0, s49, 16384
    s_nop 0
    buffer_load_dwordx4 v220, s[24:27], s48 offen lds
    s_add_u32 m0, s49, 20480
    s_nop 0
    buffer_load_dwordx4 v221, s[24:27], s48 offen lds
    s_add_u32 m0, s49, 24576
    s_nop 0
    buffer_load_dwordx4 v222, s[24:27], s48 offen lds
    s_add_u32 s34, s34, 1
    s_add_u32 s49, s49, 45056
    s_waitcnt vmcnt(7)
    s_barrier
    s_and_b32 s34, s34, 3
    s_mul_i32 s48, s34, 57344
    s_add_u32 s48, s48, s47
    s_add_u32 m0, s49, 0
    s_nop 0
    buffer_load_dwordx4 v216, s[24:27], s48 offen lds
    s_add_u32 m0, s49, 4096
    s_nop 0
    buffer_load_dwordx4 v217, s[24:27], s48 offen lds
    s_add_u32 m0, s49, 8192
    s_nop 0
    buffer_load_dwordx4 v218, s[24:27], s48 offen lds
    s_add_u32 m0, s49, 12288
    s_nop 0
    buffer_load_dwordx4 v219, s[24:27], s48 offen lds
    s_add_u32 m0, s49, 16384
    s_nop 0
    buffer_load_dwordx4 v220, s[24:27], s48 offen lds
    s_add_u32 m0, s49, 20480
    s_nop 0
    buffer_load_dwordx4 v221, s[24:27], s48 offen lds
    s_add_u32 m0, s49, 24576
    s_nop 0
    buffer_load_dwordx4 v222, s[24:27], s48 offen lds
    s_add_u32 s34, s34, 1
    s_sub_u32 s49, s49, 90112
    s_waitcnt vmcnt(7)
    s_barrier
    s_and_b32 s34, s34, 3
    s_mul_i32 s48, s34, 57344
    s_add_u32 s48, s48, s47
    s_add_u32 m0, s49, 0
    s_nop 0
    buffer_load_dwordx4 v216, s[24:27], s48 offen lds
    s_add_u32 m0, s49, 4096
    s_nop 0
    buffer_load_dwordx4 v217, s[24:27], s48 offen lds
    s_add_u32 m0, s49, 8192
    s_nop 0
    buffer_load_dwordx4 v218, s[24:27], s48 offen lds
    s_add_u32 m0, s49, 12288
    s_nop 0
    buffer_load_dwordx4 v219, s[24:27], s48 offen lds
    s_add_u32 m0, s49, 16384
    s_nop 0
    buffer_load_dwordx4 v220, s[24:27], s48 offen lds
    s_add_u32 m0, s49, 20480
    s_nop 0
    buffer_load_dwordx4 v221, s[24:27], s48 offen lds
    s_add_u32 m0, s49, 24576
    s_nop 0
    buffer_load_dwordx4 v222, s[24:27], s48 offen lds
    s_add_u32 s34, s34, 1
    s_waitcnt vmcnt(7)
    s_barrier
    s_waitcnt vmcnt(0)
    s_barrier
KB_done:
L_tile_done:
    s_waitcnt vmcnt(0)
    s_mov_b64 exec, 1
    s_cmp_ge_u32 s46, 14
    s_cbranch_scc1 L_rst_ok
    v_cmp_eq_u32 vcc, 0, v201
    s_cbranch_vccz L_rst_ok
    s_cmp_eq_u32 s43, 3
    s_cselect_b32 s36, 0, s17
    s_cmp_lg_u32 s36, 0
    s_cbranch_scc1 L_rst_ok
    v_mov_b32 v3, 128
L_rst:
    buffer_load_dword v2, v3, s[12:15], 0 offen sc0 sc1
    s_waitcnt vmcnt(0)
    v_readfirstlane_b32 s36, v2
    s_and_b32 s37, s36, 0xffff
    s_cmp_ge_u32 s37, 1
    s_cbranch_scc1 L_rst_ok
    s_sub_u32 s35, s35, 1
    s_cmp_lg_u32 s35, 0
    s_cbranch_scc1 L_rst
    s_branch L_team_done
L_rst_ok:
    s_waitcnt vmcnt(0)
    s_lshr_b32 s38, s44, 2
    s_add_u32 s38, s38, s19
    s_lshl_b32 s38, s38, 7
    s_add_u32 s38, s38, 15237120
    s_mov_b64 exec, 1
    v_mov_b32 v1, 1
    v_mov_b32 v2, 0
    s_cmp_eq_u32 s43, 3
    s_cbranch_scc1 KS_s2
    s_barrier
    v_mov_b32 v1, 2
    s_cmp_lg_u32 s17, 0
    s_cbranch_scc1 KS_s3
KS_s2:
    s_cmp_ge_u32 s46, 14
    s_cbranch_scc1 KS_s3
    buffer_atomic_add v1, v2, s[4:7], s38 offen
KS_s3:
    s_mov_b64 exec, -1
    s_barrier
    v_mbcnt_lo_u32_b32 v0, -1, 0
    v_mbcnt_hi_u32_b32 v0, -1, v0
    v_mov_b32 v3, 65536
    s_cmp_lg_u32 s17, 1
    s_cbranch_scc1 L_p4
    s_mov_b64 exec, 1
    ds_write_b32 v3, v202
    s_waitcnt lgkmcnt(0)
    s_mov_b64 exec, -1
L_p4:
    s_barrier
    ds_read_b32 v1, v3
    s_waitcnt lgkmcnt(0)
    v_readfirstlane_b32 s16, v1
    s_barrier
    s_cmp_lg_u32 s18, 0
    s_cbranch_scc1 L_have
    s_and_b32 s16, s16, 0xffff
    s_cmp_lt_u32 s16, 32
    s_cbranch_scc1 L_team
    s_branch L_next
L_next_free:
    s_cmp_lg_u32 s17, 0
    s_cbranch_scc1 L_t1_w
    v_mov_b32 v1, 0
    v_mov_b32 v2, 0
    v_mov_b32 v3, 65536
    s_mov_b64 exec, 1
    buffer_atomic_add v1, v2, s[12:15], 0 offen sc0
    s_waitcnt vmcnt(0)
    ds_write_b32 v3, v1
    s_waitcnt lgkmcnt(0)
    s_mov_b64 exec, -1
L_t1_w:
    v_mov_b32 v3, 65536
    s_barrier
    ds_read_b32 v1, v3
    s_waitcnt lgkmcnt(0)
    v_readfirstlane_b32 s16, v1
    s_barrier
    s_and_b32 s16, s16, 0xffff
    s_cmp_ge_u32 s16, 32
    s_cbranch_scc1 L_next
    s_cmp_lg_u32 s17, 0
    s_cbranch_scc1 L_t2_w
    v_mov_b32 v1, 65537
    v_mov_b32 v2, 0
    v_mov_b32 v3, 65536
    s_mov_b64 exec, 1
    buffer_atomic_add v1, v2, s[12:15], 0 offen sc0
    s_waitcnt vmcnt(0)
    ds_write_b32 v3, v1
    s_waitcnt lgkmcnt(0)
    s_mov_b64 exec, -1
L_t2_w:
    v_mov_b32 v3, 65536
    s_barrier
    ds_read_b32 v1, v3
    s_waitcnt lgkmcnt(0)
    v_readfirstlane_b32 s16, v1
    s_barrier
    s_and_b32 s16, s16, 0xffff
    s_cmp_lt_u32 s16, 32
    s_cbranch_scc1 L_team
L_next:
    s_cmp_lg_u32 s17, 0
    s_cbranch_scc1 L_t3_w
    v_mov_b32 v1, 1
    v_mov_b32 v2, 96
    v_mov_b32 v3, 65536
    s_mov_b64 exec, 1
    buffer_atomic_add v1, v2, s[12:15], 0 offen sc0
    s_waitcnt vmcnt(0)
    ds_write_b32 v3, v1
    s_waitcnt lgkmcnt(0)
    s_mov_b64 exec, -1
L_t3_w:
    v_mov_b32 v3, 65536
    s_barrier
    ds_read_b32 v1, v3
    s_waitcnt lgkmcnt(0)
    v_readfirstlane_b32 s16, v1
    s_barrier
L_have:
    s_cmp_lt_u32 s16, 56
    s_cbranch_scc1 GB_entry
    s_sub_u32 s16, s16, 56
    s_cmp_lt_u32 s16, 56
    s_cbranch_scc1 GA_entry
    s_sub_u32 s16, s16, 56
    s_cmp_lt_u32 s16, 14
    s_cbranch_scc1 GH_entry
    s_sub_u32 s16, s16, 14
    s_cmp_lt_u32 s16, 28
    s_cbranch_scc1 TU_entry
    s_sub_u32 s16, s16, 28
    s_cmp_lt_u32 s16, 24
    s_cbranch_scc1 O1_entry
    s_sub_u32 s16, s16, 24
    s_cmp_lt_u32 s16, 42
    s_cbranch_scc1 O2_entry
    s_sub_u32 s16, s16, 42
L_exit:
    s_endpgm
L_team_done:
    s_endpgm
L_side:
    s_cmp_ge_u32 s17, 2
    s_cbranch_scc1 L_side_e
    s_mov_b32 s28, s76
    s_mov_b32 s29, s77
    s_mov_b32 s30, 1835008
    s_mov_b32 s31, 0x00020000
    s_mov_b32 s52, s70
    s_mov_b32 s53, s71
    s_mov_b32 s54, 896
    s_mov_b32 s55, 0x00020000
    v_mbcnt_lo_u32_b32 v207, -1, 0
    v_mbcnt_hi_u32_b32 v207, -1, v207
    v_lshrrev_b32 v205, 5, v207
    v_lshlrev_b32 v212, 4, v207
    s_mov_b32 s34, s17
    s_mul_i32 s50, s45, 28672
    s_mul_i32 s20, s17, 14336
    s_add_u32 s33, s50, s20
    s_add_u32 m0, s20, 0
    s_add_u32 s48, s33, 0
    buffer_load_dwordx4 v212, s[28:31], s48 offen offset:0 lds
    buffer_load_dwordx4 v212, s[28:31], s48 offen offset:1024 lds
    buffer_load_dwordx4 v212, s[28:31], s48 offen offset:2048 lds
    buffer_load_dwordx4 v212, s[28:31], s48 offen offset:3072 lds
    s_add_u32 m0, s20, 4096
    s_add_u32 s48, s33, 4096
    buffer_load_dwordx4 v212, s[28:31], s48 offen offset:0 lds
    buffer_load_dwordx4 v212, s[28:31], s48 offen offset:1024 lds
    buffer_load_dwordx4 v212, s[28:31], s48 offen offset:2048 lds
    buffer_load_dwordx4 v212, s[28:31], s48 offen offset:3072 lds
    s_add_u32 m0, s20, 8192
    s_add_u32 s48, s33, 8192
    buffer_load_dwordx4 v212, s[28:31], s48 offen offset:0 lds
    buffer_load_dwordx4 v212, s[28:31], s48 offen offset:1024 lds
    buffer_load_dwordx4 v212, s[28:31], s48 offen offset:2048 lds
    buffer_load_dwordx4 v212, s[28:31], s48 offen offset:3072 lds
    s_add_u32 m0, s20, 12288
    s_add_u32 s48, s33, 12288
    buffer_load_dwordx4 v212, s[28:31], s48 offen offset:0 lds
    buffer_load_dwordx4 v212, s[28:31], s48 offen offset:1024 lds
    v_bfe_u32 v208, v207, 4, 1
    v_lshlrev_b32 v209, 4, v205
    v_lshl_add_u32 v209, v208, 5, v209
    v_and_b32 v210, 15, v207
    v_mul_u32_u24 v211, 896, v210
    v_add_u32 v211, s20, v211
    v_add_u32 v224, v211, v209
    v_lshrrev_b32 v225, 4, v207
    v_lshl_add_u32 v225, v225, 4, v211
    v_lshlrev_b32 v226, 10, v208
    v_lshl_add_u32 v226, v205, 9, v226
    v_lshl_add_u32 v226, v210, 4, v226
    s_lshl_b32 s48, s34, 8
    v_add_u32 v226, s48, v226
    buffer_load_dwordx4 v[112:115], v209, s[52:55], 0 offen offset:0
    buffer_load_dwordx4 v[116:119], v209, s[52:55], 0 offen offset:64
    buffer_load_dwordx4 v[120:123], v209, s[52:55], 0 offen offset:128
    buffer_load_dwordx4 v[124:127], v209, s[52:55], 0 offen offset:192
    buffer_load_dwordx4 v[128:131], v209, s[52:55], 0 offen offset:256
    buffer_load_dwordx4 v[132:135], v209, s[52:55], 0 offen offset:320
    buffer_load_dwordx4 v[136:139], v209, s[52:55], 0 offen offset:384
    buffer_load_dwordx4 v[140:143], v209, s[52:55], 0 offen offset:448
    buffer_load_dwordx4 v[144:147], v209, s[52:55], 0 offen offset:512
    buffer_load_dwordx4 v[148:151], v209, s[52:55], 0 offen offset:576
    buffer_load_dwordx4 v[152:155], v209, s[52:55], 0 offen offset:640
    buffer_load_dwordx4 v[156:159], v209, s[52:55], 0 offen offset:704
    buffer_load_dwordx4 v[160:163], v209, s[52:55], 0 offen offset:768
    buffer_load_dwordx4 v[164:167], v209, s[52:55], 0 offen offset:832
    v_mov_b32 v168, -1
    v_mov_b32 v169, -1
    v_mov_b32 v170, -1
    v_mov_b32 v171, -1
    v_mov_b32 v172, 0
    v_lshlrev_b32 v173, 7, v207
    v_cmp_gt_u32 vcc, 8, v207
    v_mov_b32 v174, 0x7ff00000
    s_lshl_b32 s48, s45, 1
    s_add_u32 s48, s48, s34
    s_lshl_b32 s51, s48, 12
    v_cndmask_b32 v173, v174, v173, vcc
    s_lshl_b32 s48, s48, 10
    s_add_u32 s48, s48, 15269888
    buffer_store_dword v172, v173, s[4:7], s48 offen sc1
    s_add_u32 s51, s51, 15728640
    buffer_store_dwordx4 v[168:171], v212, s[4:7], s51 offen offset:0 sc1
    buffer_store_dwordx4 v[168:171], v212, s[4:7], s51 offen offset:1024 sc1
    buffer_store_dwordx4 v[168:171], v212, s[4:7], s51 offen offset:2048 sc1
    buffer_store_dwordx4 v[168:171], v212, s[4:7], s51 offen offset:3072 sc1
    s_waitcnt vmcnt(19)
    ds_read_b128 v[0:3], v224 offset:0
    ds_read_b128 v[4:7], v224 offset:64
    ds_read_b128 v[8:11], v224 offset:128
    ds_read_b128 v[12:15], v224 offset:192
    ds_read_b128 v[16:19], v224 offset:256
    ds_read_b128 v[20:23], v224 offset:320
    ds_read_b128 v[24:27], v224 offset:384
    ds_read_b128 v[28:31], v224 offset:448
    ds_read_b128 v[32:35], v224 offset:512
    ds_read_b128 v[36:39], v224 offset:576
    ds_read_b128 v[40:43], v224 offset:640
    ds_read_b128 v[44:47], v224 offset:704
    ds_read_b128 v[48:51], v224 offset:768
    ds_read_b128 v[52:55], v224 offset:832
    s_add_u32 s51, s50, 27262976
    s_mul_i32 s48, s34, 7168
    s_add_u32 s50, s50, s48
    s_add_u32 s50, s50, 25165824
    v_mov_b32 v210, 0
    v_mov_b32 v211, 0
    s_waitcnt lgkmcnt(0)
    ds_read_b128 v[56:59], v225 offset:0
    ds_read_b128 v[60:63], v225 offset:64
    ds_read_b128 v[64:67], v225 offset:128
    ds_read_b128 v[68:71], v225 offset:192
    ds_read_b128 v[72:75], v225 offset:256
    ds_read_b128 v[76:79], v225 offset:320
    ds_read_b128 v[80:83], v225 offset:384
    ds_read_b128 v[84:87], v225 offset:448
    ds_read_b128 v[88:91], v225 offset:512
    ds_read_b128 v[92:95], v225 offset:576
    ds_read_b128 v[96:99], v225 offset:640
    ds_read_b128 v[100:103], v225 offset:704
    ds_read_b128 v[104:107], v225 offset:768
    ds_read_b128 v[108:111], v225 offset:832
    buffer_store_dwordx4 v[0:3], v226, s[4:7], s51 offen offset:0 sc1
    buffer_store_dwordx4 v[4:7], v226, s[4:7], s51 offen offset:2048 sc1
    s_add_u32 s51, s51, 4096
    buffer_store_dwordx4 v[8:11], v226, s[4:7], s51 offen offset:0 sc1
    buffer_store_dwordx4 v[12:15], v226, s[4:7], s51 offen offset:2048 sc1
    s_add_u32 s51, s51, 4096
    buffer_store_dwordx4 v[16:19], v226, s[4:7], s51 offen offset:0 sc1
    buffer_store_dwordx4 v[20:23], v226, s[4:7], s51 offen offset:2048 sc1
    s_add_u32 s51, s51, 4096
    buffer_store_dwordx4 v[24:27], v226, s[4:7], s51 offen offset:0 sc1
    buffer_store_dwordx4 v[28:31], v226, s[4:7], s51 offen offset:2048 sc1
    s_add_u32 s51, s51, 4096
    buffer_store_dwordx4 v[32:35], v226, s[4:7], s51 offen offset:0 sc1
    buffer_store_dwordx4 v[36:39], v226, s[4:7], s51 offen offset:2048 sc1
    s_add_u32 s51, s51, 4096
    buffer_store_dwordx4 v[40:43], v226, s[4:7], s51 offen offset:0 sc1
    buffer_store_dwordx4 v[44:47], v226, s[4:7], s51 offen offset:2048 sc1
    s_add_u32 s51, s51, 4096
    buffer_store_dwordx4 v[48:51], v226, s[4:7], s51 offen offset:0 sc1
    buffer_store_dwordx4 v[52:55], v226, s[4:7], s51 offen offset:2048 sc1
    s_waitcnt lgkmcnt(0)
    v_swap_b32 v57, v58
    buffer_store_dwordx4 v[56:59], v212, s[4:7], s50 offen offset:0 sc1
    v_swap_b32 v61, v62
    buffer_store_dwordx4 v[60:63], v212, s[4:7], s50 offen offset:1024 sc1
    v_swap_b32 v65, v66
    buffer_store_dwordx4 v[64:67], v212, s[4:7], s50 offen offset:2048 sc1
    v_swap_b32 v69, v70
    buffer_store_dwordx4 v[68:71], v212, s[4:7], s50 offen offset:3072 sc1
    s_add_u32 s50, s50, 4096
    v_swap_b32 v73, v74
    buffer_store_dwordx4 v[72:75], v212, s[4:7], s50 offen offset:0 sc1
    v_swap_b32 v77, v78
    buffer_store_dwordx4 v[76:79], v212, s[4:7], s50 offen offset:1024 sc1
    v_swap_b32 v81, v82
    buffer_store_dwordx4 v[80:83], v212, s[4:7], s50 offen offset:2048 sc1
    s_add_u32 s50, s50, 10240
    v_swap_b32 v85, v86
    buffer_store_dwordx4 v[84:87], v212, s[4:7], s50 offen offset:0 sc1
    v_swap_b32 v89, v90
    buffer_store_dwordx4 v[88:91], v212, s[4:7], s50 offen offset:1024 sc1
    v_swap_b32 v93, v94
    buffer_store_dwordx4 v[92:95], v212, s[4:7], s50 offen offset:2048 sc1
    v_swap_b32 v97, v98
    buffer_store_dwordx4 v[96:99], v212, s[4:7], s50 offen offset:3072 sc1
    s_add_u32 s50, s50, 4096
    v_swap_b32 v101, v102
    buffer_store_dwordx4 v[100:103], v212, s[4:7], s50 offen offset:0 sc1
    v_swap_b32 v105, v106
    buffer_store_dwordx4 v[104:107], v212, s[4:7], s50 offen offset:1024 sc1
    v_swap_b32 v109, v110
    buffer_store_dwordx4 v[108:111], v212, s[4:7], s50 offen offset:2048 sc1
    s_waitcnt vmcnt(33)
    v_dot2_f32_bf16 v210, v0, v112, v210
    v_dot2_f32_bf16 v211, v1, v113, v211
    v_dot2_f32_bf16 v210, v2, v114, v210
    v_dot2_f32_bf16 v211, v3, v115, v211
    v_dot2_f32_bf16 v210, v4, v116, v210
    v_dot2_f32_bf16 v211, v5, v117, v211
    v_dot2_f32_bf16 v210, v6, v118, v210
    v_dot2_f32_bf16 v211, v7, v119, v211
    v_dot2_f32_bf16 v210, v8, v120, v210
    v_dot2_f32_bf16 v211, v9, v121, v211
    v_dot2_f32_bf16 v210, v10, v122, v210
    v_dot2_f32_bf16 v211, v11, v123, v211
    v_dot2_f32_bf16 v210, v12, v124, v210
    v_dot2_f32_bf16 v211, v13, v125, v211
    v_dot2_f32_bf16 v210, v14, v126, v210
    v_dot2_f32_bf16 v211, v15, v127, v211
    v_dot2_f32_bf16 v210, v16, v128, v210
    v_dot2_f32_bf16 v211, v17, v129, v211
    v_dot2_f32_bf16 v210, v18, v130, v210
    v_dot2_f32_bf16 v211, v19, v131, v211
    v_dot2_f32_bf16 v210, v20, v132, v210
    v_dot2_f32_bf16 v211, v21, v133, v211
    v_dot2_f32_bf16 v210, v22, v134, v210
    v_dot2_f32_bf16 v211, v23, v135, v211
    v_dot2_f32_bf16 v210, v24, v136, v210
    v_dot2_f32_bf16 v211, v25, v137, v211
    v_dot2_f32_bf16 v210, v26, v138, v210
    v_dot2_f32_bf16 v211, v27, v139, v211
    v_dot2_f32_bf16 v210, v28, v140, v210
    v_dot2_f32_bf16 v211, v29, v141, v211
    v_dot2_f32_bf16 v210, v30, v142, v210
    v_dot2_f32_bf16 v211, v31, v143, v211
    v_dot2_f32_bf16 v210, v32, v144, v210
    v_dot2_f32_bf16 v211, v33, v145, v211
    v_dot2_f32_bf16 v210, v34, v146, v210
    v_dot2_f32_bf16 v211, v35, v147, v211
    v_dot2_f32_bf16 v210, v36, v148, v210
    v_dot2_f32_bf16 v211, v37, v149, v211
    v_dot2_f32_bf16 v210, v38, v150, v210
    v_dot2_f32_bf16 v211, v39, v151, v211
    v_dot2_f32_bf16 v210, v40, v152, v210
    v_dot2_f32_bf16 v211, v41, v153, v211
    v_dot2_f32_bf16 v210, v42, v154, v210
    v_dot2_f32_bf16 v211, v43, v155, v211
    v_dot2_f32_bf16 v210, v44, v156, v210
    v_dot2_f32_bf16 v211, v45, v157, v211
    v_dot2_f32_bf16 v210, v46, v158, v210
    v_dot2_f32_bf16 v211, v47, v159, v211
    v_dot2_f32_bf16 v210, v48, v160, v210
    v_dot2_f32_bf16 v211, v49, v161, v211
    v_dot2_f32_bf16 v210, v50, v162, v210
    v_dot2_f32_bf16 v211, v51, v163, v211
    v_dot2_f32_bf16 v210, v52, v164, v210
    v_dot2_f32_bf16 v211, v53, v165, v211
    v_dot2_f32_bf16 v210, v54, v166, v210
    v_dot2_f32_bf16 v211, v55, v167, v211
    s_nop 2
    v_add_f32 v210, v210, v211
    v_mov_b32 v211, v210
    s_nop 1
    v_permlane32_swap_b32 v210, v211
    v_add_f32 v210, v210, v211
    v_mov_b32 v211, v210
    s_nop 1
    v_permlane16_swap_b32 v210, v211
    v_add_f32 v210, v210, v211
    v_mul_f32 v210, 0xbfb8aa3b, v210
    v_exp_f32 v210, v210
    v_and_b32 v208, 15, v207
    v_add_f32 v210, 1.0, v210
    v_rcp_f32 v210, v210
    v_lshlrev_b32 v208, 2, v208
    s_lshl_b32 s50, s45, 1
    s_add_u32 s50, s50, s34
    s_lshl_b32 s50, s50, 6
    s_add_u32 s50, s50, 15400960
    buffer_store_dword v210, v208, s[4:7], s50 offen sc1
    s_and_b32 s48, s45, 1
    s_lshl_b32 s48, s48, 7
    s_add_u32 s48, s48, 15238144
    v_mov_b32 v210, 1
    v_mov_b32 v211, 0
    s_waitcnt vmcnt(0)
    s_mov_b64 exec, 1
    buffer_atomic_add v210, v211, s[4:7], s48 offen
    s_mov_b64 exec, -1
L_side_e:
    s_barrier
    s_cmp_eq_u32 s21, 0
    s_cbranch_scc1 GB_go
    s_branch GA_go
GB_entry:
    s_mov_b32 s45, s16
    s_mov_b32 s21, 0
    s_branch L_side
GB_go:
    v_mbcnt_lo_u32_b32 v0, -1, 0
    v_mbcnt_hi_u32_b32 v0, -1, v0
    v_lshlrev_b32 v250, 4, v0
    v_mov_b32 v251, 0
    v_lshrrev_b32 v1, 5, v0
    v_and_b32 v2, 31, v0
    v_and_b32 v3, 15, v0
    v_lshrrev_b32 v4, 4, v0
    s_mov_b32 s20, 0
    s_lshr_b32 s36, s16, 2
    s_and_b32 s37, s16, 3
    s_lshl_b32 s37, s37, 2
    s_add_u32 s37, s37, s17
    v_lshlrev_b32 v5, 4, v3
    v_lshl_add_u32 v5, v1, 8, v5
    v_bfe_u32 v6, v0, 4, 1
    v_lshl_add_u32 v8, v6, 14, v5
    v_mul_u32_u24 v6, 229376, v6
    v_add_u32 v5, v5, v6
    s_mul_i32 s39, s36, 458752
    s_mul_i32 s40, s37, 14336
    s_add_u32 s39, s39, s40
    s_add_u32 s39, s39, 7340032
    s_lshl_b32 s42, s36, 15
    s_lshl_b32 s40, s37, 10
    s_add_u32 s42, s42, s40
    s_add_u32 s42, s42, 33554432
    s_cmp_lg_u32 s17, 0
    s_cbranch_scc1 WW_3
    v_mbcnt_lo_u32_b32 v253, -1, 0
    v_and_b32 v253, 3, v253
    v_lshlrev_b32 v253, 7, v253
    s_mov_b32 s41, 15237632
    s_mov_b64 exec, 15
WD_4:
    buffer_load_dword v252, v253, s[4:7], s41 offen sc1
    s_waitcnt vmcnt(0)
    v_cmp_gt_u32 vcc, 0x40, v252
    s_cbranch_vccz WD_4_ok
    s_sleep 4
    s_sub_u32 s35, s35, 1
    s_cmp_lg_u32 s35, 0
    s_cbranch_scc1 WD_4
    s_branch L_exit
WD_4_ok:
    s_mov_b64 exec, -1
WW_3:
    s_barrier
    buffer_load_dwordx4 a[0:3], v5, s[4:7], s39 offen offset:0 sc1
    buffer_load_dwordx4 a[4:7], v5, s[4:7], s39 offen offset:512 sc1
    buffer_load_dwordx4 a[8:11], v5, s[4:7], s39 offen offset:1024 sc1
    buffer_load_dwordx4 a[12:15], v5, s[4:7], s39 offen offset:1536 sc1
    buffer_load_dwordx4 a[16:19], v5, s[4:7], s39 offen offset:2048 sc1
    buffer_load_dwordx4 a[20:23], v5, s[4:7], s39 offen offset:2560 sc1
    buffer_load_dwordx4 a[24:27], v5, s[4:7], s39 offen offset:3072 sc1
    buffer_load_dwordx4 a[28:31], v5, s[4:7], s39 offen offset:3584 sc1
    s_add_u32 s39, s39, 4096
    buffer_load_dwordx4 a[32:35], v5, s[4:7], s39 offen offset:0 sc1
    buffer_load_dwordx4 a[36:39], v5, s[4:7], s39 offen offset:512 sc1
    buffer_load_dwordx4 a[40:43], v5, s[4:7], s39 offen offset:1024 sc1
    buffer_load_dwordx4 a[44:47], v5, s[4:7], s39 offen offset:1536 sc1
    buffer_load_dwordx4 a[48:51], v5, s[4:7], s39 offen offset:2048 sc1
    buffer_load_dwordx4 a[52:55], v5, s[4:7], s39 offen offset:2560 sc1
    buffer_load_dwordx4 a[56:59], v5, s[4:7], s39 offen offset:3072 sc1
    buffer_load_dwordx4 a[60:63], v5, s[4:7], s39 offen offset:3584 sc1
    s_add_u32 s39, s39, 4096
    buffer_load_dwordx4 a[64:67], v5, s[4:7], s39 offen offset:0 sc1
    buffer_load_dwordx4 a[68:71], v5, s[4:7], s39 offen offset:512 sc1
    buffer_load_dwordx4 a[72:75], v5, s[4:7], s39 offen offset:1024 sc1
    buffer_load_dwordx4 a[76:79], v5, s[4:7], s39 offen offset:1536 sc1
    buffer_load_dwordx4 a[80:83], v5, s[4:7], s39 offen offset:2048 sc1
    buffer_load_dwordx4 a[84:87], v5, s[4:7], s39 offen offset:2560 sc1
    buffer_load_dwordx4 a[88:91], v5, s[4:7], s39 offen offset:3072 sc1
    buffer_load_dwordx4 a[92:95], v5, s[4:7], s39 offen offset:3584 sc1
    s_add_u32 s39, s39, 4096
    buffer_load_dwordx4 a[96:99], v5, s[4:7], s39 offen offset:0 sc1
    buffer_load_dwordx4 a[100:103], v5, s[4:7], s39 offen offset:512 sc1
    buffer_load_dwordx4 a[104:107], v5, s[4:7], s39 offen offset:1024 sc1
    buffer_load_dwordx4 a[108:111], v5, s[4:7], s39 offen offset:1536 sc1
    s_add_u32 s39, s39, 2048
    s_mul_i32 s43, s17, 7168
    s_mul_i32 s44, s20, 28672
    s_add_u32 s44, s44, s43
    s_add_u32 s44, s44, 27262976
    v_mov_b32 v11, v250
    s_mov_b32 s45, 0
    s_cmp_lg_u32 s17, 0
    s_cbranch_scc1 WW_5
    v_mbcnt_lo_u32_b32 v253, -1, 0
    v_and_b32 v253, 1, v253
    v_lshlrev_b32 v253, 7, v253
    s_mov_b32 s41, 15238144
    s_mov_b64 exec, 3
WD_6:
    buffer_load_dword v252, v253, s[4:7], s41 offen sc1
    s_waitcnt vmcnt(0)
    v_cmp_gt_u32 vcc, 0x40, v252
    s_cbranch_vccz WD_6_ok
    s_sleep 4
    s_sub_u32 s35, s35, 1
    s_cmp_lg_u32 s35, 0
    s_cbranch_scc1 WD_6
    s_branch L_exit
WD_6_ok:
    s_mov_b64 exec, -1
WW_5:
    s_barrier
    s_add_u32 m0, s43, 0
    s_add_u32 s40, s44, 0
    buffer_load_dwordx4 v250, s[4:7], s40 offen offset:0 sc1 lds
    buffer_load_dwordx4 v250, s[4:7], s40 offen offset:1024 sc1 lds
    buffer_load_dwordx4 v250, s[4:7], s40 offen offset:2048 sc1 lds
    buffer_load_dwordx4 v250, s[4:7], s40 offen offset:3072 sc1 lds
    s_add_u32 m0, s43, 4096
    s_add_u32 s40, s44, 4096
    buffer_load_dwordx4 v250, s[4:7], s40 offen offset:0 sc1 lds
    buffer_load_dwordx4 v250, s[4:7], s40 offen offset:1024 sc1 lds
    buffer_load_dwordx4 v250, s[4:7], s40 offen offset:2048 sc1 lds
    s_xor_b32 s43, s43, 0x8000
    s_add_u32 s44, s44, 28672
    s_waitcnt vmcnt(0)
GB_loop:
    s_waitcnt vmcnt(2)
    s_barrier
    s_add_u32 m0, s43, 0
    s_add_u32 s40, s44, 0
    buffer_load_dwordx4 v250, s[4:7], s40 offen offset:0 sc1 lds
    buffer_load_dwordx4 v250, s[4:7], s40 offen offset:1024 sc1 lds
    buffer_load_dwordx4 v250, s[4:7], s40 offen offset:2048 sc1 lds
    buffer_load_dwordx4 v250, s[4:7], s40 offen offset:3072 sc1 lds
    s_add_u32 m0, s43, 4096
    s_add_u32 s40, s44, 4096
    buffer_load_dwordx4 v250, s[4:7], s40 offen offset:0 sc1 lds
    buffer_load_dwordx4 v250, s[4:7], s40 offen offset:1024 sc1 lds
    buffer_load_dwordx4 v250, s[4:7], s40 offen offset:2048 sc1 lds
    s_xor_b32 s43, s43, 0x8000
    s_add_u32 s44, s44, 28672
    ds_read_b128 v[48:51], v11 offset:0
    ds_read_b128 v[52:55], v11 offset:1024
    ds_read_b128 v[56:59], v11 offset:2048
    ds_read_b128 v[60:63], v11 offset:3072
    ds_read_b128 v[64:67], v11 offset:4096
    ds_read_b128 v[68:71], v11 offset:5120
    s_waitcnt lgkmcnt(5)
    v_mfma_f32_32x32x16_bf16 v[16:31], v[48:51], a[0:3], 0
    ds_read_b128 v[48:51], v11 offset:6144
    s_waitcnt lgkmcnt(5)
    v_mfma_f32_32x32x16_bf16 v[16:31], v[52:55], a[4:7], v[16:31]
    ds_read_b128 v[52:55], v11 offset:7168
    s_waitcnt lgkmcnt(5)
    v_mfma_f32_32x32x16_bf16 v[16:31], v[56:59], a[8:11], v[16:31]
    ds_read_b128 v[56:59], v11 offset:8192
    s_waitcnt lgkmcnt(5)
    v_mfma_f32_32x32x16_bf16 v[16:31], v[60:63], a[12:15], v[16:31]
    ds_read_b128 v[60:63], v11 offset:9216
    s_waitcnt lgkmcnt(5)
    v_mfma_f32_32x32x16_bf16 v[16:31], v[64:67], a[16:19], v[16:31]
    ds_read_b128 v[64:67], v11 offset:10240
    s_waitcnt lgkmcnt(5)
    v_mfma_f32_32x32x16_bf16 v[16:31], v[68:71], a[20:23], v[16:31]
    ds_read_b128 v[68:71], v11 offset:11264
    s_waitcnt lgkmcnt(5)
    v_mfma_f32_32x32x16_bf16 v[16:31], v[48:51], a[24:27], v[16:31]
    ds_read_b128 v[48:51], v11 offset:12288
    s_waitcnt lgkmcnt(5)
    v_mfma_f32_32x32x16_bf16 v[16:31], v[52:55], a[28:31], v[16:31]
    ds_read_b128 v[52:55], v11 offset:13312
    s_waitcnt lgkmcnt(5)
    v_mfma_f32_32x32x16_bf16 v[16:31], v[56:59], a[32:35], v[16:31]
    ds_read_b128 v[56:59], v11 offset:14336
    s_waitcnt lgkmcnt(5)
    v_mfma_f32_32x32x16_bf16 v[16:31], v[60:63], a[36:39], v[16:31]
    ds_read_b128 v[60:63], v11 offset:15360
    s_waitcnt lgkmcnt(5)
    v_mfma_f32_32x32x16_bf16 v[16:31], v[64:67], a[40:43], v[16:31]
    ds_read_b128 v[64:67], v11 offset:16384
    s_waitcnt lgkmcnt(5)
    v_mfma_f32_32x32x16_bf16 v[16:31], v[68:71], a[44:47], v[16:31]
    ds_read_b128 v[68:71], v11 offset:17408
    s_waitcnt lgkmcnt(5)
    v_mfma_f32_32x32x16_bf16 v[16:31], v[48:51], a[48:51], v[16:31]
    ds_read_b128 v[48:51], v11 offset:18432
    s_waitcnt lgkmcnt(5)
    v_mfma_f32_32x32x16_bf16 v[16:31], v[52:55], a[52:55], v[16:31]
    ds_read_b128 v[52:55], v11 offset:19456
    s_waitcnt lgkmcnt(5)
    s_waitcnt vmcnt(7)
    s_barrier
    s_cmp_eq_u32 s45, 0
    s_cbranch_scc1 GB_noar
    s_sub_u32 s46, s20, 1
    s_cmp_lg_u32 s17, 0
    s_cbranch_scc1 AR_7
    s_lshl_b32 s41, s46, 11
    s_add_u32 s41, s41, 15269888
    v_mov_b32 v252, 1
    s_mov_b64 exec, 1
    buffer_atomic_add v252, v251, s[4:7], s41 offen
    s_mov_b64 exec, -1
AR_7:
GB_noar:
    v_mfma_f32_32x32x16_bf16 v[16:31], v[56:59], a[56:59], v[16:31]
    ds_read_b128 v[56:59], v11 offset:20480
    s_waitcnt lgkmcnt(5)
    v_mfma_f32_32x32x16_bf16 v[16:31], v[60:63], a[60:63], v[16:31]
    ds_read_b128 v[60:63], v11 offset:21504
    s_waitcnt lgkmcnt(5)
    v_mfma_f32_32x32x16_bf16 v[16:31], v[64:67], a[64:67], v[16:31]
    ds_read_b128 v[64:67], v11 offset:22528
    s_waitcnt lgkmcnt(5)
    v_mfma_f32_32x32x16_bf16 v[16:31], v[68:71], a[68:71], v[16:31]
    ds_read_b128 v[68:71], v11 offset:23552
    s_waitcnt lgkmcnt(5)
    v_mfma_f32_32x32x16_bf16 v[16:31], v[48:51], a[72:75], v[16:31]
    ds_read_b128 v[48:51], v11 offset:24576
    s_waitcnt lgkmcnt(5)
    v_mfma_f32_32x32x16_bf16 v[16:31], v[52:55], a[76:79], v[16:31]
    ds_read_b128 v[52:55], v11 offset:25600
    s_waitcnt lgkmcnt(5)
    v_mfma_f32_32x32x16_bf16 v[16:31], v[56:59], a[80:83], v[16:31]
    ds_read_b128 v[56:59], v11 offset:26624
    s_waitcnt lgkmcnt(5)
    v_mfma_f32_32x32x16_bf16 v[16:31], v[60:63], a[84:87], v[16:31]
    ds_read_b128 v[60:63], v11 offset:27648
    s_waitcnt lgkmcnt(5)
    v_mfma_f32_32x32x16_bf16 v[16:31], v[64:67], a[88:91], v[16:31]
    s_waitcnt lgkmcnt(4)
    v_mfma_f32_32x32x16_bf16 v[16:31], v[68:71], a[92:95], v[16:31]
    s_waitcnt lgkmcnt(3)
    v_mfma_f32_32x32x16_bf16 v[16:31], v[48:51], a[96:99], v[16:31]
    s_waitcnt lgkmcnt(2)
    v_mfma_f32_32x32x16_bf16 v[16:31], v[52:55], a[100:103], v[16:31]
    s_waitcnt lgkmcnt(1)
    v_mfma_f32_32x32x16_bf16 v[16:31], v[56:59], a[104:107], v[16:31]
    s_waitcnt lgkmcnt(0)
    v_mfma_f32_32x32x16_bf16 v[16:31], v[60:63], a[108:111], v[16:31]
    v_xor_b32 v11, 0x8000, v11
    s_nop 10
    v_cvt_pk_bf16_f32 v72, v16, v17
    v_cvt_pk_bf16_f32 v73, v20, v21
    v_cvt_pk_bf16_f32 v74, v18, v19
    v_cvt_pk_bf16_f32 v75, v22, v23
    buffer_store_dwordx4 v[72:75], v8, s[4:7], s42 offen offset:0 sc1
    v_cvt_pk_bf16_f32 v76, v24, v25
    v_cvt_pk_bf16_f32 v77, v28, v29
    v_cvt_pk_bf16_f32 v78, v26, v27
    v_cvt_pk_bf16_f32 v79, v30, v31
    buffer_store_dwordx4 v[76:79], v8, s[4:7], s42 offen offset:512 sc1
    s_add_u32 s42, s42, 458752
    s_add_u32 s45, s45, 1
    s_add_u32 s20, s20, 1
    s_cmp_lt_u32 s20, 64
    s_cbranch_scc1 GB_loop
    s_waitcnt vmcnt(0)
    s_barrier
    s_sub_u32 s46, s20, 1
    s_cmp_lg_u32 s17, 0
    s_cbranch_scc1 AR_8
    s_lshl_b32 s41, s46, 11
    s_add_u32 s41, s41, 15269888
    v_mov_b32 v252, 1
    s_mov_b64 exec, 1
    buffer_atomic_add v252, v251, s[4:7], s41 offen
    s_mov_b64 exec, -1
AR_8:
    s_branch L_next_free
GA_entry:
    s_add_u32 s45, s16, 56
    s_mov_b32 s21, 1
    s_cmp_lt_u32 s45, 64
    s_cbranch_scc1 L_side
GA_go:
    v_mbcnt_lo_u32_b32 v0, -1, 0
    v_mbcnt_hi_u32_b32 v0, -1, v0
    v_lshlrev_b32 v250, 4, v0
    v_mov_b32 v251, 0
    v_lshrrev_b32 v1, 5, v0
    v_and_b32 v2, 31, v0
    v_and_b32 v3, 15, v0
    v_lshrrev_b32 v4, 4, v0
    s_cmp_lg_u32 s17, 0
    s_cbranch_scc1 WT_9_ok
    v_mov_b32 v253, 192
WT_9:
    buffer_load_dword v252, v253, s[12:15], 0 offen sc1
    s_waitcnt vmcnt(0)
    v_cmp_eq_u32 vcc, 0, v252
    s_cbranch_vccz WT_9_ok
    s_sleep 32
    s_sub_u32 s35, s35, 1
    s_cmp_lg_u32 s35, 0
    s_cbranch_scc1 WT_9
    s_endpgm
WT_9_ok:
    s_barrier
    v_and_b32 v5, 0x13, v2
    v_bfe_u32 v6, v2, 2, 1
    v_lshl_add_u32 v5, v6, 3, v5
    v_bfe_u32 v6, v2, 3, 1
    v_lshl_add_u32 v5, v6, 2, v5
    v_and_b32 v6, 1, v5
    v_mul_u32_u24 v6, 14336, v6
    v_lshrrev_b32 v5, 1, v5
    v_lshl_add_u32 v5, v5, 4, v6
    v_lshl_add_u32 v5, v1, 8, v5
    v_mov_b32 v8, v250
    s_and_b32 s20, s16, 1
    s_lshr_b32 s16, s16, 1
    s_lshl_b32 s36, s16, 3
    s_lshl_b32 s38, s17, 1
    s_add_u32 s36, s36, s38
    s_mul_i32 s39, s36, 28672
    s_lshl_b32 s42, s36, 11
    s_add_u32 s42, s42, 67108864
    s_mul_i32 s40, s20, 458752
    s_add_u32 s42, s42, s40
    s_cmp_lg_u32 s17, 0
    s_cbranch_scc1 WW_10
    v_mbcnt_lo_u32_b32 v253, -1, 0
    v_and_b32 v253, 3, v253
    v_lshlrev_b32 v253, 7, v253
    s_mov_b32 s41, 15237120
    s_mov_b64 exec, 15
WD_11:
    buffer_load_dword v252, v253, s[4:7], s41 offen sc1
    s_waitcnt vmcnt(0)
    v_cmp_gt_u32 vcc, 0x40, v252
    s_cbranch_vccz WD_11_ok
    s_sleep 4
    s_sub_u32 s35, s35, 1
    s_cmp_lg_u32 s35, 0
    s_cbranch_scc1 WD_11
    s_branch L_exit
WD_11_ok:
    s_mov_b64 exec, -1
WW_10:
    s_barrier
    buffer_load_dwordx4 a[0:3], v5, s[4:7], s39 offen offset:0 sc1
    buffer_load_dwordx4 a[4:7], v5, s[4:7], s39 offen offset:512 sc1
    buffer_load_dwordx4 a[8:11], v5, s[4:7], s39 offen offset:1024 sc1
    buffer_load_dwordx4 a[12:15], v5, s[4:7], s39 offen offset:1536 sc1
    buffer_load_dwordx4 a[16:19], v5, s[4:7], s39 offen offset:2048 sc1
    buffer_load_dwordx4 a[20:23], v5, s[4:7], s39 offen offset:2560 sc1
    buffer_load_dwordx4 a[24:27], v5, s[4:7], s39 offen offset:3072 sc1
    buffer_load_dwordx4 a[28:31], v5, s[4:7], s39 offen offset:3584 sc1
    s_add_u32 s39, s39, 4096
    buffer_load_dwordx4 a[32:35], v5, s[4:7], s39 offen offset:0 sc1
    buffer_load_dwordx4 a[36:39], v5, s[4:7], s39 offen offset:512 sc1
    buffer_load_dwordx4 a[40:43], v5, s[4:7], s39 offen offset:1024 sc1
    buffer_load_dwordx4 a[44:47], v5, s[4:7], s39 offen offset:1536 sc1
    buffer_load_dwordx4 a[48:51], v5, s[4:7], s39 offen offset:2048 sc1
    buffer_load_dwordx4 a[52:55], v5, s[4:7], s39 offen offset:2560 sc1
    buffer_load_dwordx4 a[56:59], v5, s[4:7], s39 offen offset:3072 sc1
    buffer_load_dwordx4 a[60:63], v5, s[4:7], s39 offen offset:3584 sc1
    s_add_u32 s39, s39, 4096
    buffer_load_dwordx4 a[64:67], v5, s[4:7], s39 offen offset:0 sc1
    buffer_load_dwordx4 a[68:71], v5, s[4:7], s39 offen offset:512 sc1
    buffer_load_dwordx4 a[72:75], v5, s[4:7], s39 offen offset:1024 sc1
    buffer_load_dwordx4 a[76:79], v5, s[4:7], s39 offen offset:1536 sc1
    buffer_load_dwordx4 a[80:83], v5, s[4:7], s39 offen offset:2048 sc1
    buffer_load_dwordx4 a[84:87], v5, s[4:7], s39 offen offset:2560 sc1
    buffer_load_dwordx4 a[88:91], v5, s[4:7], s39 offen offset:3072 sc1
    buffer_load_dwordx4 a[92:95], v5, s[4:7], s39 offen offset:3584 sc1
    s_add_u32 s39, s39, 4096
    buffer_load_dwordx4 a[96:99], v5, s[4:7], s39 offen offset:0 sc1
    buffer_load_dwordx4 a[100:103], v5, s[4:7], s39 offen offset:512 sc1
    buffer_load_dwordx4 a[104:107], v5, s[4:7], s39 offen offset:1024 sc1
    buffer_load_dwordx4 a[108:111], v5, s[4:7], s39 offen offset:1536 sc1
    s_add_u32 s39, s39, 16384
    buffer_load_dwordx4 a[112:115], v5, s[4:7], s39 offen offset:0 sc1
    buffer_load_dwordx4 a[116:119], v5, s[4:7], s39 offen offset:512 sc1
    buffer_load_dwordx4 a[120:123], v5, s[4:7], s39 offen offset:1024 sc1
    buffer_load_dwordx4 a[124:127], v5, s[4:7], s39 offen offset:1536 sc1
    buffer_load_dwordx4 a[128:131], v5, s[4:7], s39 offen offset:2048 sc1
    buffer_load_dwordx4 a[132:135], v5, s[4:7], s39 offen offset:2560 sc1
    buffer_load_dwordx4 a[136:139], v5, s[4:7], s39 offen offset:3072 sc1
    buffer_load_dwordx4 a[140:143], v5, s[4:7], s39 offen offset:3584 sc1
    s_add_u32 s39, s39, 4096
    buffer_load_dwordx4 a[144:147], v5, s[4:7], s39 offen offset:0 sc1
    buffer_load_dwordx4 a[148:151], v5, s[4:7], s39 offen offset:512 sc1
    buffer_load_dwordx4 a[152:155], v5, s[4:7], s39 offen offset:1024 sc1
    buffer_load_dwordx4 a[156:159], v5, s[4:7], s39 offen offset:1536 sc1
    buffer_load_dwordx4 a[160:163], v5, s[4:7], s39 offen offset:2048 sc1
    buffer_load_dwordx4 a[164:167], v5, s[4:7], s39 offen offset:2560 sc1
    buffer_load_dwordx4 a[168:171], v5, s[4:7], s39 offen offset:3072 sc1
    buffer_load_dwordx4 a[172:175], v5, s[4:7], s39 offen offset:3584 sc1
    s_add_u32 s39, s39, 4096
    buffer_load_dwordx4 a[176:179], v5, s[4:7], s39 offen offset:0 sc1
    buffer_load_dwordx4 a[180:183], v5, s[4:7], s39 offen offset:512 sc1
    buffer_load_dwordx4 a[184:187], v5, s[4:7], s39 offen offset:1024 sc1
    buffer_load_dwordx4 a[188:191], v5, s[4:7], s39 offen offset:1536 sc1
    buffer_load_dwordx4 a[192:195], v5, s[4:7], s39 offen offset:2048 sc1
    buffer_load_dwordx4 a[196:199], v5, s[4:7], s39 offen offset:2560 sc1
    buffer_load_dwordx4 a[200:203], v5, s[4:7], s39 offen offset:3072 sc1
    buffer_load_dwordx4 a[204:207], v5, s[4:7], s39 offen offset:3584 sc1
    s_add_u32 s39, s39, 4096
    buffer_load_dwordx4 a[208:211], v5, s[4:7], s39 offen offset:0 sc1
    buffer_load_dwordx4 a[212:215], v5, s[4:7], s39 offen offset:512 sc1
    buffer_load_dwordx4 a[216:219], v5, s[4:7], s39 offen offset:1024 sc1
    buffer_load_dwordx4 a[220:223], v5, s[4:7], s39 offen offset:1536 sc1
    s_mul_i32 s43, s17, 7168
    s_mul_i32 s44, s20, 28672
    s_add_u32 s44, s44, s43
    s_add_u32 s44, s44, 27262976
    v_mov_b32 v11, v250
    s_mov_b32 s45, 0
    s_cmp_lg_u32 s17, 0
    s_cbranch_scc1 WW_12
    v_mbcnt_lo_u32_b32 v253, -1, 0
    v_and_b32 v253, 1, v253
    v_lshlrev_b32 v253, 7, v253
    s_mov_b32 s41, 15238144
    s_mov_b64 exec, 3
WD_13:
    buffer_load_dword v252, v253, s[4:7], s41 offen sc1
    s_waitcnt vmcnt(0)
    v_cmp_gt_u32 vcc, 0x40, v252
    s_cbranch_vccz WD_13_ok
    s_sleep 4
    s_sub_u32 s35, s35, 1
    s_cmp_lg_u32 s35, 0
    s_cbranch_scc1 WD_13
    s_branch L_exit
WD_13_ok:
    s_mov_b64 exec, -1
WW_12:
    s_barrier
    s_add_u32 m0, s43, 0
    s_add_u32 s40, s44, 0
    buffer_load_dwordx4 v250, s[4:7], s40 offen offset:0 sc1 lds
    buffer_load_dwordx4 v250, s[4:7], s40 offen offset:1024 sc1 lds
    buffer_load_dwordx4 v250, s[4:7], s40 offen offset:2048 sc1 lds
    buffer_load_dwordx4 v250, s[4:7], s40 offen offset:3072 sc1 lds
    s_add_u32 m0, s43, 4096
    s_add_u32 s40, s44, 4096
    buffer_load_dwordx4 v250, s[4:7], s40 offen offset:0 sc1 lds
    buffer_load_dwordx4 v250, s[4:7], s40 offen offset:1024 sc1 lds
    buffer_load_dwordx4 v250, s[4:7], s40 offen offset:2048 sc1 lds
    s_xor_b32 s43, s43, 0x8000
    s_add_u32 s44, s44, 57344
    s_waitcnt vmcnt(0)
GA_loop:
    s_waitcnt vmcnt(4)
    s_barrier
    s_add_u32 m0, s43, 0
    s_add_u32 s40, s44, 0
    buffer_load_dwordx4 v250, s[4:7], s40 offen offset:0 sc1 lds
    buffer_load_dwordx4 v250, s[4:7], s40 offen offset:1024 sc1 lds
    buffer_load_dwordx4 v250, s[4:7], s40 offen offset:2048 sc1 lds
    buffer_load_dwordx4 v250, s[4:7], s40 offen offset:3072 sc1 lds
    s_add_u32 m0, s43, 4096
    s_add_u32 s40, s44, 4096
    buffer_load_dwordx4 v250, s[4:7], s40 offen offset:0 sc1 lds
    buffer_load_dwordx4 v250, s[4:7], s40 offen offset:1024 sc1 lds
    buffer_load_dwordx4 v250, s[4:7], s40 offen offset:2048 sc1 lds
    s_xor_b32 s43, s43, 0x8000
    s_add_u32 s44, s44, 57344
    ds_read_b128 v[48:51], v11 offset:0
    ds_read_b128 v[52:55], v11 offset:1024
    ds_read_b128 v[56:59], v11 offset:2048
    ds_read_b128 v[60:63], v11 offset:3072
    ds_read_b128 v[64:67], v11 offset:4096
    ds_read_b128 v[68:71], v11 offset:5120
    s_waitcnt lgkmcnt(5)
    v_mfma_f32_32x32x16_bf16 v[16:31], a[0:3], v[48:51], 0
    v_mfma_f32_32x32x16_bf16 v[32:47], a[112:115], v[48:51], 0
    ds_read_b128 v[48:51], v11 offset:6144
    s_waitcnt lgkmcnt(5)
    v_mfma_f32_32x32x16_bf16 v[16:31], a[4:7], v[52:55], v[16:31]
    v_mfma_f32_32x32x16_bf16 v[32:47], a[116:119], v[52:55], v[32:47]
    ds_read_b128 v[52:55], v11 offset:7168
    s_waitcnt lgkmcnt(5)
    v_mfma_f32_32x32x16_bf16 v[16:31], a[8:11], v[56:59], v[16:31]
    v_mfma_f32_32x32x16_bf16 v[32:47], a[120:123], v[56:59], v[32:47]
    ds_read_b128 v[56:59], v11 offset:8192
    s_waitcnt lgkmcnt(5)
    v_mfma_f32_32x32x16_bf16 v[16:31], a[12:15], v[60:63], v[16:31]
    v_mfma_f32_32x32x16_bf16 v[32:47], a[124:127], v[60:63], v[32:47]
    ds_read_b128 v[60:63], v11 offset:9216
    s_waitcnt lgkmcnt(5)
    v_mfma_f32_32x32x16_bf16 v[16:31], a[16:19], v[64:67], v[16:31]
    v_mfma_f32_32x32x16_bf16 v[32:47], a[128:131], v[64:67], v[32:47]
    ds_read_b128 v[64:67], v11 offset:10240
    s_waitcnt lgkmcnt(5)
    v_mfma_f32_32x32x16_bf16 v[16:31], a[20:23], v[68:71], v[16:31]
    v_mfma_f32_32x32x16_bf16 v[32:47], a[132:135], v[68:71], v[32:47]
    ds_read_b128 v[68:71], v11 offset:11264
    s_waitcnt lgkmcnt(5)
    v_mfma_f32_32x32x16_bf16 v[16:31], a[24:27], v[48:51], v[16:31]
    v_mfma_f32_32x32x16_bf16 v[32:47], a[136:139], v[48:51], v[32:47]
    ds_read_b128 v[48:51], v11 offset:12288
    s_waitcnt lgkmcnt(5)
    v_mfma_f32_32x32x16_bf16 v[16:31], a[28:31], v[52:55], v[16:31]
    v_mfma_f32_32x32x16_bf16 v[32:47], a[140:143], v[52:55], v[32:47]
    ds_read_b128 v[52:55], v11 offset:13312
    s_waitcnt lgkmcnt(5)
    v_mfma_f32_32x32x16_bf16 v[16:31], a[32:35], v[56:59], v[16:31]
    v_mfma_f32_32x32x16_bf16 v[32:47], a[144:147], v[56:59], v[32:47]
    ds_read_b128 v[56:59], v11 offset:14336
    s_waitcnt lgkmcnt(5)
    v_mfma_f32_32x32x16_bf16 v[16:31], a[36:39], v[60:63], v[16:31]
    v_mfma_f32_32x32x16_bf16 v[32:47], a[148:151], v[60:63], v[32:47]
    ds_read_b128 v[60:63], v11 offset:15360
    s_waitcnt lgkmcnt(5)
    v_mfma_f32_32x32x16_bf16 v[16:31], a[40:43], v[64:67], v[16:31]
    v_mfma_f32_32x32x16_bf16 v[32:47], a[152:155], v[64:67], v[32:47]
    ds_read_b128 v[64:67], v11 offset:16384
    s_waitcnt lgkmcnt(5)
    v_mfma_f32_32x32x16_bf16 v[16:31], a[44:47], v[68:71], v[16:31]
    v_mfma_f32_32x32x16_bf16 v[32:47], a[156:159], v[68:71], v[32:47]
    ds_read_b128 v[68:71], v11 offset:17408
    s_waitcnt lgkmcnt(5)
    v_mfma_f32_32x32x16_bf16 v[16:31], a[48:51], v[48:51], v[16:31]
    v_mfma_f32_32x32x16_bf16 v[32:47], a[160:163], v[48:51], v[32:47]
    ds_read_b128 v[48:51], v11 offset:18432
    s_waitcnt lgkmcnt(5)
    v_mfma_f32_32x32x16_bf16 v[16:31], a[52:55], v[52:55], v[16:31]
    v_mfma_f32_32x32x16_bf16 v[32:47], a[164:167], v[52:55], v[32:47]
    ds_read_b128 v[52:55], v11 offset:19456
    s_waitcnt lgkmcnt(5)
    s_waitcnt vmcnt(7)
    s_barrier
    s_cmp_eq_u32 s45, 0
    s_cbranch_scc1 GA_noar
    s_sub_u32 s46, s20, 2
    s_cmp_lg_u32 s17, 0
    s_cbranch_scc1 AR_14
    s_lshl_b32 s41, s46, 11
    s_add_u32 s41, s41, 15270016
    v_mov_b32 v252, 1
    s_mov_b64 exec, 1
    buffer_atomic_add v252, v251, s[4:7], s41 offen
    s_mov_b64 exec, -1
AR_14:
GA_noar:
    v_mfma_f32_32x32x16_bf16 v[16:31], a[56:59], v[56:59], v[16:31]
    v_mfma_f32_32x32x16_bf16 v[32:47], a[168:171], v[56:59], v[32:47]
    ds_read_b128 v[56:59], v11 offset:20480
    s_waitcnt lgkmcnt(5)
    v_mfma_f32_32x32x16_bf16 v[16:31], a[60:63], v[60:63], v[16:31]
    v_mfma_f32_32x32x16_bf16 v[32:47], a[172:175], v[60:63], v[32:47]
    ds_read_b128 v[60:63], v11 offset:21504
    s_waitcnt lgkmcnt(5)
    v_mfma_f32_32x32x16_bf16 v[16:31], a[64:67], v[64:67], v[16:31]
    v_mfma_f32_32x32x16_bf16 v[32:47], a[176:179], v[64:67], v[32:47]
    ds_read_b128 v[64:67], v11 offset:22528
    s_waitcnt lgkmcnt(5)
    v_mfma_f32_32x32x16_bf16 v[16:31], a[68:71], v[68:71], v[16:31]
    v_mfma_f32_32x32x16_bf16 v[32:47], a[180:183], v[68:71], v[32:47]
    ds_read_b128 v[68:71], v11 offset:23552
    s_waitcnt lgkmcnt(5)
    v_mfma_f32_32x32x16_bf16 v[16:31], a[72:75], v[48:51], v[16:31]
    v_mfma_f32_32x32x16_bf16 v[32:47], a[184:187], v[48:51], v[32:47]
    ds_read_b128 v[48:51], v11 offset:24576
    s_waitcnt lgkmcnt(5)
    v_mfma_f32_32x32x16_bf16 v[16:31], a[76:79], v[52:55], v[16:31]
    v_mfma_f32_32x32x16_bf16 v[32:47], a[188:191], v[52:55], v[32:47]
    ds_read_b128 v[52:55], v11 offset:25600
    s_waitcnt lgkmcnt(5)
    v_mfma_f32_32x32x16_bf16 v[16:31], a[80:83], v[56:59], v[16:31]
    v_mfma_f32_32x32x16_bf16 v[32:47], a[192:195], v[56:59], v[32:47]
    ds_read_b128 v[56:59], v11 offset:26624
    s_waitcnt lgkmcnt(5)
    v_mfma_f32_32x32x16_bf16 v[16:31], a[84:87], v[60:63], v[16:31]
    v_mfma_f32_32x32x16_bf16 v[32:47], a[196:199], v[60:63], v[32:47]
    ds_read_b128 v[60:63], v11 offset:27648
    s_waitcnt lgkmcnt(5)
    v_mfma_f32_32x32x16_bf16 v[16:31], a[88:91], v[64:67], v[16:31]
    v_mfma_f32_32x32x16_bf16 v[32:47], a[200:203], v[64:67], v[32:47]
    s_waitcnt lgkmcnt(4)
    v_mfma_f32_32x32x16_bf16 v[16:31], a[92:95], v[68:71], v[16:31]
    v_mfma_f32_32x32x16_bf16 v[32:47], a[204:207], v[68:71], v[32:47]
    s_waitcnt lgkmcnt(3)
    v_mfma_f32_32x32x16_bf16 v[16:31], a[96:99], v[48:51], v[16:31]
    v_mfma_f32_32x32x16_bf16 v[32:47], a[208:211], v[48:51], v[32:47]
    s_waitcnt lgkmcnt(2)
    v_mfma_f32_32x32x16_bf16 v[16:31], a[100:103], v[52:55], v[16:31]
    v_mfma_f32_32x32x16_bf16 v[32:47], a[212:215], v[52:55], v[32:47]
    s_waitcnt lgkmcnt(1)
    v_mfma_f32_32x32x16_bf16 v[16:31], a[104:107], v[56:59], v[16:31]
    v_mfma_f32_32x32x16_bf16 v[32:47], a[216:219], v[56:59], v[32:47]
    s_waitcnt lgkmcnt(0)
    v_mfma_f32_32x32x16_bf16 v[16:31], a[108:111], v[60:63], v[16:31]
    v_mfma_f32_32x32x16_bf16 v[32:47], a[220:223], v[60:63], v[32:47]
    v_xor_b32 v11, 0x8000, v11
    s_nop 10
    v_cvt_pk_bf16_f32 v72, v16, v17
    v_cvt_pk_bf16_f32 v73, v18, v19
    v_cvt_pk_bf16_f32 v74, v20, v21
    v_cvt_pk_bf16_f32 v75, v22, v23
    buffer_store_dwordx4 v[72:75], v8, s[4:7], s42 offen offset:0 sc1
    v_cvt_pk_bf16_f32 v76, v24, v25
    v_cvt_pk_bf16_f32 v77, v26, v27
    v_cvt_pk_bf16_f32 v78, v28, v29
    v_cvt_pk_bf16_f32 v79, v30, v31
    buffer_store_dwordx4 v[76:79], v8, s[4:7], s42 offen offset:1024 sc1
    v_cvt_pk_bf16_f32 v80, v32, v33
    v_cvt_pk_bf16_f32 v81, v34, v35
    v_cvt_pk_bf16_f32 v82, v36, v37
    v_cvt_pk_bf16_f32 v83, v38, v39
    buffer_store_dwordx4 v[80:83], v8, s[4:7], s42 offen offset:2048 sc1
    v_cvt_pk_bf16_f32 v84, v40, v41
    v_cvt_pk_bf16_f32 v85, v42, v43
    v_cvt_pk_bf16_f32 v86, v44, v45
    v_cvt_pk_bf16_f32 v87, v46, v47
    buffer_store_dwordx4 v[84:87], v8, s[4:7], s42 offen offset:3072 sc1
    s_add_u32 s42, s42, 917504
    s_add_u32 s45, s45, 1
    s_add_u32 s20, s20, 2
    s_cmp_lt_u32 s20, 64
    s_cbranch_scc1 GA_loop
    s_waitcnt vmcnt(0)
    s_barrier
    s_sub_u32 s46, s20, 2
    s_cmp_lg_u32 s17, 0
    s_cbranch_scc1 AR_15
    s_lshl_b32 s41, s46, 11
    s_add_u32 s41, s41, 15270016
    v_mov_b32 v252, 1
    s_mov_b64 exec, 1
    buffer_atomic_add v252, v251, s[4:7], s41 offen
    s_mov_b64 exec, -1
AR_15:
    s_branch L_next_free
GH_entry:
    v_mbcnt_lo_u32_b32 v0, -1, 0
    v_mbcnt_hi_u32_b32 v0, -1, v0
    v_lshlrev_b32 v250, 4, v0
    v_mov_b32 v251, 0
    v_lshrrev_b32 v1, 5, v0
    v_and_b32 v2, 31, v0
    v_and_b32 v3, 15, v0
    v_lshrrev_b32 v4, 4, v0
    s_cmp_lg_u32 s17, 0
    s_cbranch_scc1 WT_16_ok
    v_mov_b32 v253, 192
WT_16:
    buffer_load_dword v252, v253, s[12:15], 0 offen sc1
    s_waitcnt vmcnt(0)
    v_cmp_eq_u32 vcc, 0, v252
    s_cbranch_vccz WT_16_ok
    s_sleep 32
    s_sub_u32 s35, s35, 1
    s_cmp_lg_u32 s35, 0
    s_cbranch_scc1 WT_16
    s_endpgm
WT_16_ok:
    s_barrier
    s_mov_b32 s8, s66
    s_mov_b32 s9, s67
    s_mov_b32 s10, 1605632
    s_mov_b32 s11, 0x00020000
    s_and_b32 s20, s16, 1
    s_lshr_b32 s36, s16, 1
    s_lshl_b32 s36, s36, 2
    s_add_u32 s36, s36, s17
    s_lshl_b32 s39, s36, 7
    s_lshl_b32 s42, s36, 12
    s_mul_i32 s40, s20, 114688
    s_add_u32 s42, s42, s40
    s_add_u32 s42, s42, 100663296
    v_lshrrev_b32 v5, 3, v0
    v_mul_u32_u24 v5, 3584, v5
    v_and_b32 v6, 7, v0
    v_lshl_add_u32 v5, v6, 4, v5
    v_bfe_u32 v6, v0, 2, 2
    v_lshl_add_u32 v6, v1, 3, v6
    v_lshlrev_b32 v6, 7, v6
    v_bfe_u32 v7, v0, 4, 1
    v_lshl_add_u32 v6, v7, 5, v6
    v_lshl_add_u32 v8, v7, 10, 0
    v_and_b32 v7, 1, v0
    v_lshl_add_u32 v6, v7, 4, v6
    v_bfe_u32 v7, v0, 1, 1
    v_lshl_add_u32 v6, v7, 3, v6
    s_mul_i32 s40, s17, 14336
    v_add_u32 v6, s40, v6
    v_lshl_add_u32 v8, v1, 8, v8
    v_lshl_add_u32 v8, v3, 4, v8
    v_lshlrev_b32 v10, 2, v2
    s_add_u32 m0, s40, 0
    s_nop 0
    buffer_load_dwordx4 v5, s[8:11], s39 offen lds
    s_add_u32 s39, s39, 28672
    s_add_u32 m0, s40, 1024
    s_nop 0
    buffer_load_dwordx4 v5, s[8:11], s39 offen lds
    s_add_u32 s39, s39, 28672
    s_add_u32 m0, s40, 2048
    s_nop 0
    buffer_load_dwordx4 v5, s[8:11], s39 offen lds
    s_add_u32 s39, s39, 28672
    s_add_u32 m0, s40, 3072
    s_nop 0
    buffer_load_dwordx4 v5, s[8:11], s39 offen lds
    s_add_u32 s39, s39, 28672
    s_add_u32 m0, s40, 4096
    s_nop 0
    buffer_load_dwordx4 v5, s[8:11], s39 offen lds
    s_add_u32 s39, s39, 28672
    s_add_u32 m0, s40, 5120
    s_nop 0
    buffer_load_dwordx4 v5, s[8:11], s39 offen lds
    s_add_u32 s39, s39, 28672
    s_add_u32 m0, s40, 6144
    s_nop 0
    buffer_load_dwordx4 v5, s[8:11], s39 offen lds
    s_add_u32 s39, s39, 28672
    s_add_u32 m0, s40, 7168
    s_nop 0
    buffer_load_dwordx4 v5, s[8:11], s39 offen lds
    s_add_u32 s39, s39, 28672
    s_add_u32 m0, s40, 8192
    s_nop 0
    buffer_load_dwordx4 v5, s[8:11], s39 offen lds
    s_add_u32 s39, s39, 28672
    s_add_u32 m0, s40, 9216
    s_nop 0
    buffer_load_dwordx4 v5, s[8:11], s39 offen lds
    s_add_u32 s39, s39, 28672
    s_add_u32 m0, s40, 10240
    s_nop 0
    buffer_load_dwordx4 v5, s[8:11], s39 offen lds
    s_add_u32 s39, s39, 28672
    s_add_u32 m0, s40, 11264
    s_nop 0
    buffer_load_dwordx4 v5, s[8:11], s39 offen lds
    s_add_u32 s39, s39, 28672
    s_add_u32 m0, s40, 12288
    s_nop 0
    buffer_load_dwordx4 v5, s[8:11], s39 offen lds
    s_add_u32 s39, s39, 28672
    s_add_u32 m0, s40, 13312
    s_nop 0
    buffer_load_dwordx4 v5, s[8:11], s39 offen lds
    s_add_u32 s39, s39, 28672
    s_waitcnt vmcnt(0)
    ds_read_b64_tr_b16 a[0:1], v6 offset:0
    ds_read_b64_tr_b16 a[2:3], v6 offset:512
    ds_read_b64_tr_b16 a[4:5], v6 offset:2048
    ds_read_b64_tr_b16 a[6:7], v6 offset:2560
    ds_read_b64_tr_b16 a[8:9], v6 offset:4096
    ds_read_b64_tr_b16 a[10:11], v6 offset:4608
    ds_read_b64_tr_b16 a[12:13], v6 offset:6144
    ds_read_b64_tr_b16 a[14:15], v6 offset:6656
    ds_read_b64_tr_b16 a[16:17], v6 offset:8192
    ds_read_b64_tr_b16 a[18:19], v6 offset:8704
    ds_read_b64_tr_b16 a[20:21], v6 offset:10240
    ds_read_b64_tr_b16 a[22:23], v6 offset:10752
    ds_read_b64_tr_b16 a[24:25], v6 offset:12288
    ds_read_b64_tr_b16 a[26:27], v6 offset:12800
    ds_read_b64_tr_b16 a[112:113], v6 offset:64
    ds_read_b64_tr_b16 a[114:115], v6 offset:576
    ds_read_b64_tr_b16 a[116:117], v6 offset:2112
    ds_read_b64_tr_b16 a[118:119], v6 offset:2624
    ds_read_b64_tr_b16 a[120:121], v6 offset:4160
    ds_read_b64_tr_b16 a[122:123], v6 offset:4672
    ds_read_b64_tr_b16 a[124:125], v6 offset:6208
    ds_read_b64_tr_b16 a[126:127], v6 offset:6720
    ds_read_b64_tr_b16 a[128:129], v6 offset:8256
    ds_read_b64_tr_b16 a[130:131], v6 offset:8768
    ds_read_b64_tr_b16 a[132:133], v6 offset:10304
    ds_read_b64_tr_b16 a[134:135], v6 offset:10816
    ds_read_b64_tr_b16 a[136:137], v6 offset:12352
    ds_read_b64_tr_b16 a[138:139], v6 offset:12864
    s_waitcnt lgkmcnt(0)
    s_add_u32 m0, s40, 0
    s_nop 0
    buffer_load_dwordx4 v5, s[8:11], s39 offen lds
    s_add_u32 s39, s39, 28672
    s_add_u32 m0, s40, 1024
    s_nop 0
    buffer_load_dwordx4 v5, s[8:11], s39 offen lds
    s_add_u32 s39, s39, 28672
    s_add_u32 m0, s40, 2048
    s_nop 0
    buffer_load_dwordx4 v5, s[8:11], s39 offen lds
    s_add_u32 s39, s39, 28672
    s_add_u32 m0, s40, 3072
    s_nop 0
    buffer_load_dwordx4 v5, s[8:11], s39 offen lds
    s_add_u32 s39, s39, 28672
    s_add_u32 m0, s40, 4096
    s_nop 0
    buffer_load_dwordx4 v5, s[8:11], s39 offen lds
    s_add_u32 s39, s39, 28672
    s_add_u32 m0, s40, 5120
    s_nop 0
    buffer_load_dwordx4 v5, s[8:11], s39 offen lds
    s_add_u32 s39, s39, 28672
    s_add_u32 m0, s40, 6144
    s_nop 0
    buffer_load_dwordx4 v5, s[8:11], s39 offen lds
    s_add_u32 s39, s39, 28672
    s_add_u32 m0, s40, 7168
    s_nop 0
    buffer_load_dwordx4 v5, s[8:11], s39 offen lds
    s_add_u32 s39, s39, 28672
    s_add_u32 m0, s40, 8192
    s_nop 0
    buffer_load_dwordx4 v5, s[8:11], s39 offen lds
    s_add_u32 s39, s39, 28672
    s_add_u32 m0, s40, 9216
    s_nop 0
    buffer_load_dwordx4 v5, s[8:11], s39 offen lds
    s_add_u32 s39, s39, 28672
    s_add_u32 m0, s40, 10240
    s_nop 0
    buffer_load_dwordx4 v5, s[8:11], s39 offen lds
    s_add_u32 s39, s39, 28672
    s_add_u32 m0, s40, 11264
    s_nop 0
    buffer_load_dwordx4 v5, s[8:11], s39 offen lds
    s_add_u32 s39, s39, 28672
    s_add_u32 m0, s40, 12288
    s_nop 0
    buffer_load_dwordx4 v5, s[8:11], s39 offen lds
    s_add_u32 s39, s39, 28672
    s_add_u32 m0, s40, 13312
    s_nop 0
    buffer_load_dwordx4 v5, s[8:11], s39 offen lds
    s_add_u32 s39, s39, 28672
    s_waitcnt vmcnt(0)
    ds_read_b64_tr_b16 a[28:29], v6 offset:0
    ds_read_b64_tr_b16 a[30:31], v6 offset:512
    ds_read_b64_tr_b16 a[32:33], v6 offset:2048
    ds_read_b64_tr_b16 a[34:35], v6 offset:2560
    ds_read_b64_tr_b16 a[36:37], v6 offset:4096
    ds_read_b64_tr_b16 a[38:39], v6 offset:4608
    ds_read_b64_tr_b16 a[40:41], v6 offset:6144
    ds_read_b64_tr_b16 a[42:43], v6 offset:6656
    ds_read_b64_tr_b16 a[44:45], v6 offset:8192
    ds_read_b64_tr_b16 a[46:47], v6 offset:8704
    ds_read_b64_tr_b16 a[48:49], v6 offset:10240
    ds_read_b64_tr_b16 a[50:51], v6 offset:10752
    ds_read_b64_tr_b16 a[52:53], v6 offset:12288
    ds_read_b64_tr_b16 a[54:55], v6 offset:12800
    ds_read_b64_tr_b16 a[140:141], v6 offset:64
    ds_read_b64_tr_b16 a[142:143], v6 offset:576
    ds_read_b64_tr_b16 a[144:145], v6 offset:2112
    ds_read_b64_tr_b16 a[146:147], v6 offset:2624
    ds_read_b64_tr_b16 a[148:149], v6 offset:4160
    ds_read_b64_tr_b16 a[150:151], v6 offset:4672
    ds_read_b64_tr_b16 a[152:153], v6 offset:6208
    ds_read_b64_tr_b16 a[154:155], v6 offset:6720
    ds_read_b64_tr_b16 a[156:157], v6 offset:8256
    ds_read_b64_tr_b16 a[158:159], v6 offset:8768
    ds_read_b64_tr_b16 a[160:161], v6 offset:10304
    ds_read_b64_tr_b16 a[162:163], v6 offset:10816
    ds_read_b64_tr_b16 a[164:165], v6 offset:12352
    ds_read_b64_tr_b16 a[166:167], v6 offset:12864
    s_waitcnt lgkmcnt(0)
    s_add_u32 m0, s40, 0
    s_nop 0
    buffer_load_dwordx4 v5, s[8:11], s39 offen lds
    s_add_u32 s39, s39, 28672
    s_add_u32 m0, s40, 1024
    s_nop 0
    buffer_load_dwordx4 v5, s[8:11], s39 offen lds
    s_add_u32 s39, s39, 28672
    s_add_u32 m0, s40, 2048
    s_nop 0
    buffer_load_dwordx4 v5, s[8:11], s39 offen lds
    s_add_u32 s39, s39, 28672
    s_add_u32 m0, s40, 3072
    s_nop 0
    buffer_load_dwordx4 v5, s[8:11], s39 offen lds
    s_add_u32 s39, s39, 28672
    s_add_u32 m0, s40, 4096
    s_nop 0
    buffer_load_dwordx4 v5, s[8:11], s39 offen lds
    s_add_u32 s39, s39, 28672
    s_add_u32 m0, s40, 5120
    s_nop 0
    buffer_load_dwordx4 v5, s[8:11], s39 offen lds
    s_add_u32 s39, s39, 28672
    s_add_u32 m0, s40, 6144
    s_nop 0
    buffer_load_dwordx4 v5, s[8:11], s39 offen lds
    s_add_u32 s39, s39, 28672
    s_add_u32 m0, s40, 7168
    s_nop 0
    buffer_load_dwordx4 v5, s[8:11], s39 offen lds
    s_add_u32 s39, s39, 28672
    s_add_u32 m0, s40, 8192
    s_nop 0
    buffer_load_dwordx4 v5, s[8:11], s39 offen lds
    s_add_u32 s39, s39, 28672
    s_add_u32 m0, s40, 9216
    s_nop 0
    buffer_load_dwordx4 v5, s[8:11], s39 offen lds
    s_add_u32 s39, s39, 28672
    s_add_u32 m0, s40, 10240
    s_nop 0
    buffer_load_dwordx4 v5, s[8:11], s39 offen lds
    s_add_u32 s39, s39, 28672
    s_add_u32 m0, s40, 11264
    s_nop 0
    buffer_load_dwordx4 v5, s[8:11], s39 offen lds
    s_add_u32 s39, s39, 28672
    s_add_u32 m0, s40, 12288
    s_nop 0
    buffer_load_dwordx4 v5, s[8:11], s39 offen lds
    s_add_u32 s39, s39, 28672
    s_add_u32 m0, s40, 13312
    s_nop 0
    buffer_load_dwordx4 v5, s[8:11], s39 offen lds
    s_add_u32 s39, s39, 28672
    s_waitcnt vmcnt(0)
    ds_read_b64_tr_b16 a[56:57], v6 offset:0
    ds_read_b64_tr_b16 a[58:59], v6 offset:512
    ds_read_b64_tr_b16 a[60:61], v6 offset:2048
    ds_read_b64_tr_b16 a[62:63], v6 offset:2560
    ds_read_b64_tr_b16 a[64:65], v6 offset:4096
    ds_read_b64_tr_b16 a[66:67], v6 offset:4608
    ds_read_b64_tr_b16 a[68:69], v6 offset:6144
    ds_read_b64_tr_b16 a[70:71], v6 offset:6656
    ds_read_b64_tr_b16 a[72:73], v6 offset:8192
    ds_read_b64_tr_b16 a[74:75], v6 offset:8704
    ds_read_b64_tr_b16 a[76:77], v6 offset:10240
    ds_read_b64_tr_b16 a[78:79], v6 offset:10752
    ds_read_b64_tr_b16 a[80:81], v6 offset:12288
    ds_read_b64_tr_b16 a[82:83], v6 offset:12800
    ds_read_b64_tr_b16 a[168:169], v6 offset:64
    ds_read_b64_tr_b16 a[170:171], v6 offset:576
    ds_read_b64_tr_b16 a[172:173], v6 offset:2112
    ds_read_b64_tr_b16 a[174:175], v6 offset:2624
    ds_read_b64_tr_b16 a[176:177], v6 offset:4160
    ds_read_b64_tr_b16 a[178:179], v6 offset:4672
    ds_read_b64_tr_b16 a[180:181], v6 offset:6208
    ds_read_b64_tr_b16 a[182:183], v6 offset:6720
    ds_read_b64_tr_b16 a[184:185], v6 offset:8256
    ds_read_b64_tr_b16 a[186:187], v6 offset:8768
    ds_read_b64_tr_b16 a[188:189], v6 offset:10304
    ds_read_b64_tr_b16 a[190:191], v6 offset:10816
    ds_read_b64_tr_b16 a[192:193], v6 offset:12352
    ds_read_b64_tr_b16 a[194:195], v6 offset:12864
    s_waitcnt lgkmcnt(0)
    s_add_u32 m0, s40, 0
    s_nop 0
    buffer_load_dwordx4 v5, s[8:11], s39 offen lds
    s_add_u32 s39, s39, 28672
    s_add_u32 m0, s40, 1024
    s_nop 0
    buffer_load_dwordx4 v5, s[8:11], s39 offen lds
    s_add_u32 s39, s39, 28672
    s_add_u32 m0, s40, 2048
    s_nop 0
    buffer_load_dwordx4 v5, s[8:11], s39 offen lds
    s_add_u32 s39, s39, 28672
    s_add_u32 m0, s40, 3072
    s_nop 0
    buffer_load_dwordx4 v5, s[8:11], s39 offen lds
    s_add_u32 s39, s39, 28672
    s_add_u32 m0, s40, 4096
    s_nop 0
    buffer_load_dwordx4 v5, s[8:11], s39 offen lds
    s_add_u32 s39, s39, 28672
    s_add_u32 m0, s40, 5120
    s_nop 0
    buffer_load_dwordx4 v5, s[8:11], s39 offen lds
    s_add_u32 s39, s39, 28672
    s_add_u32 m0, s40, 6144
    s_nop 0
    buffer_load_dwordx4 v5, s[8:11], s39 offen lds
    s_add_u32 s39, s39, 28672
    s_add_u32 m0, s40, 7168
    s_nop 0
    buffer_load_dwordx4 v5, s[8:11], s39 offen lds
    s_add_u32 s39, s39, 28672
    s_add_u32 m0, s40, 8192
    s_nop 0
    buffer_load_dwordx4 v5, s[8:11], s39 offen lds
    s_add_u32 s39, s39, 28672
    s_add_u32 m0, s40, 9216
    s_nop 0
    buffer_load_dwordx4 v5, s[8:11], s39 offen lds
    s_add_u32 s39, s39, 28672
    s_add_u32 m0, s40, 10240
    s_nop 0
    buffer_load_dwordx4 v5, s[8:11], s39 offen lds
    s_add_u32 s39, s39, 28672
    s_add_u32 m0, s40, 11264
    s_nop 0
    buffer_load_dwordx4 v5, s[8:11], s39 offen lds
    s_add_u32 s39, s39, 28672
    s_add_u32 m0, s40, 12288
    s_nop 0
    buffer_load_dwordx4 v5, s[8:11], s39 offen lds
    s_add_u32 s39, s39, 28672
    s_add_u32 m0, s40, 13312
    s_nop 0
    buffer_load_dwordx4 v5, s[8:11], s39 offen lds
    s_add_u32 s39, s39, 28672
    s_waitcnt vmcnt(0)
    ds_read_b64_tr_b16 a[84:85], v6 offset:0
    ds_read_b64_tr_b16 a[86:87], v6 offset:512
    ds_read_b64_tr_b16 a[88:89], v6 offset:2048
    ds_read_b64_tr_b16 a[90:91], v6 offset:2560
    ds_read_b64_tr_b16 a[92:93], v6 offset:4096
    ds_read_b64_tr_b16 a[94:95], v6 offset:4608
    ds_read_b64_tr_b16 a[96:97], v6 offset:6144
    ds_read_b64_tr_b16 a[98:99], v6 offset:6656
    ds_read_b64_tr_b16 a[100:101], v6 offset:8192
    ds_read_b64_tr_b16 a[102:103], v6 offset:8704
    ds_read_b64_tr_b16 a[104:105], v6 offset:10240
    ds_read_b64_tr_b16 a[106:107], v6 offset:10752
    ds_read_b64_tr_b16 a[108:109], v6 offset:12288
    ds_read_b64_tr_b16 a[110:111], v6 offset:12800
    ds_read_b64_tr_b16 a[196:197], v6 offset:64
    ds_read_b64_tr_b16 a[198:199], v6 offset:576
    ds_read_b64_tr_b16 a[200:201], v6 offset:2112
    ds_read_b64_tr_b16 a[202:203], v6 offset:2624
    ds_read_b64_tr_b16 a[204:205], v6 offset:4160
    ds_read_b64_tr_b16 a[206:207], v6 offset:4672
    ds_read_b64_tr_b16 a[208:209], v6 offset:6208
    ds_read_b64_tr_b16 a[210:211], v6 offset:6720
    ds_read_b64_tr_b16 a[212:213], v6 offset:8256
    ds_read_b64_tr_b16 a[214:215], v6 offset:8768
    ds_read_b64_tr_b16 a[216:217], v6 offset:10304
    ds_read_b64_tr_b16 a[218:219], v6 offset:10816
    ds_read_b64_tr_b16 a[220:221], v6 offset:12352
    ds_read_b64_tr_b16 a[222:223], v6 offset:12864
    s_waitcnt lgkmcnt(0)
    s_barrier
    s_mul_i32 s43, s17, 7168
    s_mul_i32 s44, s20, 28672
    s_add_u32 s44, s44, s43
    s_add_u32 s44, s44, 27262976
    v_mov_b32 v11, v250
    s_mov_b32 s45, 0
    s_cmp_lg_u32 s17, 0
    s_cbranch_scc1 WW_17
    v_mbcnt_lo_u32_b32 v253, -1, 0
    v_and_b32 v253, 1, v253
    v_lshlrev_b32 v253, 7, v253
    s_mov_b32 s41, 15238144
    s_mov_b64 exec, 3
WD_18:
    buffer_load_dword v252, v253, s[4:7], s41 offen sc1
    s_waitcnt vmcnt(0)
    v_cmp_gt_u32 vcc, 0x40, v252
    s_cbranch_vccz WD_18_ok
    s_sleep 4
    s_sub_u32 s35, s35, 1
    s_cmp_lg_u32 s35, 0
    s_cbranch_scc1 WD_18
    s_branch L_exit
WD_18_ok:
    s_mov_b64 exec, -1
WW_17:
    s_barrier
    s_add_u32 m0, s43, 0
    s_add_u32 s40, s44, 0
    buffer_load_dwordx4 v250, s[4:7], s40 offen offset:0 sc1 lds
    buffer_load_dwordx4 v250, s[4:7], s40 offen offset:1024 sc1 lds
    buffer_load_dwordx4 v250, s[4:7], s40 offen offset:2048 sc1 lds
    buffer_load_dwordx4 v250, s[4:7], s40 offen offset:3072 sc1 lds
    s_add_u32 m0, s43, 4096
    s_add_u32 s40, s44, 4096
    buffer_load_dwordx4 v250, s[4:7], s40 offen offset:0 sc1 lds
    buffer_load_dwordx4 v250, s[4:7], s40 offen offset:1024 sc1 lds
    buffer_load_dwordx4 v250, s[4:7], s40 offen offset:2048 sc1 lds
    s_xor_b32 s43, s43, 0x8000
    s_add_u32 s44, s44, 57344
    s_waitcnt vmcnt(0)
GH_loop:
    s_waitcnt vmcnt(4)
    s_barrier
    s_lshl_b32 s40, s20, 7
    s_add_u32 s40, s40, 15400960
    buffer_load_dword v9, v10, s[4:7], s40 offen sc1
    s_add_u32 m0, s43, 0
    s_add_u32 s40, s44, 0
    buffer_load_dwordx4 v250, s[4:7], s40 offen offset:0 sc1 lds
    buffer_load_dwordx4 v250, s[4:7], s40 offen offset:1024 sc1 lds
    buffer_load_dwordx4 v250, s[4:7], s40 offen offset:2048 sc1 lds
    buffer_load_dwordx4 v250, s[4:7], s40 offen offset:3072 sc1 lds
    s_add_u32 m0, s43, 4096
    s_add_u32 s40, s44, 4096
    buffer_load_dwordx4 v250, s[4:7], s40 offen offset:0 sc1 lds
    buffer_load_dwordx4 v250, s[4:7], s40 offen offset:1024 sc1 lds
    buffer_load_dwordx4 v250, s[4:7], s40 offen offset:2048 sc1 lds
    s_xor_b32 s43, s43, 0x8000
    s_add_u32 s44, s44, 57344
    ds_read_b128 v[48:51], v11 offset:0
    ds_read_b128 v[52:55], v11 offset:1024
    ds_read_b128 v[56:59], v11 offset:2048
    ds_read_b128 v[60:63], v11 offset:3072
    ds_read_b128 v[64:67], v11 offset:4096
    ds_read_b128 v[68:71], v11 offset:5120
    s_waitcnt lgkmcnt(5)
    v_mfma_f32_32x32x16_bf16 v[16:31], a[0:3], v[48:51], 0
    v_mfma_f32_32x32x16_bf16 v[32:47], a[112:115], v[48:51], 0
    ds_read_b128 v[48:51], v11 offset:6144
    s_waitcnt lgkmcnt(5)
    v_mfma_f32_32x32x16_bf16 v[16:31], a[4:7], v[52:55], v[16:31]
    v_mfma_f32_32x32x16_bf16 v[32:47], a[116:119], v[52:55], v[32:47]
    ds_read_b128 v[52:55], v11 offset:7168
    s_waitcnt lgkmcnt(5)
    v_mfma_f32_32x32x16_bf16 v[16:31], a[8:11], v[56:59], v[16:31]
    v_mfma_f32_32x32x16_bf16 v[32:47], a[120:123], v[56:59], v[32:47]
    ds_read_b128 v[56:59], v11 offset:8192
    s_waitcnt lgkmcnt(5)
    v_mfma_f32_32x32x16_bf16 v[16:31], a[12:15], v[60:63], v[16:31]
    v_mfma_f32_32x32x16_bf16 v[32:47], a[124:127], v[60:63], v[32:47]
    ds_read_b128 v[60:63], v11 offset:9216
    s_waitcnt lgkmcnt(5)
    v_mfma_f32_32x32x16_bf16 v[16:31], a[16:19], v[64:67], v[16:31]
    v_mfma_f32_32x32x16_bf16 v[32:47], a[128:131], v[64:67], v[32:47]
    ds_read_b128 v[64:67], v11 offset:10240
    s_waitcnt lgkmcnt(5)
    v_mfma_f32_32x32x16_bf16 v[16:31], a[20:23], v[68:71], v[16:31]
    v_mfma_f32_32x32x16_bf16 v[32:47], a[132:135], v[68:71], v[32:47]
    ds_read_b128 v[68:71], v11 offset:11264
    s_waitcnt lgkmcnt(5)
    v_mfma_f32_32x32x16_bf16 v[16:31], a[24:27], v[48:51], v[16:31]
    v_mfma_f32_32x32x16_bf16 v[32:47], a[136:139], v[48:51], v[32:47]
    ds_read_b128 v[48:51], v11 offset:12288
    s_waitcnt lgkmcnt(5)
    v_mfma_f32_32x32x16_bf16 v[16:31], a[28:31], v[52:55], v[16:31]
    v_mfma_f32_32x32x16_bf16 v[32:47], a[140:143], v[52:55], v[32:47]
    ds_read_b128 v[52:55], v11 offset:13312
    s_waitcnt lgkmcnt(5)
    v_mfma_f32_32x32x16_bf16 v[16:31], a[32:35], v[56:59], v[16:31]
    v_mfma_f32_32x32x16_bf16 v[32:47], a[144:147], v[56:59], v[32:47]
    ds_read_b128 v[56:59], v11 offset:14336
    s_waitcnt lgkmcnt(5)
    v_mfma_f32_32x32x16_bf16 v[16:31], a[36:39], v[60:63], v[16:31]
    v_mfma_f32_32x32x16_bf16 v[32:47], a[148:151], v[60:63], v[32:47]
    ds_read_b128 v[60:63], v11 offset:15360
    s_waitcnt lgkmcnt(5)
    v_mfma_f32_32x32x16_bf16 v[16:31], a[40:43], v[64:67], v[16:31]
    v_mfma_f32_32x32x16_bf16 v[32:47], a[152:155], v[64:67], v[32:47]
    ds_read_b128 v[64:67], v11 offset:16384
    s_waitcnt lgkmcnt(5)
    v_mfma_f32_32x32x16_bf16 v[16:31], a[44:47], v[68:71], v[16:31]
    v_mfma_f32_32x32x16_bf16 v[32:47], a[156:159], v[68:71], v[32:47]
    ds_read_b128 v[68:71], v11 offset:17408
    s_waitcnt lgkmcnt(5)
    v_mfma_f32_32x32x16_bf16 v[16:31], a[48:51], v[48:51], v[16:31]
    v_mfma_f32_32x32x16_bf16 v[32:47], a[160:163], v[48:51], v[32:47]
    ds_read_b128 v[48:51], v11 offset:18432
    s_waitcnt lgkmcnt(5)
    v_mfma_f32_32x32x16_bf16 v[16:31], a[52:55], v[52:55], v[16:31]
    v_mfma_f32_32x32x16_bf16 v[32:47], a[164:167], v[52:55], v[32:47]
    ds_read_b128 v[52:55], v11 offset:19456
    s_waitcnt lgkmcnt(5)
    s_waitcnt vmcnt(8)
    s_barrier
    s_cmp_eq_u32 s45, 0
    s_cbranch_scc1 GH_noar
    s_sub_u32 s46, s20, 2
    s_cmp_lg_u32 s17, 0
    s_cbranch_scc1 AR_19
    s_lshl_b32 s41, s46, 11
    s_add_u32 s41, s41, 15270144
    v_mov_b32 v252, 1
    s_mov_b64 exec, 1
    buffer_atomic_add v252, v251, s[4:7], s41 offen
    s_mov_b64 exec, -1
AR_19:
GH_noar:
    v_mfma_f32_32x32x16_bf16 v[16:31], a[56:59], v[56:59], v[16:31]
    v_mfma_f32_32x32x16_bf16 v[32:47], a[168:171], v[56:59], v[32:47]
    ds_read_b128 v[56:59], v11 offset:20480
    s_waitcnt lgkmcnt(5)
    v_mfma_f32_32x32x16_bf16 v[16:31], a[60:63], v[60:63], v[16:31]
    v_mfma_f32_32x32x16_bf16 v[32:47], a[172:175], v[60:63], v[32:47]
    ds_read_b128 v[60:63], v11 offset:21504
    s_waitcnt lgkmcnt(5)
    v_mfma_f32_32x32x16_bf16 v[16:31], a[64:67], v[64:67], v[16:31]
    v_mfma_f32_32x32x16_bf16 v[32:47], a[176:179], v[64:67], v[32:47]
    ds_read_b128 v[64:67], v11 offset:22528
    s_waitcnt lgkmcnt(5)
    v_mfma_f32_32x32x16_bf16 v[16:31], a[68:71], v[68:71], v[16:31]
    v_mfma_f32_32x32x16_bf16 v[32:47], a[180:183], v[68:71], v[32:47]
    ds_read_b128 v[68:71], v11 offset:23552
    s_waitcnt lgkmcnt(5)
    v_mfma_f32_32x32x16_bf16 v[16:31], a[72:75], v[48:51], v[16:31]
    v_mfma_f32_32x32x16_bf16 v[32:47], a[184:187], v[48:51], v[32:47]
    ds_read_b128 v[48:51], v11 offset:24576
    s_waitcnt lgkmcnt(5)
    v_mfma_f32_32x32x16_bf16 v[16:31], a[76:79], v[52:55], v[16:31]
    v_mfma_f32_32x32x16_bf16 v[32:47], a[188:191], v[52:55], v[32:47]
    ds_read_b128 v[52:55], v11 offset:25600
    s_waitcnt lgkmcnt(5)
    v_mfma_f32_32x32x16_bf16 v[16:31], a[80:83], v[56:59], v[16:31]
    v_mfma_f32_32x32x16_bf16 v[32:47], a[192:195], v[56:59], v[32:47]
    ds_read_b128 v[56:59], v11 offset:26624
    s_waitcnt lgkmcnt(5)
    v_mfma_f32_32x32x16_bf16 v[16:31], a[84:87], v[60:63], v[16:31]
    v_mfma_f32_32x32x16_bf16 v[32:47], a[196:199], v[60:63], v[32:47]
    ds_read_b128 v[60:63], v11 offset:27648
    s_waitcnt lgkmcnt(5)
    v_mfma_f32_32x32x16_bf16 v[16:31], a[88:91], v[64:67], v[16:31]
    v_mfma_f32_32x32x16_bf16 v[32:47], a[200:203], v[64:67], v[32:47]
    s_waitcnt lgkmcnt(4)
    v_mfma_f32_32x32x16_bf16 v[16:31], a[92:95], v[68:71], v[16:31]
    v_mfma_f32_32x32x16_bf16 v[32:47], a[204:207], v[68:71], v[32:47]
    s_waitcnt lgkmcnt(3)
    v_mfma_f32_32x32x16_bf16 v[16:31], a[96:99], v[48:51], v[16:31]
    v_mfma_f32_32x32x16_bf16 v[32:47], a[208:211], v[48:51], v[32:47]
    s_waitcnt lgkmcnt(2)
    v_mfma_f32_32x32x16_bf16 v[16:31], a[100:103], v[52:55], v[16:31]
    v_mfma_f32_32x32x16_bf16 v[32:47], a[212:215], v[52:55], v[32:47]
    s_waitcnt lgkmcnt(1)
    v_mfma_f32_32x32x16_bf16 v[16:31], a[104:107], v[56:59], v[16:31]
    v_mfma_f32_32x32x16_bf16 v[32:47], a[216:219], v[56:59], v[32:47]
    s_waitcnt lgkmcnt(0)
    v_mfma_f32_32x32x16_bf16 v[16:31], a[108:111], v[60:63], v[16:31]
    v_mfma_f32_32x32x16_bf16 v[32:47], a[220:223], v[60:63], v[32:47]
    v_xor_b32 v11, 0x8000, v11
    s_waitcnt vmcnt(7)
    v_sub_f32 v9, 1.0, v9
    s_nop 10
    v_mul_f32 v88, 0xbfb8aa3b, v16
    v_mul_f32 v89, 0xbfb8aa3b, v17
    v_mul_f32 v90, 0xbfb8aa3b, v18
    v_mul_f32 v91, 0xbfb8aa3b, v19
    v_mul_f32 v92, 0xbfb8aa3b, v20
    v_mul_f32 v93, 0xbfb8aa3b, v21
    v_mul_f32 v94, 0xbfb8aa3b, v22
    v_mul_f32 v95, 0xbfb8aa3b, v23
    v_exp_f32 v88, v88
    v_exp_f32 v89, v89
    v_exp_f32 v90, v90
    v_exp_f32 v91, v91
    v_exp_f32 v92, v92
    v_exp_f32 v93, v93
    v_exp_f32 v94, v94
    v_exp_f32 v95, v95
    v_add_f32 v88, 1.0, v88
    v_mul_f32 v16, v9, v16
    v_add_f32 v89, 1.0, v89
    v_mul_f32 v17, v9, v17
    v_add_f32 v90, 1.0, v90
    v_mul_f32 v18, v9, v18
    v_add_f32 v91, 1.0, v91
    v_mul_f32 v19, v9, v19
    v_add_f32 v92, 1.0, v92
    v_mul_f32 v20, v9, v20
    v_add_f32 v93, 1.0, v93
    v_mul_f32 v21, v9, v21
    v_add_f32 v94, 1.0, v94
    v_mul_f32 v22, v9, v22
    v_add_f32 v95, 1.0, v95
    v_mul_f32 v23, v9, v23
    v_rcp_f32 v88, v88
    v_rcp_f32 v89, v89
    v_rcp_f32 v90, v90
    v_rcp_f32 v91, v91
    v_rcp_f32 v92, v92
    v_rcp_f32 v93, v93
    v_rcp_f32 v94, v94
    v_rcp_f32 v95, v95
    s_nop 0
    v_mul_f32 v16, v88, v16
    v_mul_f32 v17, v89, v17
    v_mul_f32 v18, v90, v18
    v_mul_f32 v19, v91, v19
    v_mul_f32 v20, v92, v20
    v_mul_f32 v21, v93, v21
    v_mul_f32 v22, v94, v22
    v_mul_f32 v23, v95, v23
    v_mul_f32 v88, 0xbfb8aa3b, v24
    v_mul_f32 v89, 0xbfb8aa3b, v25
    v_mul_f32 v90, 0xbfb8aa3b, v26
    v_mul_f32 v91, 0xbfb8aa3b, v27
    v_mul_f32 v92, 0xbfb8aa3b, v28
    v_mul_f32 v93, 0xbfb8aa3b, v29
    v_mul_f32 v94, 0xbfb8aa3b, v30
    v_mul_f32 v95, 0xbfb8aa3b, v31
    v_exp_f32 v88, v88
    v_exp_f32 v89, v89
    v_exp_f32 v90, v90
    v_exp_f32 v91, v91
    v_exp_f32 v92, v92
    v_exp_f32 v93, v93
    v_exp_f32 v94, v94
    v_exp_f32 v95, v95
    v_add_f32 v88, 1.0, v88
    v_mul_f32 v24, v9, v24
    v_add_f32 v89, 1.0, v89
    v_mul_f32 v25, v9, v25
    v_add_f32 v90, 1.0, v90
    v_mul_f32 v26, v9, v26
    v_add_f32 v91, 1.0, v91
    v_mul_f32 v27, v9, v27
    v_add_f32 v92, 1.0, v92
    v_mul_f32 v28, v9, v28
    v_add_f32 v93, 1.0, v93
    v_mul_f32 v29, v9, v29
    v_add_f32 v94, 1.0, v94
    v_mul_f32 v30, v9, v30
    v_add_f32 v95, 1.0, v95
    v_mul_f32 v31, v9, v31
    v_rcp_f32 v88, v88
    v_rcp_f32 v89, v89
    v_rcp_f32 v90, v90
    v_rcp_f32 v91, v91
    v_rcp_f32 v92, v92
    v_rcp_f32 v93, v93
    v_rcp_f32 v94, v94
    v_rcp_f32 v95, v95
    s_nop 0
    v_mul_f32 v24, v88, v24
    v_mul_f32 v25, v89, v25
    v_mul_f32 v26, v90, v26
    v_mul_f32 v27, v91, v27
    v_mul_f32 v28, v92, v28
    v_mul_f32 v29, v93, v29
    v_mul_f32 v30, v94, v30
    v_mul_f32 v31, v95, v31
    v_cvt_pk_bf16_f32 v72, v16, v17
    v_cvt_pk_bf16_f32 v73, v18, v19
    v_cvt_pk_bf16_f32 v74, v20, v21
    v_cvt_pk_bf16_f32 v75, v22, v23
    buffer_store_dwordx4 v[72:75], v8, s[4:7], s42 offen offset:0 sc1
    v_cvt_pk_bf16_f32 v76, v24, v25
    v_cvt_pk_bf16_f32 v77, v26, v27
    v_cvt_pk_bf16_f32 v78, v28, v29
    v_cvt_pk_bf16_f32 v79, v30, v31
    buffer_store_dwordx4 v[76:79], v8, s[4:7], s42 offen offset:512 sc1
    v_mul_f32 v88, 0xbfb8aa3b, v32
    v_mul_f32 v89, 0xbfb8aa3b, v33
    v_mul_f32 v90, 0xbfb8aa3b, v34
    v_mul_f32 v91, 0xbfb8aa3b, v35
    v_mul_f32 v92, 0xbfb8aa3b, v36
    v_mul_f32 v93, 0xbfb8aa3b, v37
    v_mul_f32 v94, 0xbfb8aa3b, v38
    v_mul_f32 v95, 0xbfb8aa3b, v39
    v_exp_f32 v88, v88
    v_exp_f32 v89, v89
    v_exp_f32 v90, v90
    v_exp_f32 v91, v91
    v_exp_f32 v92, v92
    v_exp_f32 v93, v93
    v_exp_f32 v94, v94
    v_exp_f32 v95, v95
    v_add_f32 v88, 1.0, v88
    v_mul_f32 v32, v9, v32
    v_add_f32 v89, 1.0, v89
    v_mul_f32 v33, v9, v33
    v_add_f32 v90, 1.0, v90
    v_mul_f32 v34, v9, v34
    v_add_f32 v91, 1.0, v91
    v_mul_f32 v35, v9, v35
    v_add_f32 v92, 1.0, v92
    v_mul_f32 v36, v9, v36
    v_add_f32 v93, 1.0, v93
    v_mul_f32 v37, v9, v37
    v_add_f32 v94, 1.0, v94
    v_mul_f32 v38, v9, v38
    v_add_f32 v95, 1.0, v95
    v_mul_f32 v39, v9, v39
    v_rcp_f32 v88, v88
    v_rcp_f32 v89, v89
    v_rcp_f32 v90, v90
    v_rcp_f32 v91, v91
    v_rcp_f32 v92, v92
    v_rcp_f32 v93, v93
    v_rcp_f32 v94, v94
    v_rcp_f32 v95, v95
    s_nop 0
    v_mul_f32 v32, v88, v32
    v_mul_f32 v33, v89, v33
    v_mul_f32 v34, v90, v34
    v_mul_f32 v35, v91, v35
    v_mul_f32 v36, v92, v36
    v_mul_f32 v37, v93, v37
    v_mul_f32 v38, v94, v38
    v_mul_f32 v39, v95, v39
    v_mul_f32 v88, 0xbfb8aa3b, v40
    v_mul_f32 v89, 0xbfb8aa3b, v41
    v_mul_f32 v90, 0xbfb8aa3b, v42
    v_mul_f32 v91, 0xbfb8aa3b, v43
    v_mul_f32 v92, 0xbfb8aa3b, v44
    v_mul_f32 v93, 0xbfb8aa3b, v45
    v_mul_f32 v94, 0xbfb8aa3b, v46
    v_mul_f32 v95, 0xbfb8aa3b, v47
    v_exp_f32 v88, v88
    v_exp_f32 v89, v89
    v_exp_f32 v90, v90
    v_exp_f32 v91, v91
    v_exp_f32 v92, v92
    v_exp_f32 v93, v93
    v_exp_f32 v94, v94
    v_exp_f32 v95, v95
    v_add_f32 v88, 1.0, v88
    v_mul_f32 v40, v9, v40
    v_add_f32 v89, 1.0, v89
    v_mul_f32 v41, v9, v41
    v_add_f32 v90, 1.0, v90
    v_mul_f32 v42, v9, v42
    v_add_f32 v91, 1.0, v91
    v_mul_f32 v43, v9, v43
    v_add_f32 v92, 1.0, v92
    v_mul_f32 v44, v9, v44
    v_add_f32 v93, 1.0, v93
    v_mul_f32 v45, v9, v45
    v_add_f32 v94, 1.0, v94
    v_mul_f32 v46, v9, v46
    v_add_f32 v95, 1.0, v95
    v_mul_f32 v47, v9, v47
    v_rcp_f32 v88, v88
    v_rcp_f32 v89, v89
    v_rcp_f32 v90, v90
    v_rcp_f32 v91, v91
    v_rcp_f32 v92, v92
    v_rcp_f32 v93, v93
    v_rcp_f32 v94, v94
    v_rcp_f32 v95, v95
    s_nop 0
    v_mul_f32 v40, v88, v40
    v_mul_f32 v41, v89, v41
    v_mul_f32 v42, v90, v42
    v_mul_f32 v43, v91, v43
    v_mul_f32 v44, v92, v44
    v_mul_f32 v45, v93, v45
    v_mul_f32 v46, v94, v46
    v_mul_f32 v47, v95, v47
    v_cvt_pk_bf16_f32 v80, v32, v33
    v_cvt_pk_bf16_f32 v81, v34, v35
    v_cvt_pk_bf16_f32 v82, v36, v37
    v_cvt_pk_bf16_f32 v83, v38, v39
    buffer_store_dwordx4 v[80:83], v8, s[4:7], s42 offen offset:2048 sc1
    v_cvt_pk_bf16_f32 v84, v40, v41
    v_cvt_pk_bf16_f32 v85, v42, v43
    v_cvt_pk_bf16_f32 v86, v44, v45
    v_cvt_pk_bf16_f32 v87, v46, v47
    buffer_store_dwordx4 v[84:87], v8, s[4:7], s42 offen offset:2560 sc1
    s_add_u32 s42, s42, 229376
    s_add_u32 s45, s45, 1
    s_add_u32 s20, s20, 2
    s_cmp_lt_u32 s20, 64
    s_cbranch_scc1 GH_loop
    s_waitcnt vmcnt(0)
    s_barrier
    s_sub_u32 s46, s20, 2
    s_cmp_lg_u32 s17, 0
    s_cbranch_scc1 AR_20
    s_lshl_b32 s41, s46, 11
    s_add_u32 s41, s41, 15270144
    v_mov_b32 v252, 1
    s_mov_b64 exec, 1
    buffer_atomic_add v252, v251, s[4:7], s41 offen
    s_mov_b64 exec, -1
AR_20:
    s_branch L_next_free
TU_entry:
    v_mbcnt_lo_u32_b32 v0, -1, 0
    v_mbcnt_hi_u32_b32 v0, -1, v0
    v_lshlrev_b32 v250, 4, v0
    v_mov_b32 v251, 0
    v_lshrrev_b32 v1, 5, v0
    v_and_b32 v2, 31, v0
    v_and_b32 v3, 15, v0
    v_lshrrev_b32 v4, 4, v0
    s_cmp_lg_u32 s17, 0
    s_cbranch_scc1 WT_21_ok
    v_mov_b32 v253, 192
WT_21:
    buffer_load_dword v252, v253, s[12:15], 0 offen sc1
    s_waitcnt vmcnt(0)
    v_cmp_eq_u32 vcc, 0, v252
    s_cbranch_vccz WT_21_ok
    s_sleep 32
    s_sub_u32 s35, s35, 1
    s_cmp_lg_u32 s35, 0
    s_cbranch_scc1 WT_21
    s_endpgm
WT_21_ok:
    s_barrier
    s_mul_i32 s39, s16, 229376
    s_mul_i32 s40, s17, 57344
    s_add_u32 s39, s39, s40
    s_add_u32 s39, s39, 7340032
    s_cmp_lg_u32 s17, 0
    s_cbranch_scc1 WW_22
    v_mbcnt_lo_u32_b32 v253, -1, 0
    v_and_b32 v253, 3, v253
    v_lshlrev_b32 v253, 7, v253
    s_mov_b32 s41, 15237632
    s_mov_b64 exec, 15
WD_23:
    buffer_load_dword v252, v253, s[4:7], s41 offen sc1
    s_waitcnt vmcnt(0)
    v_cmp_gt_u32 vcc, 0x40, v252
    s_cbranch_vccz WD_23_ok
    s_sleep 4
    s_sub_u32 s35, s35, 1
    s_cmp_lg_u32 s35, 0
    s_cbranch_scc1 WD_23
    s_branch L_exit
WD_23_ok:
    s_mov_b64 exec, -1
WW_22:
    s_barrier
    buffer_load_dwordx4 a[0:3], v250, s[4:7], s39 offen offset:0 sc1
    buffer_load_dwordx4 a[4:7], v250, s[4:7], s39 offen offset:1024 sc1
    buffer_load_dwordx4 a[8:11], v250, s[4:7], s39 offen offset:2048 sc1
    buffer_load_dwordx4 a[12:15], v250, s[4:7], s39 offen offset:3072 sc1
    s_add_u32 s39, s39, 4096
    buffer_load_dwordx4 a[16:19], v250, s[4:7], s39 offen offset:0 sc1
    buffer_load_dwordx4 a[20:23], v250, s[4:7], s39 offen offset:1024 sc1
    buffer_load_dwordx4 a[24:27], v250, s[4:7], s39 offen offset:2048 sc1
    buffer_load_dwordx4 a[28:31], v250, s[4:7], s39 offen offset:3072 sc1
    s_add_u32 s39, s39, 4096
    buffer_load_dwordx4 a[32:35], v250, s[4:7], s39 offen offset:0 sc1
    buffer_load_dwordx4 a[36:39], v250, s[4:7], s39 offen offset:1024 sc1
    buffer_load_dwordx4 a[40:43], v250, s[4:7], s39 offen offset:2048 sc1
    buffer_load_dwordx4 a[44:47], v250, s[4:7], s39 offen offset:3072 sc1
    s_add_u32 s39, s39, 4096
    buffer_load_dwordx4 a[48:51], v250, s[4:7], s39 offen offset:0 sc1
    buffer_load_dwordx4 a[52:55], v250, s[4:7], s39 offen offset:1024 sc1
    buffer_load_dwordx4 a[56:59], v250, s[4:7], s39 offen offset:2048 sc1
    buffer_load_dwordx4 a[60:63], v250, s[4:7], s39 offen offset:3072 sc1
    s_add_u32 s39, s39, 4096
    buffer_load_dwordx4 a[64:67], v250, s[4:7], s39 offen offset:0 sc1
    buffer_load_dwordx4 a[68:71], v250, s[4:7], s39 offen offset:1024 sc1
    buffer_load_dwordx4 a[72:75], v250, s[4:7], s39 offen offset:2048 sc1
    buffer_load_dwordx4 a[76:79], v250, s[4:7], s39 offen offset:3072 sc1
    s_add_u32 s39, s39, 4096
    buffer_load_dwordx4 a[80:83], v250, s[4:7], s39 offen offset:0 sc1
    buffer_load_dwordx4 a[84:87], v250, s[4:7], s39 offen offset:1024 sc1
    buffer_load_dwordx4 a[88:91], v250, s[4:7], s39 offen offset:2048 sc1
    buffer_load_dwordx4 a[92:95], v250, s[4:7], s39 offen offset:3072 sc1
    s_add_u32 s39, s39, 4096
    buffer_load_dwordx4 a[96:99], v250, s[4:7], s39 offen offset:0 sc1
    buffer_load_dwordx4 a[100:103], v250, s[4:7], s39 offen offset:1024 sc1
    buffer_load_dwordx4 a[104:107], v250, s[4:7], s39 offen offset:2048 sc1
    buffer_load_dwordx4 a[108:111], v250, s[4:7], s39 offen offset:3072 sc1
    s_add_u32 s39, s39, 4096
    buffer_load_dwordx4 a[112:115], v250, s[4:7], s39 offen offset:0 sc1
    buffer_load_dwordx4 a[116:119], v250, s[4:7], s39 offen offset:1024 sc1
    buffer_load_dwordx4 a[120:123], v250, s[4:7], s39 offen offset:2048 sc1
    buffer_load_dwordx4 a[124:127], v250, s[4:7], s39 offen offset:3072 sc1
    s_add_u32 s39, s39, 4096
    buffer_load_dwordx4 a[128:131], v250, s[4:7], s39 offen offset:0 sc1
    buffer_load_dwordx4 a[132:135], v250, s[4:7], s39 offen offset:1024 sc1
    buffer_load_dwordx4 a[136:139], v250, s[4:7], s39 offen offset:2048 sc1
    buffer_load_dwordx4 a[140:143], v250, s[4:7], s39 offen offset:3072 sc1
    s_add_u32 s39, s39, 4096
    buffer_load_dwordx4 a[144:147], v250, s[4:7], s39 offen offset:0 sc1
    buffer_load_dwordx4 a[148:151], v250, s[4:7], s39 offen offset:1024 sc1
    buffer_load_dwordx4 a[152:155], v250, s[4:7], s39 offen offset:2048 sc1
    buffer_load_dwordx4 a[156:159], v250, s[4:7], s39 offen offset:3072 sc1
    s_add_u32 s39, s39, 4096
    buffer_load_dwordx4 a[160:163], v250, s[4:7], s39 offen offset:0 sc1
    buffer_load_dwordx4 a[164:167], v250, s[4:7], s39 offen offset:1024 sc1
    buffer_load_dwordx4 a[168:171], v250, s[4:7], s39 offen offset:2048 sc1
    buffer_load_dwordx4 a[172:175], v250, s[4:7], s39 offen offset:3072 sc1
    s_add_u32 s39, s39, 4096
    buffer_load_dwordx4 a[176:179], v250, s[4:7], s39 offen offset:0 sc1
    buffer_load_dwordx4 a[180:183], v250, s[4:7], s39 offen offset:1024 sc1
    buffer_load_dwordx4 a[184:187], v250, s[4:7], s39 offen offset:2048 sc1
    buffer_load_dwordx4 a[188:191], v250, s[4:7], s39 offen offset:3072 sc1
    s_add_u32 s39, s39, 4096
    buffer_load_dwordx4 a[192:195], v250, s[4:7], s39 offen offset:0 sc1
    buffer_load_dwordx4 a[196:199], v250, s[4:7], s39 offen offset:1024 sc1
    buffer_load_dwordx4 a[200:203], v250, s[4:7], s39 offen offset:2048 sc1
    buffer_load_dwordx4 a[204:207], v250, s[4:7], s39 offen offset:3072 sc1
    s_add_u32 s39, s39, 4096
    buffer_load_dwordx4 a[208:211], v250, s[4:7], s39 offen offset:0 sc1
    buffer_load_dwordx4 a[212:215], v250, s[4:7], s39 offen offset:1024 sc1
    buffer_load_dwordx4 a[216:219], v250, s[4:7], s39 offen offset:2048 sc1
    buffer_load_dwordx4 a[220:223], v250, s[4:7], s39 offen offset:3072 sc1
    v_and_b32 v5, 1, v0
    v_cmp_eq_u32 vcc, 1, v5
    v_mov_b32 v8, 0x44444444
    v_mov_b32 v6, 0xeeeeeeee
    v_cndmask_b32 v8, v8, v6, vcc
    v_lshlrev_b32 v6, 8, v4
    v_lshl_add_u32 v6, v5, 2, v6
    v_bfe_u32 v5, v0, 1, 3
    v_lshl_add_u32 v6, v5, 4, v6
    s_lshl_b32 s42, s16, 12
    s_lshl_b32 s40, s17, 10
    s_add_u32 s42, s42, s40
    s_add_u32 s42, s42, 16777216
    s_lshr_b32 s43, s16, 2
    s_lshl_b32 s43, s43, 7
    s_mov_b32 s20, 0
    v_add_u32 v72, 0, v6
    v_add_u32 v73, 1024, v6
    v_add_u32 v74, 2048, v6
    v_add_u32 v75, 3072, v6
    v_add_u32 v76, 4096, v6
    v_add_u32 v77, 5120, v6
    v_add_u32 v78, 6144, v6
    s_cmp_lg_u32 s17, 0
    s_cbranch_scc1 WW_24
    v_mbcnt_lo_u32_b32 v253, -1, 0
    v_and_b32 v253, 1, v253
    v_lshlrev_b32 v253, 7, v253
    s_mov_b32 s41, 15238144
    s_mov_b64 exec, 3
WD_25:
    buffer_load_dword v252, v253, s[4:7], s41 offen sc1
    s_waitcnt vmcnt(0)
    v_cmp_gt_u32 vcc, 0x40, v252
    s_cbranch_vccz WD_25_ok
    s_sleep 4
    s_sub_u32 s35, s35, 1
    s_cmp_lg_u32 s35, 0
    s_cbranch_scc1 WD_25
    s_branch L_exit
WD_25_ok:
    s_mov_b64 exec, -1
WW_24:
    s_barrier
    s_lshl_b32 s36, s20, 13
    s_add_u32 s36, s36, 15728640
    s_lshl_b32 s37, s17, 10
    s_add_u32 s36, s36, s37
    s_add_u32 s38, s17, 4
    s_min_u32 s38, s38, 6
    s_sub_u32 s38, s38, s17
    s_lshl_b32 s38, s38, 10
    s_add_u32 s39, s36, s38
    v_add_u32 v88, s37, v250
    v_add_u32 v89, s38, v88
    buffer_load_dwordx4 v[80:83], v250, s[4:7], s36 offen sc1
    buffer_load_dwordx4 v[84:87], v250, s[4:7], s39 offen sc1
TU_loop:
    v_mov_b32 v48, 0
    v_mov_b32 v49, 0
    v_mov_b32 v50, 0
    v_mov_b32 v51, 0
    v_mov_b32 v52, 0
    v_mov_b32 v53, 0
    v_mov_b32 v54, 0
    v_mov_b32 v55, 0
    v_mov_b32 v56, 0
    v_mov_b32 v57, 0
    v_mov_b32 v58, 0
    v_mov_b32 v59, 0
    v_mov_b32 v60, 0
    v_mov_b32 v61, 0
    v_mov_b32 v62, 0
    v_mov_b32 v63, 0
    s_cmp_eq_u32 s20, 63
    s_cselect_b32 s40, 1, 0
TU_m1:
    s_waitcnt vmcnt(0)
    v_max3_u32 v252, v80, v81, v82
    v_max3_u32 v252, v252, v83, v84
    v_max3_u32 v252, v252, v85, v86
    v_max_u32 v252, v252, v87
    v_cmp_eq_u32 vcc, -1, v252
    s_cbranch_vccz TU_mok
TU_mw:
    s_sub_u32 s35, s35, 1
    s_cmp_eq_u32 s35, 0
    s_cbranch_scc1 L_exit
    s_cmp_eq_u32 s40, 1
    s_cbranch_scc1 TU_m2
    s_sleep 4
    buffer_load_dword v252, v251, s[4:7], s39 offen sc1
    s_waitcnt vmcnt(0)
    v_cmp_eq_u32 vcc, -1, v252
    s_cbranch_vccnz TU_mw
    s_mov_b32 s40, 1
TU_m2:
    buffer_load_dwordx4 v[80:83], v250, s[4:7], s36 offen sc1
    buffer_load_dwordx4 v[84:87], v250, s[4:7], s39 offen sc1
    s_branch TU_m1
TU_mok:
    ds_write_b128 v88, v[80:83] offset:0
    ds_write_b128 v89, v[84:87] offset:0
    s_waitcnt lgkmcnt(0)
    s_barrier
    ds_read2_b32 v[16:17], v72 offset0:0 offset1:2
    ds_read2_b32 v[18:19], v72 offset0:32 offset1:34
    ds_read2_b32 v[20:21], v73 offset0:0 offset1:2
    ds_read2_b32 v[22:23], v73 offset0:32 offset1:34
    ds_read2_b32 v[24:25], v74 offset0:0 offset1:2
    ds_read2_b32 v[26:27], v74 offset0:32 offset1:34
    ds_read2_b32 v[28:29], v75 offset0:0 offset1:2
    ds_read2_b32 v[30:31], v75 offset0:32 offset1:34
    ds_read2_b32 v[32:33], v76 offset0:0 offset1:2
    ds_read2_b32 v[34:35], v76 offset0:32 offset1:34
    ds_read2_b32 v[36:37], v77 offset0:0 offset1:2
    ds_read2_b32 v[38:39], v77 offset0:32 offset1:34
    ds_read2_b32 v[40:41], v78 offset0:0 offset1:2
    ds_read2_b32 v[42:43], v78 offset0:32 offset1:34
    s_waitcnt lgkmcnt(12)
    v_smfmac_f32_16x16x64_bf16 v[48:51], v[16:19], a[0:7], v8
    v_smfmac_f32_16x16x64_bf16 v[52:55], v[16:19], a[56:63], v8
    v_smfmac_f32_16x16x64_bf16 v[56:59], v[16:19], a[112:119], v8
    v_smfmac_f32_16x16x64_bf16 v[60:63], v[16:19], a[168:175], v8
    s_waitcnt lgkmcnt(10)
    v_smfmac_f32_16x16x64_bf16 v[48:51], v[20:23], a[8:15], v8
    v_smfmac_f32_16x16x64_bf16 v[52:55], v[20:23], a[64:71], v8
    v_smfmac_f32_16x16x64_bf16 v[56:59], v[20:23], a[120:127], v8
    v_smfmac_f32_16x16x64_bf16 v[60:63], v[20:23], a[176:183], v8
    s_waitcnt lgkmcnt(8)
    v_smfmac_f32_16x16x64_bf16 v[48:51], v[24:27], a[16:23], v8
    v_smfmac_f32_16x16x64_bf16 v[52:55], v[24:27], a[72:79], v8
    v_smfmac_f32_16x16x64_bf16 v[56:59], v[24:27], a[128:135], v8
    v_smfmac_f32_16x16x64_bf16 v[60:63], v[24:27], a[184:191], v8
    s_waitcnt lgkmcnt(6)
    v_smfmac_f32_16x16x64_bf16 v[48:51], v[28:31], a[24:31], v8
    v_smfmac_f32_16x16x64_bf16 v[52:55], v[28:31], a[80:87], v8
    v_smfmac_f32_16x16x64_bf16 v[56:59], v[28:31], a[136:143], v8
    v_smfmac_f32_16x16x64_bf16 v[60:63], v[28:31], a[192:199], v8
    s_waitcnt lgkmcnt(4)
    v_smfmac_f32_16x16x64_bf16 v[48:51], v[32:35], a[32:39], v8
    v_smfmac_f32_16x16x64_bf16 v[52:55], v[32:35], a[88:95], v8
    v_smfmac_f32_16x16x64_bf16 v[56:59], v[32:35], a[144:151], v8
    v_smfmac_f32_16x16x64_bf16 v[60:63], v[32:35], a[200:207], v8
    s_waitcnt lgkmcnt(2)
    v_smfmac_f32_16x16x64_bf16 v[48:51], v[36:39], a[40:47], v8
    v_smfmac_f32_16x16x64_bf16 v[52:55], v[36:39], a[96:103], v8
    v_smfmac_f32_16x16x64_bf16 v[56:59], v[36:39], a[152:159], v8
    v_smfmac_f32_16x16x64_bf16 v[60:63], v[36:39], a[208:215], v8
    s_waitcnt lgkmcnt(0)
    v_smfmac_f32_16x16x64_bf16 v[48:51], v[40:43], a[48:55], v8
    v_smfmac_f32_16x16x64_bf16 v[52:55], v[40:43], a[104:111], v8
    v_smfmac_f32_16x16x64_bf16 v[56:59], v[40:43], a[160:167], v8
    v_smfmac_f32_16x16x64_bf16 v[60:63], v[40:43], a[216:223], v8
    s_nop 4
    v_add_f32 v48, v48, v49
    v_add_f32 v50, v50, v51
    v_cvt_pk_bf16_f32 v64, v48, v50
    v_add_f32 v52, v52, v53
    v_add_f32 v54, v54, v55
    v_cvt_pk_bf16_f32 v65, v52, v54
    v_add_f32 v56, v56, v57
    v_add_f32 v58, v58, v59
    v_cvt_pk_bf16_f32 v66, v56, v58
    v_add_f32 v60, v60, v61
    v_add_f32 v62, v62, v63
    v_cvt_pk_bf16_f32 v67, v60, v62
    buffer_store_dwordx4 v[64:67], v250, s[4:7], s42 offen sc1
    s_mov_b32 s46, s20
    s_add_u32 s20, s20, 1
    s_lshl_b32 s36, s20, 13
    s_add_u32 s36, s36, 15728640
    s_lshl_b32 s37, s17, 10
    s_add_u32 s36, s36, s37
    s_add_u32 s38, s17, 4
    s_min_u32 s38, s38, 6
    s_sub_u32 s38, s38, s17
    s_lshl_b32 s38, s38, 10
    s_add_u32 s39, s36, s38
    v_add_u32 v88, s37, v250
    v_add_u32 v89, s38, v88
    buffer_load_dwordx4 v[80:83], v250, s[4:7], s36 offen sc1
    buffer_load_dwordx4 v[84:87], v250, s[4:7], s39 offen sc1
    s_waitcnt vmcnt(2)
    s_barrier
    s_cmp_lg_u32 s17, 0
    s_cbranch_scc1 AR_26
    s_lshl_b32 s41, s46, 11
    s_add_u32 s41, s41, 15270400
    s_add_u32 s41, s41, s43
    v_mov_b32 v252, 1
    s_mov_b64 exec, 1
    buffer_atomic_add v252, v251, s[4:7], s41 offen
    s_mov_b64 exec, -1
AR_26:
    s_add_u32 s42, s42, 114688
    s_cmp_lt_u32 s20, 64
    s_cbranch_scc1 TU_loop
    s_branch L_next
O1_entry:
    v_mbcnt_lo_u32_b32 v0, -1, 0
    v_mbcnt_hi_u32_b32 v0, -1, v0
    v_lshlrev_b32 v250, 4, v0
    v_mov_b32 v251, 0
    v_lshrrev_b32 v1, 5, v0
    v_and_b32 v2, 31, v0
    v_and_b32 v3, 15, v0
    v_lshrrev_b32 v4, 4, v0
    s_cmp_lg_u32 s17, 0
    s_cbranch_scc1 WT_27_ok
    v_mov_b32 v253, 192
WT_27:
    buffer_load_dword v252, v253, s[12:15], 0 offen sc1
    s_waitcnt vmcnt(0)
    v_cmp_eq_u32 vcc, 0, v252
    s_cbranch_vccz WT_27_ok
    s_sleep 32
    s_sub_u32 s35, s35, 1
    s_cmp_lg_u32 s35, 0
    s_cbranch_scc1 WT_27
    s_endpgm
WT_27_ok:
    s_barrier
    s_lshr_b32 s20, s16, 2
    s_and_b32 s43, s16, 3
    s_lshl_b32 s44, s43, 2
    s_add_u32 s44, s44, s17
    v_bfe_u32 v5, v0, 4, 1
    v_lshlrev_b32 v5, 10, v5
    v_lshl_add_u32 v5, v3, 4, v5
    v_lshl_add_u32 v9, v1, 8, v5
    s_lshl_b32 s36, s44, 11
    v_add_u32 v9, s36, v9
    v_lshl_add_u32 v10, v1, 9, v5
    s_lshl_b32 s36, s43, 11
    s_lshl_b32 s37, s17, 2
    s_add_u32 s36, s36, s37
    s_add_u32 s36, s36, 32768
    v_add_u32 v10, s36, v10
    v_lshlrev_b32 v5, 2, v1
    v_sub_u32 v11, v2, v5
    v_and_b32 v5, 7, v0
    v_lshlrev_b32 v5, 4, v5
    v_lshl_add_u32 v12, v1, 7, v5
    v_lshlrev_b32 v14, 2, v2
    s_mul_i32 s45, s17, 7168
    s_cmp_lg_u32 s17, 0
    s_cbranch_scc1 WW_28
    v_mbcnt_lo_u32_b32 v253, -1, 0
    v_and_b32 v253, 1, v253
    v_lshlrev_b32 v253, 7, v253
    s_mov_b32 s41, 15238144
    s_mov_b64 exec, 3
WD_29:
    buffer_load_dword v252, v253, s[4:7], s41 offen sc1
    s_waitcnt vmcnt(0)
    v_cmp_gt_u32 vcc, 0x40, v252
    s_cbranch_vccz WD_29_ok
    s_sleep 4
    s_sub_u32 s35, s35, 1
    s_cmp_lg_u32 s35, 0
    s_cbranch_scc1 WD_29
    s_branch L_exit
WD_29_ok:
    s_mov_b64 exec, -1
WW_28:
    s_barrier
O1_loop:
    s_mul_i32 s36, s20, 28672
    s_add_u32 s36, s36, s45
    s_add_u32 s36, s36, 27262976
    s_add_u32 m0, s45, 0
    s_add_u32 s40, s36, 0
    buffer_load_dwordx4 v250, s[4:7], s40 offen offset:0 sc1 lds
    buffer_load_dwordx4 v250, s[4:7], s40 offen offset:1024 sc1 lds
    buffer_load_dwordx4 v250, s[4:7], s40 offen offset:2048 sc1 lds
    buffer_load_dwordx4 v250, s[4:7], s40 offen offset:3072 sc1 lds
    s_add_u32 m0, s45, 4096
    s_add_u32 s40, s36, 4096
    buffer_load_dwordx4 v250, s[4:7], s40 offen offset:0 sc1 lds
    buffer_load_dwordx4 v250, s[4:7], s40 offen offset:1024 sc1 lds
    buffer_load_dwordx4 v250, s[4:7], s40 offen offset:2048 sc1 lds
    s_lshl_b32 s40, s20, 7
    s_add_u32 s40, s40, 15400960
    buffer_load_dword v8, v14, s[4:7], s40 offen sc1
    s_cmp_lg_u32 s17, 0
    s_cbranch_scc1 W_30_ok
    s_lshl_b32 s41, s20, 11
    s_add_u32 s41, s41, 15270016
W_30:
    buffer_load_dword v252, v251, s[4:7], s41 offen sc1
    s_waitcnt vmcnt(0)
    v_cmp_gt_u32 vcc, 28, v252
    s_cbranch_vccz W_30_ok
    s_sleep 4
    s_sub_u32 s35, s35, 1
    s_cmp_lg_u32 s35, 0
    s_cbranch_scc1 W_30
    s_endpgm
W_30_ok:
    s_waitcnt vmcnt(0)
    s_barrier
    s_mul_i32 s36, s20, 458752
    s_mul_i32 s37, s44, 28672
    s_add_u32 s36, s36, s37
    s_add_u32 s36, s36, 67108864
    buffer_load_dwordx4 a[0:3], v250, s[4:7], s36 offen offset:0 sc1
    buffer_load_dwordx4 a[4:7], v250, s[4:7], s36 offen offset:1024 sc1
    buffer_load_dwordx4 a[8:11], v250, s[4:7], s36 offen offset:2048 sc1
    buffer_load_dwordx4 a[12:15], v250, s[4:7], s36 offen offset:3072 sc1
    s_add_u32 s36, s36, 4096
    buffer_load_dwordx4 a[16:19], v250, s[4:7], s36 offen offset:0 sc1
    buffer_load_dwordx4 a[20:23], v250, s[4:7], s36 offen offset:1024 sc1
    buffer_load_dwordx4 a[24:27], v250, s[4:7], s36 offen offset:2048 sc1
    buffer_load_dwordx4 a[28:31], v250, s[4:7], s36 offen offset:3072 sc1
    s_add_u32 s36, s36, 4096
    buffer_load_dwordx4 a[32:35], v250, s[4:7], s36 offen offset:0 sc1
    buffer_load_dwordx4 a[36:39], v250, s[4:7], s36 offen offset:1024 sc1
    buffer_load_dwordx4 a[40:43], v250, s[4:7], s36 offen offset:2048 sc1
    buffer_load_dwordx4 a[44:47], v250, s[4:7], s36 offen offset:3072 sc1
    s_add_u32 s36, s36, 4096
    buffer_load_dwordx4 a[48:51], v250, s[4:7], s36 offen offset:0 sc1
    buffer_load_dwordx4 a[52:55], v250, s[4:7], s36 offen offset:1024 sc1
    buffer_load_dwordx4 a[56:59], v250, s[4:7], s36 offen offset:2048 sc1
    buffer_load_dwordx4 a[60:63], v250, s[4:7], s36 offen offset:3072 sc1
    s_add_u32 s36, s36, 4096
    buffer_load_dwordx4 a[64:67], v250, s[4:7], s36 offen offset:0 sc1
    buffer_load_dwordx4 a[68:71], v250, s[4:7], s36 offen offset:1024 sc1
    buffer_load_dwordx4 a[72:75], v250, s[4:7], s36 offen offset:2048 sc1
    buffer_load_dwordx4 a[76:79], v250, s[4:7], s36 offen offset:3072 sc1
    s_add_u32 s36, s36, 4096
    buffer_load_dwordx4 a[80:83], v250, s[4:7], s36 offen offset:0 sc1
    buffer_load_dwordx4 a[84:87], v250, s[4:7], s36 offen offset:1024 sc1
    buffer_load_dwordx4 a[88:91], v250, s[4:7], s36 offen offset:2048 sc1
    buffer_load_dwordx4 a[92:95], v250, s[4:7], s36 offen offset:3072 sc1
    s_add_u32 s36, s36, 4096
    buffer_load_dwordx4 a[96:99], v250, s[4:7], s36 offen offset:0 sc1
    buffer_load_dwordx4 a[100:103], v250, s[4:7], s36 offen offset:1024 sc1
    buffer_load_dwordx4 a[104:107], v250, s[4:7], s36 offen offset:2048 sc1
    buffer_load_dwordx4 a[108:111], v250, s[4:7], s36 offen offset:3072 sc1
    s_barrier
    ds_read_b128 v[48:51], v250 offset:0
    ds_read_b128 v[52:55], v250 offset:1024
    ds_read_b128 v[56:59], v250 offset:2048
    ds_read_b128 v[60:63], v250 offset:3072
    ds_read_b128 v[64:67], v250 offset:4096
    ds_read_b128 v[68:71], v250 offset:5120
    s_waitcnt lgkmcnt(5) vmcnt(27)
    v_mfma_f32_32x32x16_bf16 v[16:31], v[48:51], a[0:3], 0
    ds_read_b128 v[48:51], v250 offset:6144
    s_waitcnt lgkmcnt(5) vmcnt(26)
    v_mfma_f32_32x32x16_bf16 v[16:31], v[52:55], a[4:7], v[16:31]
    ds_read_b128 v[52:55], v250 offset:7168
    s_waitcnt lgkmcnt(5) vmcnt(25)
    v_mfma_f32_32x32x16_bf16 v[16:31], v[56:59], a[8:11], v[16:31]
    ds_read_b128 v[56:59], v250 offset:8192
    s_waitcnt lgkmcnt(5) vmcnt(24)
    v_mfma_f32_32x32x16_bf16 v[16:31], v[60:63], a[12:15], v[16:31]
    ds_read_b128 v[60:63], v250 offset:9216
    s_waitcnt lgkmcnt(5) vmcnt(23)
    v_mfma_f32_32x32x16_bf16 v[16:31], v[64:67], a[16:19], v[16:31]
    ds_read_b128 v[64:67], v250 offset:10240
    s_waitcnt lgkmcnt(5) vmcnt(22)
    v_mfma_f32_32x32x16_bf16 v[16:31], v[68:71], a[20:23], v[16:31]
    ds_read_b128 v[68:71], v250 offset:11264
    s_waitcnt lgkmcnt(5) vmcnt(21)
    v_mfma_f32_32x32x16_bf16 v[16:31], v[48:51], a[24:27], v[16:31]
    ds_read_b128 v[48:51], v250 offset:12288
    s_waitcnt lgkmcnt(5) vmcnt(20)
    v_mfma_f32_32x32x16_bf16 v[16:31], v[52:55], a[28:31], v[16:31]
    ds_read_b128 v[52:55], v250 offset:13312
    s_waitcnt lgkmcnt(5) vmcnt(19)
    v_mfma_f32_32x32x16_bf16 v[16:31], v[56:59], a[32:35], v[16:31]
    ds_read_b128 v[56:59], v250 offset:14336
    s_waitcnt lgkmcnt(5) vmcnt(18)
    v_mfma_f32_32x32x16_bf16 v[16:31], v[60:63], a[36:39], v[16:31]
    ds_read_b128 v[60:63], v250 offset:15360
    s_waitcnt lgkmcnt(5) vmcnt(17)
    v_mfma_f32_32x32x16_bf16 v[16:31], v[64:67], a[40:43], v[16:31]
    ds_read_b128 v[64:67], v250 offset:16384
    s_waitcnt lgkmcnt(5) vmcnt(16)
    v_mfma_f32_32x32x16_bf16 v[16:31], v[68:71], a[44:47], v[16:31]
    ds_read_b128 v[68:71], v250 offset:17408
    s_waitcnt lgkmcnt(5) vmcnt(15)
    v_mfma_f32_32x32x16_bf16 v[16:31], v[48:51], a[48:51], v[16:31]
    ds_read_b128 v[48:51], v250 offset:18432
    s_waitcnt lgkmcnt(5) vmcnt(14)
    v_mfma_f32_32x32x16_bf16 v[16:31], v[52:55], a[52:55], v[16:31]
    ds_read_b128 v[52:55], v250 offset:19456
    s_waitcnt lgkmcnt(5) vmcnt(13)
    v_mfma_f32_32x32x16_bf16 v[16:31], v[56:59], a[56:59], v[16:31]
    ds_read_b128 v[56:59], v250 offset:20480
    s_waitcnt lgkmcnt(5) vmcnt(12)
    v_mfma_f32_32x32x16_bf16 v[16:31], v[60:63], a[60:63], v[16:31]
    ds_read_b128 v[60:63], v250 offset:21504
    s_waitcnt lgkmcnt(5) vmcnt(11)
    v_mfma_f32_32x32x16_bf16 v[16:31], v[64:67], a[64:67], v[16:31]
    ds_read_b128 v[64:67], v250 offset:22528
    s_waitcnt lgkmcnt(5) vmcnt(10)
    v_mfma_f32_32x32x16_bf16 v[16:31], v[68:71], a[68:71], v[16:31]
    ds_read_b128 v[68:71], v250 offset:23552
    s_waitcnt lgkmcnt(5) vmcnt(9)
    v_mfma_f32_32x32x16_bf16 v[16:31], v[48:51], a[72:75], v[16:31]
    ds_read_b128 v[48:51], v250 offset:24576
    s_waitcnt lgkmcnt(5) vmcnt(8)
    v_mfma_f32_32x32x16_bf16 v[16:31], v[52:55], a[76:79], v[16:31]
    ds_read_b128 v[52:55], v250 offset:25600
    s_waitcnt lgkmcnt(5) vmcnt(7)
    v_mfma_f32_32x32x16_bf16 v[16:31], v[56:59], a[80:83], v[16:31]
    ds_read_b128 v[56:59], v250 offset:26624
    s_waitcnt lgkmcnt(5) vmcnt(6)
    v_mfma_f32_32x32x16_bf16 v[16:31], v[60:63], a[84:87], v[16:31]
    ds_read_b128 v[60:63], v250 offset:27648
    s_waitcnt lgkmcnt(5) vmcnt(5)
    v_mfma_f32_32x32x16_bf16 v[16:31], v[64:67], a[88:91], v[16:31]
    s_waitcnt lgkmcnt(4) vmcnt(4)
    v_mfma_f32_32x32x16_bf16 v[16:31], v[68:71], a[92:95], v[16:31]
    s_waitcnt lgkmcnt(3) vmcnt(3)
    v_mfma_f32_32x32x16_bf16 v[16:31], v[48:51], a[96:99], v[16:31]
    s_waitcnt lgkmcnt(2) vmcnt(2)
    v_mfma_f32_32x32x16_bf16 v[16:31], v[52:55], a[100:103], v[16:31]
    s_waitcnt lgkmcnt(1) vmcnt(1)
    v_mfma_f32_32x32x16_bf16 v[16:31], v[56:59], a[104:107], v[16:31]
    s_waitcnt lgkmcnt(0) vmcnt(0)
    v_mfma_f32_32x32x16_bf16 v[16:31], v[60:63], a[108:111], v[16:31]
    v_mov_b32 v72, 0xff800000
    s_nop 10
    v_cmp_le_i32 vcc, 0, v11
    s_nop 1
    v_cndmask_b32 v16, v72, v16, vcc
    v_cmp_le_i32 vcc, 1, v11
    s_nop 1
    v_cndmask_b32 v17, v72, v17, vcc
    v_cmp_le_i32 vcc, 2, v11
    s_nop 1
    v_cndmask_b32 v18, v72, v18, vcc
    v_cmp_le_i32 vcc, 3, v11
    s_nop 1
    v_cndmask_b32 v19, v72, v19, vcc
    v_cmp_le_i32 vcc, 8, v11
    s_nop 1
    v_cndmask_b32 v20, v72, v20, vcc
    v_cmp_le_i32 vcc, 9, v11
    s_nop 1
    v_cndmask_b32 v21, v72, v21, vcc
    v_cmp_le_i32 vcc, 10, v11
    s_nop 1
    v_cndmask_b32 v22, v72, v22, vcc
    v_cmp_le_i32 vcc, 11, v11
    s_nop 1
    v_cndmask_b32 v23, v72, v23, vcc
    v_cmp_le_i32 vcc, 16, v11
    s_nop 1
    v_cndmask_b32 v24, v72, v24, vcc
    v_cmp_le_i32 vcc, 17, v11
    s_nop 1
    v_cndmask_b32 v25, v72, v25, vcc
    v_cmp_le_i32 vcc, 18, v11
    s_nop 1
    v_cndmask_b32 v26, v72, v26, vcc
    v_cmp_le_i32 vcc, 19, v11
    s_nop 1
    v_cndmask_b32 v27, v72, v27, vcc
    v_cmp_le_i32 vcc, 24, v11
    s_nop 1
    v_cndmask_b32 v28, v72, v28, vcc
    v_cmp_le_i32 vcc, 25, v11
    s_nop 1
    v_cndmask_b32 v29, v72, v29, vcc
    v_cmp_le_i32 vcc, 26, v11
    s_nop 1
    v_cndmask_b32 v30, v72, v30, vcc
    v_cmp_le_i32 vcc, 27, v11
    s_nop 1
    v_cndmask_b32 v31, v72, v31, vcc
    v_max3_f32 v13, v16, v17, v18
    v_max3_f32 v13, v13, v19, v20
    v_max3_f32 v13, v13, v21, v22
    v_max3_f32 v13, v13, v23, v24
    v_max3_f32 v13, v13, v25, v26
    v_max3_f32 v13, v13, v27, v28
    v_max3_f32 v13, v13, v29, v30
    v_max_f32 v13, v13, v31
    s_lshl_b32 s36, s20, 13
    s_add_u32 s36, s36, 15728640
    s_lshl_b32 s37, s17, 10
    s_add_u32 s36, s36, s37
    s_add_u32 s38, s17, 4
    s_min_u32 s38, s38, 6
    s_sub_u32 s38, s38, s17
    s_lshl_b32 s38, s38, 10
    s_add_u32 s39, s36, s38
    v_add_u32 v96, s37, v250
    v_add_u32 v97, s38, v96
    buffer_load_dwordx4 v[88:91], v250, s[4:7], s36 offen sc1
    buffer_load_dwordx4 v[92:95], v250, s[4:7], s39 offen sc1
    s_cmp_eq_u32 s20, 63
    s_cselect_b32 s40, 1, 0
O1_m1:
    s_waitcnt vmcnt(0)
    v_max3_u32 v252, v88, v89, v90
    v_max3_u32 v252, v252, v91, v92
    v_max3_u32 v252, v252, v93, v94
    v_max_u32 v252, v252, v95
    v_cmp_eq_u32 vcc, -1, v252
    s_cbranch_vccz O1_mok
O1_mw:
    s_sub_u32 s35, s35, 1
    s_cmp_eq_u32 s35, 0
    s_cbranch_scc1 L_exit
    s_cmp_eq_u32 s40, 1
    s_cbranch_scc1 O1_m2
    s_sleep 4
    buffer_load_dword v252, v251, s[4:7], s39 offen sc1
    s_waitcnt vmcnt(0)
    v_cmp_eq_u32 vcc, -1, v252
    s_cbranch_vccnz O1_mw
    s_mov_b32 s40, 1
O1_m2:
    buffer_load_dwordx4 v[88:91], v250, s[4:7], s36 offen sc1
    buffer_load_dwordx4 v[92:95], v250, s[4:7], s39 offen sc1
    s_branch O1_m1
O1_mok:
    ds_write_b128 v96, v[88:91] offset:28672
    ds_write_b128 v97, v[92:95] offset:28672
    s_waitcnt lgkmcnt(0)
    s_barrier
    ds_read_b128 v[48:51], v12 offset:28672
    ds_read_b128 v[52:55], v12 offset:28928
    ds_read_b128 v[56:59], v12 offset:29184
    ds_read_b128 v[60:63], v12 offset:29440
    ds_read_b128 v[64:67], v12 offset:29696
    ds_read_b128 v[68:71], v12 offset:29952
    s_waitcnt lgkmcnt(5)
    v_mfma_f32_32x32x16_bf16 v[32:47], v[48:51], a[0:3], 0
    ds_read_b128 v[48:51], v12 offset:30208
    s_waitcnt lgkmcnt(5)
    v_mfma_f32_32x32x16_bf16 v[32:47], v[52:55], a[4:7], v[32:47]
    ds_read_b128 v[52:55], v12 offset:30464
    s_waitcnt lgkmcnt(5)
    v_mfma_f32_32x32x16_bf16 v[32:47], v[56:59], a[8:11], v[32:47]
    ds_read_b128 v[56:59], v12 offset:30720
    s_waitcnt lgkmcnt(5)
    v_mfma_f32_32x32x16_bf16 v[32:47], v[60:63], a[12:15], v[32:47]
    ds_read_b128 v[60:63], v12 offset:30976
    s_waitcnt lgkmcnt(5)
    v_mfma_f32_32x32x16_bf16 v[32:47], v[64:67], a[16:19], v[32:47]
    ds_read_b128 v[64:67], v12 offset:31232
    s_waitcnt lgkmcnt(5)
    v_mfma_f32_32x32x16_bf16 v[32:47], v[68:71], a[20:23], v[32:47]
    ds_read_b128 v[68:71], v12 offset:31488
    s_waitcnt lgkmcnt(5)
    v_mfma_f32_32x32x16_bf16 v[32:47], v[48:51], a[24:27], v[32:47]
    ds_read_b128 v[48:51], v12 offset:31744
    s_waitcnt lgkmcnt(5)
    v_mfma_f32_32x32x16_bf16 v[32:47], v[52:55], a[28:31], v[32:47]
    ds_read_b128 v[52:55], v12 offset:32000
    s_waitcnt lgkmcnt(5)
    v_mfma_f32_32x32x16_bf16 v[32:47], v[56:59], a[32:35], v[32:47]
    ds_read_b128 v[56:59], v12 offset:32256
    s_waitcnt lgkmcnt(5)
    v_mfma_f32_32x32x16_bf16 v[32:47], v[60:63], a[36:39], v[32:47]
    ds_read_b128 v[60:63], v12 offset:32512
    s_waitcnt lgkmcnt(5)
    v_mfma_f32_32x32x16_bf16 v[32:47], v[64:67], a[40:43], v[32:47]
    ds_read_b128 v[64:67], v12 offset:32768
    s_waitcnt lgkmcnt(5)
    v_mfma_f32_32x32x16_bf16 v[32:47], v[68:71], a[44:47], v[32:47]
    ds_read_b128 v[68:71], v12 offset:33024
    s_waitcnt lgkmcnt(5)
    v_mfma_f32_32x32x16_bf16 v[32:47], v[48:51], a[48:51], v[32:47]
    ds_read_b128 v[48:51], v12 offset:33280
    s_waitcnt lgkmcnt(5)
    v_mfma_f32_32x32x16_bf16 v[32:47], v[52:55], a[52:55], v[32:47]
    ds_read_b128 v[52:55], v12 offset:33536
    s_waitcnt lgkmcnt(5)
    v_mfma_f32_32x32x16_bf16 v[32:47], v[56:59], a[56:59], v[32:47]
    ds_read_b128 v[56:59], v12 offset:33792
    s_waitcnt lgkmcnt(5)
    v_mfma_f32_32x32x16_bf16 v[32:47], v[60:63], a[60:63], v[32:47]
    ds_read_b128 v[60:63], v12 offset:34048
    s_waitcnt lgkmcnt(5)
    v_mfma_f32_32x32x16_bf16 v[32:47], v[64:67], a[64:67], v[32:47]
    ds_read_b128 v[64:67], v12 offset:34304
    s_waitcnt lgkmcnt(5)
    v_mfma_f32_32x32x16_bf16 v[32:47], v[68:71], a[68:71], v[32:47]
    ds_read_b128 v[68:71], v12 offset:34560
    s_waitcnt lgkmcnt(5)
    v_mfma_f32_32x32x16_bf16 v[32:47], v[48:51], a[72:75], v[32:47]
    ds_read_b128 v[48:51], v12 offset:34816
    s_waitcnt lgkmcnt(5)
    v_mfma_f32_32x32x16_bf16 v[32:47], v[52:55], a[76:79], v[32:47]
    ds_read_b128 v[52:55], v12 offset:35072
    s_waitcnt lgkmcnt(5)
    v_mfma_f32_32x32x16_bf16 v[32:47], v[56:59], a[80:83], v[32:47]
    ds_read_b128 v[56:59], v12 offset:35328
    s_waitcnt lgkmcnt(5)
    v_mfma_f32_32x32x16_bf16 v[32:47], v[60:63], a[84:87], v[32:47]
    ds_read_b128 v[60:63], v12 offset:35584
    s_waitcnt lgkmcnt(5)
    v_mfma_f32_32x32x16_bf16 v[32:47], v[64:67], a[88:91], v[32:47]
    s_waitcnt lgkmcnt(4)
    v_mfma_f32_32x32x16_bf16 v[32:47], v[68:71], a[92:95], v[32:47]
    s_waitcnt lgkmcnt(3)
    v_mfma_f32_32x32x16_bf16 v[32:47], v[48:51], a[96:99], v[32:47]
    s_waitcnt lgkmcnt(2)
    v_mfma_f32_32x32x16_bf16 v[32:47], v[52:55], a[100:103], v[32:47]
    s_waitcnt lgkmcnt(1)
    v_mfma_f32_32x32x16_bf16 v[32:47], v[56:59], a[104:107], v[32:47]
    s_waitcnt lgkmcnt(0)
    v_mfma_f32_32x32x16_bf16 v[32:47], v[60:63], a[108:111], v[32:47]
    s_nop 11
    v_max3_f32 v13, v13, v32, v33
    v_max3_f32 v13, v13, v34, v35
    v_mov_b32 v72, v13
    s_nop 1
    v_permlane32_swap_b32 v72, v13
    v_max_f32 v13, v13, v72
    s_mov_b32 s37, 1035512379
    v_mul_f32 v13, s37, v13
    v_fma_f32 v16, v16, s37, -v13
    v_fma_f32 v17, v17, s37, -v13
    v_fma_f32 v18, v18, s37, -v13
    v_fma_f32 v19, v19, s37, -v13
    v_fma_f32 v20, v20, s37, -v13
    v_fma_f32 v21, v21, s37, -v13
    v_fma_f32 v22, v22, s37, -v13
    v_fma_f32 v23, v23, s37, -v13
    v_fma_f32 v24, v24, s37, -v13
    v_fma_f32 v25, v25, s37, -v13
    v_fma_f32 v26, v26, s37, -v13
    v_fma_f32 v27, v27, s37, -v13
    v_fma_f32 v28, v28, s37, -v13
    v_fma_f32 v29, v29, s37, -v13
    v_fma_f32 v30, v30, s37, -v13
    v_fma_f32 v31, v31, s37, -v13
    v_fma_f32 v32, v32, s37, -v13
    v_fma_f32 v33, v33, s37, -v13
    v_fma_f32 v34, v34, s37, -v13
    v_fma_f32 v35, v35, s37, -v13
    v_exp_f32 v16, v16
    v_exp_f32 v17, v17
    v_exp_f32 v18, v18
    v_exp_f32 v19, v19
    v_exp_f32 v20, v20
    v_exp_f32 v21, v21
    v_exp_f32 v22, v22
    v_exp_f32 v23, v23
    v_exp_f32 v24, v24
    v_exp_f32 v25, v25
    v_exp_f32 v26, v26
    v_exp_f32 v27, v27
    v_exp_f32 v28, v28
    v_exp_f32 v29, v29
    v_exp_f32 v30, v30
    v_exp_f32 v31, v31
    v_exp_f32 v32, v32
    v_exp_f32 v33, v33
    v_exp_f32 v34, v34
    v_exp_f32 v35, v35
    v_add_f32 v72, v16, v17
    v_add_f32 v73, v18, v19
    v_add_f32 v72, v72, v20
    v_add_f32 v73, v73, v21
    v_add_f32 v72, v72, v22
    v_add_f32 v73, v73, v23
    v_add_f32 v72, v72, v24
    v_add_f32 v73, v73, v25
    v_add_f32 v72, v72, v26
    v_add_f32 v73, v73, v27
    v_add_f32 v72, v72, v28
    v_add_f32 v73, v73, v29
    v_add_f32 v72, v72, v30
    v_add_f32 v73, v73, v31
    v_add_f32 v72, v72, v32
    v_add_f32 v73, v73, v33
    v_add_f32 v72, v72, v34
    v_add_f32 v73, v73, v35
    v_add_f32 v72, v72, v73
    v_mov_b32 v73, v72
    s_nop 1
    v_permlane32_swap_b32 v72, v73
    v_add_f32 v72, v72, v73
    v_rcp_f32 v72, v72
    s_nop 0
    v_mul_f32 v72, v72, v8
    v_mul_f32 v16, v16, v72
    v_mul_f32 v17, v17, v72
    v_mul_f32 v18, v18, v72
    v_mul_f32 v19, v19, v72
    v_mul_f32 v20, v20, v72
    v_mul_f32 v21, v21, v72
    v_mul_f32 v22, v22, v72
    v_mul_f32 v23, v23, v72
    v_mul_f32 v24, v24, v72
    v_mul_f32 v25, v25, v72
    v_mul_f32 v26, v26, v72
    v_mul_f32 v27, v27, v72
    v_mul_f32 v28, v28, v72
    v_mul_f32 v29, v29, v72
    v_mul_f32 v30, v30, v72
    v_mul_f32 v31, v31, v72
    v_mul_f32 v32, v32, v72
    v_mul_f32 v33, v33, v72
    v_mul_f32 v34, v34, v72
    v_mul_f32 v35, v35, v72
    s_mul_i32 s36, s20, 40960
    s_add_u32 s36, s36, 29360128
    v_cvt_pk_bf16_f32 v76, v16, v17
    v_cvt_pk_bf16_f32 v77, v20, v21
    v_cvt_pk_bf16_f32 v78, v18, v19
    v_cvt_pk_bf16_f32 v79, v22, v23
    buffer_store_dwordx4 v[76:79], v9, s[4:7], s36 offen offset:0 sc1
    v_cvt_pk_bf16_f32 v80, v24, v25
    v_cvt_pk_bf16_f32 v81, v28, v29
    v_cvt_pk_bf16_f32 v82, v26, v27
    v_cvt_pk_bf16_f32 v83, v30, v31
    buffer_store_dwordx4 v[80:83], v9, s[4:7], s36 offen offset:512 sc1
    v_cvt_pk_bf16_f32 v84, v32, v33
    buffer_store_dword v84, v10, s[4:7], s36 offen offset:0 sc1
    v_cvt_pk_bf16_f32 v85, v34, v35
    buffer_store_dword v85, v10, s[4:7], s36 offen offset:256 sc1
    s_waitcnt vmcnt(0)
    s_barrier
    s_cmp_lg_u32 s17, 0
    s_cbranch_scc1 AR_31
    s_lshl_b32 s41, s20, 11
    s_add_u32 s41, s41, 15270272
    v_mov_b32 v252, 1
    s_mov_b64 exec, 1
    buffer_atomic_add v252, v251, s[4:7], s41 offen
    s_mov_b64 exec, -1
AR_31:
    s_add_u32 s20, s20, 6
    s_cmp_lt_u32 s20, 64
    s_cbranch_scc1 O1_loop
    s_branch L_next
O2_entry:
    v_mbcnt_lo_u32_b32 v0, -1, 0
    v_mbcnt_hi_u32_b32 v0, -1, v0
    v_lshlrev_b32 v250, 4, v0
    v_mov_b32 v251, 0
    v_lshrrev_b32 v1, 5, v0
    v_and_b32 v2, 31, v0
    v_and_b32 v3, 15, v0
    v_lshrrev_b32 v4, 4, v0
    s_cmp_lg_u32 s17, 0
    s_cbranch_scc1 WT_32_ok
    v_mov_b32 v253, 192
WT_32:
    buffer_load_dword v252, v253, s[12:15], 0 offen sc1
    s_waitcnt vmcnt(0)
    v_cmp_eq_u32 vcc, 0, v252
    s_cbranch_vccz WT_32_ok
    s_sleep 32
    s_sub_u32 s35, s35, 1
    s_cmp_lg_u32 s35, 0
    s_cbranch_scc1 WT_32
    s_endpgm
WT_32_ok:
    s_barrier
    s_mov_b32 s8, s68
    s_mov_b32 s9, s69
    s_mov_b32 s10, 1605632
    s_mov_b32 s11, 0x00020000
    s_mul_i32 s20, s16, 9363
    s_lshr_b32 s20, s20, 16
    s_mul_i32 s36, s20, 7
    s_sub_u32 s43, s16, s36
    s_mul_i32 s39, s17, 401408
    s_lshl_b32 s36, s43, 7
    s_add_u32 s39, s39, s36
    v_lshrrev_b32 v5, 3, v0
    v_mul_u32_u24 v5, 896, v5
    v_and_b32 v6, 7, v0
    v_lshl_add_u32 v5, v6, 4, v5
    v_bfe_u32 v6, v0, 2, 2
    v_lshl_add_u32 v6, v4, 3, v6
    v_lshlrev_b32 v6, 7, v6
    v_and_b32 v7, 3, v0
    v_lshl_add_u32 v6, v7, 3, v6
    s_lshl_b32 s40, s17, 14
    v_add_u32 v6, s40, v6
    s_add_u32 m0, s40, 0
    s_nop 0
    buffer_load_dwordx4 v5, s[8:11], s39 offen lds
    s_add_u32 s39, s39, 7168
    s_add_u32 m0, s40, 1024
    s_nop 0
    buffer_load_dwordx4 v5, s[8:11], s39 offen lds
    s_add_u32 s39, s39, 7168
    s_add_u32 m0, s40, 2048
    s_nop 0
    buffer_load_dwordx4 v5, s[8:11], s39 offen lds
    s_add_u32 s39, s39, 7168
    s_add_u32 m0, s40, 3072
    s_nop 0
    buffer_load_dwordx4 v5, s[8:11], s39 offen lds
    s_add_u32 s39, s39, 7168
    s_add_u32 m0, s40, 4096
    s_nop 0
    buffer_load_dwordx4 v5, s[8:11], s39 offen lds
    s_add_u32 s39, s39, 7168
    s_add_u32 m0, s40, 5120
    s_nop 0
    buffer_load_dwordx4 v5, s[8:11], s39 offen lds
    s_add_u32 s39, s39, 7168
    s_add_u32 m0, s40, 6144
    s_nop 0
    buffer_load_dwordx4 v5, s[8:11], s39 offen lds
    s_add_u32 s39, s39, 7168
    s_add_u32 m0, s40, 7168
    s_nop 0
    buffer_load_dwordx4 v5, s[8:11], s39 offen lds
    s_add_u32 s39, s39, 7168
    s_add_u32 m0, s40, 8192
    s_nop 0
    buffer_load_dwordx4 v5, s[8:11], s39 offen lds
    s_add_u32 s39, s39, 7168
    s_add_u32 m0, s40, 9216
    s_nop 0
    buffer_load_dwordx4 v5, s[8:11], s39 offen lds
    s_add_u32 s39, s39, 7168
    s_add_u32 m0, s40, 10240
    s_nop 0
    buffer_load_dwordx4 v5, s[8:11], s39 offen lds
    s_add_u32 s39, s39, 7168
    s_add_u32 m0, s40, 11264
    s_nop 0
    buffer_load_dwordx4 v5, s[8:11], s39 offen lds
    s_add_u32 s39, s39, 7168
    s_add_u32 m0, s40, 12288
    s_nop 0
    buffer_load_dwordx4 v5, s[8:11], s39 offen lds
    s_add_u32 s39, s39, 7168
    s_add_u32 m0, s40, 13312
    s_nop 0
    buffer_load_dwordx4 v5, s[8:11], s39 offen lds
    s_add_u32 s39, s39, 7168
    s_add_u32 m0, s40, 14336
    s_nop 0
    buffer_load_dwordx4 v5, s[8:11], s39 offen lds
    s_add_u32 s39, s39, 7168
    s_add_u32 m0, s40, 15360
    s_nop 0
    buffer_load_dwordx4 v5, s[8:11], s39 offen lds
    s_add_u32 s39, s39, 7168
    s_waitcnt vmcnt(0)
    ds_read_b64_tr_b16 a[0:1], v6 offset:0
    ds_read_b64_tr_b16 a[2:3], v6 offset:512
    ds_read_b64_tr_b16 a[4:5], v6 offset:32
    ds_read_b64_tr_b16 a[6:7], v6 offset:544
    ds_read_b64_tr_b16 a[8:9], v6 offset:64
    ds_read_b64_tr_b16 a[10:11], v6 offset:576
    ds_read_b64_tr_b16 a[12:13], v6 offset:96
    ds_read_b64_tr_b16 a[14:15], v6 offset:608
    ds_read_b64_tr_b16 a[16:17], v6 offset:4096
    ds_read_b64_tr_b16 a[18:19], v6 offset:4608
    ds_read_b64_tr_b16 a[20:21], v6 offset:4128
    ds_read_b64_tr_b16 a[22:23], v6 offset:4640
    ds_read_b64_tr_b16 a[24:25], v6 offset:4160
    ds_read_b64_tr_b16 a[26:27], v6 offset:4672
    ds_read_b64_tr_b16 a[28:29], v6 offset:4192
    ds_read_b64_tr_b16 a[30:31], v6 offset:4704
    ds_read_b64_tr_b16 a[32:33], v6 offset:8192
    ds_read_b64_tr_b16 a[34:35], v6 offset:8704
    ds_read_b64_tr_b16 a[36:37], v6 offset:8224
    ds_read_b64_tr_b16 a[38:39], v6 offset:8736
    ds_read_b64_tr_b16 a[40:41], v6 offset:8256
    ds_read_b64_tr_b16 a[42:43], v6 offset:8768
    ds_read_b64_tr_b16 a[44:45], v6 offset:8288
    ds_read_b64_tr_b16 a[46:47], v6 offset:8800
    ds_read_b64_tr_b16 a[48:49], v6 offset:12288
    ds_read_b64_tr_b16 a[50:51], v6 offset:12800
    ds_read_b64_tr_b16 a[52:53], v6 offset:12320
    ds_read_b64_tr_b16 a[54:55], v6 offset:12832
    ds_read_b64_tr_b16 a[56:57], v6 offset:12352
    ds_read_b64_tr_b16 a[58:59], v6 offset:12864
    ds_read_b64_tr_b16 a[60:61], v6 offset:12384
    ds_read_b64_tr_b16 a[62:63], v6 offset:12896
    s_waitcnt lgkmcnt(0)
    s_add_u32 m0, s40, 0
    s_nop 0
    buffer_load_dwordx4 v5, s[8:11], s39 offen lds
    s_add_u32 s39, s39, 7168
    s_add_u32 m0, s40, 1024
    s_nop 0
    buffer_load_dwordx4 v5, s[8:11], s39 offen lds
    s_add_u32 s39, s39, 7168
    s_add_u32 m0, s40, 2048
    s_nop 0
    buffer_load_dwordx4 v5, s[8:11], s39 offen lds
    s_add_u32 s39, s39, 7168
    s_add_u32 m0, s40, 3072
    s_nop 0
    buffer_load_dwordx4 v5, s[8:11], s39 offen lds
    s_add_u32 s39, s39, 7168
    s_add_u32 m0, s40, 4096
    s_nop 0
    buffer_load_dwordx4 v5, s[8:11], s39 offen lds
    s_add_u32 s39, s39, 7168
    s_add_u32 m0, s40, 5120
    s_nop 0
    buffer_load_dwordx4 v5, s[8:11], s39 offen lds
    s_add_u32 s39, s39, 7168
    s_add_u32 m0, s40, 6144
    s_nop 0
    buffer_load_dwordx4 v5, s[8:11], s39 offen lds
    s_add_u32 s39, s39, 7168
    s_add_u32 m0, s40, 7168
    s_nop 0
    buffer_load_dwordx4 v5, s[8:11], s39 offen lds
    s_add_u32 s39, s39, 7168
    s_add_u32 m0, s40, 8192
    s_nop 0
    buffer_load_dwordx4 v5, s[8:11], s39 offen lds
    s_add_u32 s39, s39, 7168
    s_add_u32 m0, s40, 9216
    s_nop 0
    buffer_load_dwordx4 v5, s[8:11], s39 offen lds
    s_add_u32 s39, s39, 7168
    s_add_u32 m0, s40, 10240
    s_nop 0
    buffer_load_dwordx4 v5, s[8:11], s39 offen lds
    s_add_u32 s39, s39, 7168
    s_add_u32 m0, s40, 11264
    s_nop 0
    buffer_load_dwordx4 v5, s[8:11], s39 offen lds
    s_add_u32 s39, s39, 7168
    s_add_u32 m0, s40, 12288
    s_nop 0
    buffer_load_dwordx4 v5, s[8:11], s39 offen lds
    s_add_u32 s39, s39, 7168
    s_add_u32 m0, s40, 13312
    s_nop 0
    buffer_load_dwordx4 v5, s[8:11], s39 offen lds
    s_add_u32 s39, s39, 7168
    s_add_u32 m0, s40, 14336
    s_nop 0
    buffer_load_dwordx4 v5, s[8:11], s39 offen lds
    s_add_u32 s39, s39, 7168
    s_add_u32 m0, s40, 15360
    s_nop 0
    buffer_load_dwordx4 v5, s[8:11], s39 offen lds
    s_add_u32 s39, s39, 7168
    s_waitcnt vmcnt(0)
    ds_read_b64_tr_b16 a[64:65], v6 offset:0
    ds_read_b64_tr_b16 a[66:67], v6 offset:512
    ds_read_b64_tr_b16 a[68:69], v6 offset:32
    ds_read_b64_tr_b16 a[70:71], v6 offset:544
    ds_read_b64_tr_b16 a[72:73], v6 offset:64
    ds_read_b64_tr_b16 a[74:75], v6 offset:576
    ds_read_b64_tr_b16 a[76:77], v6 offset:96
    ds_read_b64_tr_b16 a[78:79], v6 offset:608
    ds_read_b64_tr_b16 a[80:81], v6 offset:4096
    ds_read_b64_tr_b16 a[82:83], v6 offset:4608
    ds_read_b64_tr_b16 a[84:85], v6 offset:4128
    ds_read_b64_tr_b16 a[86:87], v6 offset:4640
    ds_read_b64_tr_b16 a[88:89], v6 offset:4160
    ds_read_b64_tr_b16 a[90:91], v6 offset:4672
    ds_read_b64_tr_b16 a[92:93], v6 offset:4192
    ds_read_b64_tr_b16 a[94:95], v6 offset:4704
    ds_read_b64_tr_b16 a[96:97], v6 offset:8192
    ds_read_b64_tr_b16 a[98:99], v6 offset:8704
    ds_read_b64_tr_b16 a[100:101], v6 offset:8224
    ds_read_b64_tr_b16 a[102:103], v6 offset:8736
    ds_read_b64_tr_b16 a[104:105], v6 offset:8256
    ds_read_b64_tr_b16 a[106:107], v6 offset:8768
    ds_read_b64_tr_b16 a[108:109], v6 offset:8288
    ds_read_b64_tr_b16 a[110:111], v6 offset:8800
    ds_read_b64_tr_b16 a[112:113], v6 offset:12288
    ds_read_b64_tr_b16 a[114:115], v6 offset:12800
    ds_read_b64_tr_b16 a[116:117], v6 offset:12320
    ds_read_b64_tr_b16 a[118:119], v6 offset:12832
    ds_read_b64_tr_b16 a[120:121], v6 offset:12352
    ds_read_b64_tr_b16 a[122:123], v6 offset:12864
    ds_read_b64_tr_b16 a[124:125], v6 offset:12384
    ds_read_b64_tr_b16 a[126:127], v6 offset:12896
    s_waitcnt lgkmcnt(0)
    s_add_u32 m0, s40, 0
    s_nop 0
    buffer_load_dwordx4 v5, s[8:11], s39 offen lds
    s_add_u32 s39, s39, 7168
    s_add_u32 m0, s40, 1024
    s_nop 0
    buffer_load_dwordx4 v5, s[8:11], s39 offen lds
    s_add_u32 s39, s39, 7168
    s_add_u32 m0, s40, 2048
    s_nop 0
    buffer_load_dwordx4 v5, s[8:11], s39 offen lds
    s_add_u32 s39, s39, 7168
    s_add_u32 m0, s40, 3072
    s_nop 0
    buffer_load_dwordx4 v5, s[8:11], s39 offen lds
    s_add_u32 s39, s39, 7168
    s_add_u32 m0, s40, 4096
    s_nop 0
    buffer_load_dwordx4 v5, s[8:11], s39 offen lds
    s_add_u32 s39, s39, 7168
    s_add_u32 m0, s40, 5120
    s_nop 0
    buffer_load_dwordx4 v5, s[8:11], s39 offen lds
    s_add_u32 s39, s39, 7168
    s_add_u32 m0, s40, 6144
    s_nop 0
    buffer_load_dwordx4 v5, s[8:11], s39 offen lds
    s_add_u32 s39, s39, 7168
    s_add_u32 m0, s40, 7168
    s_nop 0
    buffer_load_dwordx4 v5, s[8:11], s39 offen lds
    s_add_u32 s39, s39, 7168
    s_add_u32 m0, s40, 8192
    s_nop 0
    buffer_load_dwordx4 v5, s[8:11], s39 offen lds
    s_add_u32 s39, s39, 7168
    s_add_u32 m0, s40, 9216
    s_nop 0
    buffer_load_dwordx4 v5, s[8:11], s39 offen lds
    s_add_u32 s39, s39, 7168
    s_add_u32 m0, s40, 10240
    s_nop 0
    buffer_load_dwordx4 v5, s[8:11], s39 offen lds
    s_add_u32 s39, s39, 7168
    s_add_u32 m0, s40, 11264
    s_nop 0
    buffer_load_dwordx4 v5, s[8:11], s39 offen lds
    s_add_u32 s39, s39, 7168
    s_add_u32 m0, s40, 12288
    s_nop 0
    buffer_load_dwordx4 v5, s[8:11], s39 offen lds
    s_add_u32 s39, s39, 7168
    s_add_u32 m0, s40, 13312
    s_nop 0
    buffer_load_dwordx4 v5, s[8:11], s39 offen lds
    s_add_u32 s39, s39, 7168
    s_add_u32 m0, s40, 14336
    s_nop 0
    buffer_load_dwordx4 v5, s[8:11], s39 offen lds
    s_add_u32 s39, s39, 7168
    s_add_u32 m0, s40, 15360
    s_nop 0
    buffer_load_dwordx4 v5, s[8:11], s39 offen lds
    s_add_u32 s39, s39, 7168
    s_waitcnt vmcnt(0)
    ds_read_b64_tr_b16 a[128:129], v6 offset:0
    ds_read_b64_tr_b16 a[130:131], v6 offset:512
    ds_read_b64_tr_b16 a[132:133], v6 offset:32
    ds_read_b64_tr_b16 a[134:135], v6 offset:544
    ds_read_b64_tr_b16 a[136:137], v6 offset:64
    ds_read_b64_tr_b16 a[138:139], v6 offset:576
    ds_read_b64_tr_b16 a[140:141], v6 offset:96
    ds_read_b64_tr_b16 a[142:143], v6 offset:608
    ds_read_b64_tr_b16 a[144:145], v6 offset:4096
    ds_read_b64_tr_b16 a[146:147], v6 offset:4608
    ds_read_b64_tr_b16 a[148:149], v6 offset:4128
    ds_read_b64_tr_b16 a[150:151], v6 offset:4640
    ds_read_b64_tr_b16 a[152:153], v6 offset:4160
    ds_read_b64_tr_b16 a[154:155], v6 offset:4672
    ds_read_b64_tr_b16 a[156:157], v6 offset:4192
    ds_read_b64_tr_b16 a[158:159], v6 offset:4704
    ds_read_b64_tr_b16 a[160:161], v6 offset:8192
    ds_read_b64_tr_b16 a[162:163], v6 offset:8704
    ds_read_b64_tr_b16 a[164:165], v6 offset:8224
    ds_read_b64_tr_b16 a[166:167], v6 offset:8736
    ds_read_b64_tr_b16 a[168:169], v6 offset:8256
    ds_read_b64_tr_b16 a[170:171], v6 offset:8768
    ds_read_b64_tr_b16 a[172:173], v6 offset:8288
    ds_read_b64_tr_b16 a[174:175], v6 offset:8800
    ds_read_b64_tr_b16 a[176:177], v6 offset:12288
    ds_read_b64_tr_b16 a[178:179], v6 offset:12800
    ds_read_b64_tr_b16 a[180:181], v6 offset:12320
    ds_read_b64_tr_b16 a[182:183], v6 offset:12832
    ds_read_b64_tr_b16 a[184:185], v6 offset:12352
    ds_read_b64_tr_b16 a[186:187], v6 offset:12864
    ds_read_b64_tr_b16 a[188:189], v6 offset:12384
    ds_read_b64_tr_b16 a[190:191], v6 offset:12896
    s_waitcnt lgkmcnt(0)
    s_add_u32 m0, s40, 0
    s_nop 0
    buffer_load_dwordx4 v5, s[8:11], s39 offen lds
    s_add_u32 s39, s39, 7168
    s_add_u32 m0, s40, 1024
    s_nop 0
    buffer_load_dwordx4 v5, s[8:11], s39 offen lds
    s_add_u32 s39, s39, 7168
    s_add_u32 m0, s40, 2048
    s_nop 0
    buffer_load_dwordx4 v5, s[8:11], s39 offen lds
    s_add_u32 s39, s39, 7168
    s_add_u32 m0, s40, 3072
    s_nop 0
    buffer_load_dwordx4 v5, s[8:11], s39 offen lds
    s_add_u32 s39, s39, 7168
    s_add_u32 m0, s40, 4096
    s_nop 0
    buffer_load_dwordx4 v5, s[8:11], s39 offen lds
    s_add_u32 s39, s39, 7168
    s_add_u32 m0, s40, 5120
    s_nop 0
    buffer_load_dwordx4 v5, s[8:11], s39 offen lds
    s_add_u32 s39, s39, 7168
    s_add_u32 m0, s40, 6144
    s_nop 0
    buffer_load_dwordx4 v5, s[8:11], s39 offen lds
    s_add_u32 s39, s39, 7168
    s_add_u32 m0, s40, 7168
    s_nop 0
    buffer_load_dwordx4 v5, s[8:11], s39 offen lds
    s_add_u32 s39, s39, 7168
    s_waitcnt vmcnt(0)
    ds_read_b64_tr_b16 a[192:193], v6 offset:0
    ds_read_b64_tr_b16 a[194:195], v6 offset:512
    ds_read_b64_tr_b16 a[196:197], v6 offset:32
    ds_read_b64_tr_b16 a[198:199], v6 offset:544
    ds_read_b64_tr_b16 a[200:201], v6 offset:64
    ds_read_b64_tr_b16 a[202:203], v6 offset:576
    ds_read_b64_tr_b16 a[204:205], v6 offset:96
    ds_read_b64_tr_b16 a[206:207], v6 offset:608
    ds_read_b64_tr_b16 a[208:209], v6 offset:4096
    ds_read_b64_tr_b16 a[210:211], v6 offset:4608
    ds_read_b64_tr_b16 a[212:213], v6 offset:4128
    ds_read_b64_tr_b16 a[214:215], v6 offset:4640
    ds_read_b64_tr_b16 a[216:217], v6 offset:4160
    ds_read_b64_tr_b16 a[218:219], v6 offset:4672
    ds_read_b64_tr_b16 a[220:221], v6 offset:4192
    ds_read_b64_tr_b16 a[222:223], v6 offset:4704
    s_waitcnt lgkmcnt(0)
    s_mov_b32 s8, s88
    s_mov_b32 s9, s89
    s_mov_b32 s10, 1835008
    s_mov_b32 s11, 0x00020000
    s_barrier
    v_mul_u32_u24 v8, 272, v3
    v_lshl_add_u32 v8, v4, 4, v8
    s_mul_i32 s36, s17, 8704
    v_add_u32 v8, s36, v8
    v_lshrrev_b32 v5, 3, v0
    s_lshl_b32 s36, s17, 3
    v_add_u32 v5, s36, v5
    v_and_b32 v6, 7, v0
    v_mul_u32_u24 v9, 272, v5
    v_lshl_add_u32 v9, v6, 5, v9
    v_mul_u32_u24 v10, 896, v5
    v_lshl_add_u32 v10, v6, 4, v10
    s_lshl_b32 s36, s43, 7
    v_add_u32 v10, s36, v10
    v_and_b32 v11, 1, v0
    v_mov_b32 v12, 4
    s_add_u32 s36, s36, 128
    v_mul_lo_u32 v11, v11, s36
    s_cmp_lg_u32 s17, 0
    s_cbranch_scc1 WW_33
    v_mbcnt_lo_u32_b32 v253, -1, 0
    v_and_b32 v253, 1, v253
    v_lshlrev_b32 v253, 7, v253
    s_mov_b32 s41, 15238144
    s_mov_b64 exec, 3
WD_34:
    buffer_load_dword v252, v253, s[4:7], s41 offen sc1
    s_waitcnt vmcnt(0)
    v_cmp_gt_u32 vcc, 0x40, v252
    s_cbranch_vccz WD_34_ok
    s_sleep 4
    s_sub_u32 s35, s35, 1
    s_cmp_lg_u32 s35, 0
    s_cbranch_scc1 WD_34
    s_branch L_exit
WD_34_ok:
    s_mov_b64 exec, -1
WW_33:
    s_barrier
O2_loop:
    s_cmp_lg_u32 s17, 0
    s_cbranch_scc1 W_35_ok
    s_lshl_b32 s41, s20, 11
    s_add_u32 s41, s41, 15270144
W_35:
    buffer_load_dword v252, v251, s[4:7], s41 offen sc1
    s_waitcnt vmcnt(0)
    v_cmp_gt_u32 vcc, 7, v252
    s_cbranch_vccz W_35_ok
    s_sleep 4
    s_sub_u32 s35, s35, 1
    s_cmp_lg_u32 s35, 0
    s_cbranch_scc1 W_35
    s_endpgm
W_35_ok:
    s_waitcnt vmcnt(0)
    s_barrier
    s_mul_i32 s36, s20, 114688
    s_mul_i32 s37, s17, 28672
    s_add_u32 s36, s36, s37
    s_add_u32 s36, s36, 100663296
    buffer_load_dwordx4 v[48:51], v250, s[4:7], s36 offen offset:0 sc1
    buffer_load_dwordx4 v[52:55], v250, s[4:7], s36 offen offset:1024 sc1
    buffer_load_dwordx4 v[56:59], v250, s[4:7], s36 offen offset:2048 sc1
    buffer_load_dwordx4 v[60:63], v250, s[4:7], s36 offen offset:3072 sc1
    s_add_u32 s36, s36, 4096
    buffer_load_dwordx4 v[64:67], v250, s[4:7], s36 offen offset:0 sc1
    buffer_load_dwordx4 v[68:71], v250, s[4:7], s36 offen offset:1024 sc1
    buffer_load_dwordx4 v[72:75], v250, s[4:7], s36 offen offset:2048 sc1
    buffer_load_dwordx4 v[76:79], v250, s[4:7], s36 offen offset:3072 sc1
    s_add_u32 s36, s36, 4096
    buffer_load_dwordx4 v[80:83], v250, s[4:7], s36 offen offset:0 sc1
    buffer_load_dwordx4 v[84:87], v250, s[4:7], s36 offen offset:1024 sc1
    buffer_load_dwordx4 v[88:91], v250, s[4:7], s36 offen offset:2048 sc1
    buffer_load_dwordx4 v[92:95], v250, s[4:7], s36 offen offset:3072 sc1
    s_add_u32 s36, s36, 4096
    buffer_load_dwordx4 v[96:99], v250, s[4:7], s36 offen offset:0 sc1
    buffer_load_dwordx4 v[100:103], v250, s[4:7], s36 offen offset:1024 sc1
    buffer_load_dwordx4 v[104:107], v250, s[4:7], s36 offen offset:2048 sc1
    buffer_load_dwordx4 v[108:111], v250, s[4:7], s36 offen offset:3072 sc1
    s_add_u32 s36, s36, 4096
    buffer_load_dwordx4 v[112:115], v250, s[4:7], s36 offen offset:0 sc1
    buffer_load_dwordx4 v[116:119], v250, s[4:7], s36 offen offset:1024 sc1
    buffer_load_dwordx4 v[120:123], v250, s[4:7], s36 offen offset:2048 sc1
    buffer_load_dwordx4 v[124:127], v250, s[4:7], s36 offen offset:3072 sc1
    s_add_u32 s36, s36, 4096
    buffer_load_dwordx4 v[128:131], v250, s[4:7], s36 offen offset:0 sc1
    buffer_load_dwordx4 v[132:135], v250, s[4:7], s36 offen offset:1024 sc1
    buffer_load_dwordx4 v[136:139], v250, s[4:7], s36 offen offset:2048 sc1
    buffer_load_dwordx4 v[140:143], v250, s[4:7], s36 offen offset:3072 sc1
    s_add_u32 s36, s36, 4096
    buffer_load_dwordx4 v[144:147], v250, s[4:7], s36 offen offset:0 sc1
    buffer_load_dwordx4 v[148:151], v250, s[4:7], s36 offen offset:1024 sc1
    buffer_load_dwordx4 v[152:155], v250, s[4:7], s36 offen offset:2048 sc1
    buffer_load_dwordx4 v[156:159], v250, s[4:7], s36 offen offset:3072 sc1
    s_waitcnt vmcnt(27)
    v_mfma_f32_16x16x32_bf16 v[16:19], a[0:3], v[48:51], 0
    v_mfma_f32_16x16x32_bf16 v[24:27], a[4:7], v[48:51], 0
    v_mfma_f32_16x16x32_bf16 v[32:35], a[8:11], v[48:51], 0
    v_mfma_f32_16x16x32_bf16 v[40:43], a[12:15], v[48:51], 0
    s_waitcnt vmcnt(26)
    v_mfma_f32_16x16x32_bf16 v[20:23], a[0:3], v[52:55], 0
    v_mfma_f32_16x16x32_bf16 v[28:31], a[4:7], v[52:55], 0
    v_mfma_f32_16x16x32_bf16 v[36:39], a[8:11], v[52:55], 0
    v_mfma_f32_16x16x32_bf16 v[44:47], a[12:15], v[52:55], 0
    s_waitcnt vmcnt(25)
    v_mfma_f32_16x16x32_bf16 v[16:19], a[16:19], v[56:59], v[16:19]
    v_mfma_f32_16x16x32_bf16 v[24:27], a[20:23], v[56:59], v[24:27]
    v_mfma_f32_16x16x32_bf16 v[32:35], a[24:27], v[56:59], v[32:35]
    v_mfma_f32_16x16x32_bf16 v[40:43], a[28:31], v[56:59], v[40:43]
    s_waitcnt vmcnt(24)
    v_mfma_f32_16x16x32_bf16 v[20:23], a[16:19], v[60:63], v[20:23]
    v_mfma_f32_16x16x32_bf16 v[28:31], a[20:23], v[60:63], v[28:31]
    v_mfma_f32_16x16x32_bf16 v[36:39], a[24:27], v[60:63], v[36:39]
    v_mfma_f32_16x16x32_bf16 v[44:47], a[28:31], v[60:63], v[44:47]
    s_waitcnt vmcnt(23)
    v_mfma_f32_16x16x32_bf16 v[16:19], a[32:35], v[64:67], v[16:19]
    v_mfma_f32_16x16x32_bf16 v[24:27], a[36:39], v[64:67], v[24:27]
    v_mfma_f32_16x16x32_bf16 v[32:35], a[40:43], v[64:67], v[32:35]
    v_mfma_f32_16x16x32_bf16 v[40:43], a[44:47], v[64:67], v[40:43]
    s_waitcnt vmcnt(22)
    v_mfma_f32_16x16x32_bf16 v[20:23], a[32:35], v[68:71], v[20:23]
    v_mfma_f32_16x16x32_bf16 v[28:31], a[36:39], v[68:71], v[28:31]
    v_mfma_f32_16x16x32_bf16 v[36:39], a[40:43], v[68:71], v[36:39]
    v_mfma_f32_16x16x32_bf16 v[44:47], a[44:47], v[68:71], v[44:47]
    s_waitcnt vmcnt(21)
    v_mfma_f32_16x16x32_bf16 v[16:19], a[48:51], v[72:75], v[16:19]
    v_mfma_f32_16x16x32_bf16 v[24:27], a[52:55], v[72:75], v[24:27]
    v_mfma_f32_16x16x32_bf16 v[32:35], a[56:59], v[72:75], v[32:35]
    v_mfma_f32_16x16x32_bf16 v[40:43], a[60:63], v[72:75], v[40:43]
    s_waitcnt vmcnt(20)
    v_mfma_f32_16x16x32_bf16 v[20:23], a[48:51], v[76:79], v[20:23]
    v_mfma_f32_16x16x32_bf16 v[28:31], a[52:55], v[76:79], v[28:31]
    v_mfma_f32_16x16x32_bf16 v[36:39], a[56:59], v[76:79], v[36:39]
    v_mfma_f32_16x16x32_bf16 v[44:47], a[60:63], v[76:79], v[44:47]
    s_waitcnt vmcnt(19)
    v_mfma_f32_16x16x32_bf16 v[16:19], a[64:67], v[80:83], v[16:19]
    v_mfma_f32_16x16x32_bf16 v[24:27], a[68:71], v[80:83], v[24:27]
    v_mfma_f32_16x16x32_bf16 v[32:35], a[72:75], v[80:83], v[32:35]
    v_mfma_f32_16x16x32_bf16 v[40:43], a[76:79], v[80:83], v[40:43]
    s_waitcnt vmcnt(18)
    v_mfma_f32_16x16x32_bf16 v[20:23], a[64:67], v[84:87], v[20:23]
    v_mfma_f32_16x16x32_bf16 v[28:31], a[68:71], v[84:87], v[28:31]
    v_mfma_f32_16x16x32_bf16 v[36:39], a[72:75], v[84:87], v[36:39]
    v_mfma_f32_16x16x32_bf16 v[44:47], a[76:79], v[84:87], v[44:47]
    s_waitcnt vmcnt(17)
    v_mfma_f32_16x16x32_bf16 v[16:19], a[80:83], v[88:91], v[16:19]
    v_mfma_f32_16x16x32_bf16 v[24:27], a[84:87], v[88:91], v[24:27]
    v_mfma_f32_16x16x32_bf16 v[32:35], a[88:91], v[88:91], v[32:35]
    v_mfma_f32_16x16x32_bf16 v[40:43], a[92:95], v[88:91], v[40:43]
    s_waitcnt vmcnt(16)
    v_mfma_f32_16x16x32_bf16 v[20:23], a[80:83], v[92:95], v[20:23]
    v_mfma_f32_16x16x32_bf16 v[28:31], a[84:87], v[92:95], v[28:31]
    v_mfma_f32_16x16x32_bf16 v[36:39], a[88:91], v[92:95], v[36:39]
    v_mfma_f32_16x16x32_bf16 v[44:47], a[92:95], v[92:95], v[44:47]
    s_waitcnt vmcnt(15)
    v_mfma_f32_16x16x32_bf16 v[16:19], a[96:99], v[96:99], v[16:19]
    v_mfma_f32_16x16x32_bf16 v[24:27], a[100:103], v[96:99], v[24:27]
    v_mfma_f32_16x16x32_bf16 v[32:35], a[104:107], v[96:99], v[32:35]
    v_mfma_f32_16x16x32_bf16 v[40:43], a[108:111], v[96:99], v[40:43]
    s_waitcnt vmcnt(14)
    v_mfma_f32_16x16x32_bf16 v[20:23], a[96:99], v[100:103], v[20:23]
    v_mfma_f32_16x16x32_bf16 v[28:31], a[100:103], v[100:103], v[28:31]
    v_mfma_f32_16x16x32_bf16 v[36:39], a[104:107], v[100:103], v[36:39]
    v_mfma_f32_16x16x32_bf16 v[44:47], a[108:111], v[100:103], v[44:47]
    s_waitcnt vmcnt(13)
    v_mfma_f32_16x16x32_bf16 v[16:19], a[112:115], v[104:107], v[16:19]
    v_mfma_f32_16x16x32_bf16 v[24:27], a[116:119], v[104:107], v[24:27]
    v_mfma_f32_16x16x32_bf16 v[32:35], a[120:123], v[104:107], v[32:35]
    v_mfma_f32_16x16x32_bf16 v[40:43], a[124:127], v[104:107], v[40:43]
    s_waitcnt vmcnt(12)
    v_mfma_f32_16x16x32_bf16 v[20:23], a[112:115], v[108:111], v[20:23]
    v_mfma_f32_16x16x32_bf16 v[28:31], a[116:119], v[108:111], v[28:31]
    v_mfma_f32_16x16x32_bf16 v[36:39], a[120:123], v[108:111], v[36:39]
    v_mfma_f32_16x16x32_bf16 v[44:47], a[124:127], v[108:111], v[44:47]
    s_waitcnt vmcnt(11)
    v_mfma_f32_16x16x32_bf16 v[16:19], a[128:131], v[112:115], v[16:19]
    v_mfma_f32_16x16x32_bf16 v[24:27], a[132:135], v[112:115], v[24:27]
    v_mfma_f32_16x16x32_bf16 v[32:35], a[136:139], v[112:115], v[32:35]
    v_mfma_f32_16x16x32_bf16 v[40:43], a[140:143], v[112:115], v[40:43]
    s_waitcnt vmcnt(10)
    v_mfma_f32_16x16x32_bf16 v[20:23], a[128:131], v[116:119], v[20:23]
    v_mfma_f32_16x16x32_bf16 v[28:31], a[132:135], v[116:119], v[28:31]
    v_mfma_f32_16x16x32_bf16 v[36:39], a[136:139], v[116:119], v[36:39]
    v_mfma_f32_16x16x32_bf16 v[44:47], a[140:143], v[116:119], v[44:47]
    s_waitcnt vmcnt(9)
    v_mfma_f32_16x16x32_bf16 v[16:19], a[144:147], v[120:123], v[16:19]
    v_mfma_f32_16x16x32_bf16 v[24:27], a[148:151], v[120:123], v[24:27]
    v_mfma_f32_16x16x32_bf16 v[32:35], a[152:155], v[120:123], v[32:35]
    v_mfma_f32_16x16x32_bf16 v[40:43], a[156:159], v[120:123], v[40:43]
    s_waitcnt vmcnt(8)
    v_mfma_f32_16x16x32_bf16 v[20:23], a[144:147], v[124:127], v[20:23]
    v_mfma_f32_16x16x32_bf16 v[28:31], a[148:151], v[124:127], v[28:31]
    v_mfma_f32_16x16x32_bf16 v[36:39], a[152:155], v[124:127], v[36:39]
    v_mfma_f32_16x16x32_bf16 v[44:47], a[156:159], v[124:127], v[44:47]
    s_waitcnt vmcnt(7)
    v_mfma_f32_16x16x32_bf16 v[16:19], a[160:163], v[128:131], v[16:19]
    v_mfma_f32_16x16x32_bf16 v[24:27], a[164:167], v[128:131], v[24:27]
    v_mfma_f32_16x16x32_bf16 v[32:35], a[168:171], v[128:131], v[32:35]
    v_mfma_f32_16x16x32_bf16 v[40:43], a[172:175], v[128:131], v[40:43]
    s_waitcnt vmcnt(6)
    v_mfma_f32_16x16x32_bf16 v[20:23], a[160:163], v[132:135], v[20:23]
    v_mfma_f32_16x16x32_bf16 v[28:31], a[164:167], v[132:135], v[28:31]
    v_mfma_f32_16x16x32_bf16 v[36:39], a[168:171], v[132:135], v[36:39]
    v_mfma_f32_16x16x32_bf16 v[44:47], a[172:175], v[132:135], v[44:47]
    s_waitcnt vmcnt(5)
    v_mfma_f32_16x16x32_bf16 v[16:19], a[176:179], v[136:139], v[16:19]
    v_mfma_f32_16x16x32_bf16 v[24:27], a[180:183], v[136:139], v[24:27]
    v_mfma_f32_16x16x32_bf16 v[32:35], a[184:187], v[136:139], v[32:35]
    v_mfma_f32_16x16x32_bf16 v[40:43], a[188:191], v[136:139], v[40:43]
    s_waitcnt vmcnt(4)
    v_mfma_f32_16x16x32_bf16 v[20:23], a[176:179], v[140:143], v[20:23]
    v_mfma_f32_16x16x32_bf16 v[28:31], a[180:183], v[140:143], v[28:31]
    v_mfma_f32_16x16x32_bf16 v[36:39], a[184:187], v[140:143], v[36:39]
    v_mfma_f32_16x16x32_bf16 v[44:47], a[188:191], v[140:143], v[44:47]
    s_waitcnt vmcnt(3)
    v_mfma_f32_16x16x32_bf16 v[16:19], a[192:195], v[144:147], v[16:19]
    v_mfma_f32_16x16x32_bf16 v[24:27], a[196:199], v[144:147], v[24:27]
    v_mfma_f32_16x16x32_bf16 v[32:35], a[200:203], v[144:147], v[32:35]
    v_mfma_f32_16x16x32_bf16 v[40:43], a[204:207], v[144:147], v[40:43]
    s_waitcnt vmcnt(2)
    v_mfma_f32_16x16x32_bf16 v[20:23], a[192:195], v[148:151], v[20:23]
    v_mfma_f32_16x16x32_bf16 v[28:31], a[196:199], v[148:151], v[28:31]
    v_mfma_f32_16x16x32_bf16 v[36:39], a[200:203], v[148:151], v[36:39]
    v_mfma_f32_16x16x32_bf16 v[44:47], a[204:207], v[148:151], v[44:47]
    s_waitcnt vmcnt(1)
    v_mfma_f32_16x16x32_bf16 v[16:19], a[208:211], v[152:155], v[16:19]
    v_mfma_f32_16x16x32_bf16 v[24:27], a[212:215], v[152:155], v[24:27]
    v_mfma_f32_16x16x32_bf16 v[32:35], a[216:219], v[152:155], v[32:35]
    v_mfma_f32_16x16x32_bf16 v[40:43], a[220:223], v[152:155], v[40:43]
    s_waitcnt vmcnt(0)
    v_mfma_f32_16x16x32_bf16 v[20:23], a[208:211], v[156:159], v[20:23]
    v_mfma_f32_16x16x32_bf16 v[28:31], a[212:215], v[156:159], v[28:31]
    v_mfma_f32_16x16x32_bf16 v[36:39], a[216:219], v[156:159], v[36:39]
    v_mfma_f32_16x16x32_bf16 v[44:47], a[220:223], v[156:159], v[44:47]
    s_cmp_lg_u32 s17, 0
    s_cbranch_scc1 W_36_ok
    s_lshl_b32 s41, s20, 11
    s_add_u32 s41, s41, 15269888
W_36:
    buffer_load_dword v252, v251, s[4:7], s41 offen sc1
    s_waitcnt vmcnt(0)
    v_cmp_gt_u32 vcc, 56, v252
    s_cbranch_vccz W_36_ok
    s_sleep 4
    s_sub_u32 s35, s35, 1
    s_cmp_lg_u32 s35, 0
    s_cbranch_scc1 W_36
    s_endpgm
W_36_ok:
    s_waitcnt vmcnt(0)
    s_barrier
    s_mul_i32 s36, s20, 458752
    s_lshl_b32 s37, s43, 16
    s_add_u32 s36, s36, s37
    s_lshl_b32 s37, s17, 12
    s_add_u32 s36, s36, s37
    s_add_u32 s36, s36, 33554432
    buffer_load_dwordx4 v[160:163], v250, s[4:7], s36 offen offset:0 sc1
    buffer_load_dwordx4 v[176:179], v250, s[4:7], s36 offen offset:1024 sc1
    buffer_load_dwordx4 v[192:195], v250, s[4:7], s36 offen offset:2048 sc1
    buffer_load_dwordx4 v[208:211], v250, s[4:7], s36 offen offset:3072 sc1
    s_add_u32 s36, s36, 16384
    buffer_load_dwordx4 v[164:167], v250, s[4:7], s36 offen offset:0 sc1
    buffer_load_dwordx4 v[180:183], v250, s[4:7], s36 offen offset:1024 sc1
    buffer_load_dwordx4 v[196:199], v250, s[4:7], s36 offen offset:2048 sc1
    buffer_load_dwordx4 v[212:215], v250, s[4:7], s36 offen offset:3072 sc1
    s_add_u32 s36, s36, 16384
    buffer_load_dwordx4 v[168:171], v250, s[4:7], s36 offen offset:0 sc1
    buffer_load_dwordx4 v[184:187], v250, s[4:7], s36 offen offset:1024 sc1
    buffer_load_dwordx4 v[200:203], v250, s[4:7], s36 offen offset:2048 sc1
    buffer_load_dwordx4 v[216:219], v250, s[4:7], s36 offen offset:3072 sc1
    s_add_u32 s36, s36, 16384
    buffer_load_dwordx4 v[172:175], v250, s[4:7], s36 offen offset:0 sc1
    buffer_load_dwordx4 v[188:191], v250, s[4:7], s36 offen offset:1024 sc1
    buffer_load_dwordx4 v[204:207], v250, s[4:7], s36 offen offset:2048 sc1
    buffer_load_dwordx4 v[220:223], v250, s[4:7], s36 offen offset:3072 sc1
    s_cmp_lg_u32 s17, 0
    s_cbranch_scc1 W_37_ok
    s_lshl_b32 s41, s20, 11
    s_add_u32 s41, s41, 15270272
W_37:
    buffer_load_dword v252, v11, s[4:7], s41 offen sc1
    s_waitcnt vmcnt(0)
    v_cmp_gt_u32 vcc, v12, v252
    s_cbranch_vccz W_37_ok
    s_sleep 4
    s_sub_u32 s35, s35, 1
    s_cmp_lg_u32 s35, 0
    s_cbranch_scc1 W_37
    s_endpgm
W_37_ok:
    s_waitcnt vmcnt(0)
    s_barrier
    s_mul_i32 s36, s20, 114688
    s_lshl_b32 s37, s43, 14
    s_add_u32 s36, s36, s37
    s_lshl_b32 s37, s17, 10
    s_add_u32 s36, s36, s37
    s_add_u32 s36, s36, 16777216
    buffer_load_dwordx4 v[88:91], v250, s[4:7], s36 offen sc1
    s_add_u32 s36, s36, 4096
    buffer_load_dwordx4 v[92:95], v250, s[4:7], s36 offen sc1
    s_add_u32 s36, s36, 4096
    buffer_load_dwordx4 v[96:99], v250, s[4:7], s36 offen sc1
    s_add_u32 s36, s36, 4096
    buffer_load_dwordx4 v[100:103], v250, s[4:7], s36 offen sc1
    s_mul_i32 s36, s20, 40960
    s_add_u32 s36, s36, 29360128
    s_lshl_b32 s37, s17, 13
    s_add_u32 s37, s36, s37
    s_add_u32 s38, s37, 4096
    s_lshl_b32 s39, s17, 11
    s_add_u32 s39, s39, s36
    s_add_u32 s39, s39, 32768
    buffer_load_dwordx4 v[48:51], v250, s[4:7], s37 offen offset:0 sc1
    buffer_load_dwordx4 v[52:55], v250, s[4:7], s37 offen offset:1024 sc1
    buffer_load_dwordx4 v[56:59], v250, s[4:7], s37 offen offset:2048 sc1
    buffer_load_dwordx4 v[60:63], v250, s[4:7], s37 offen offset:3072 sc1
    buffer_load_dwordx4 v[64:67], v250, s[4:7], s38 offen offset:0 sc1
    buffer_load_dwordx4 v[68:71], v250, s[4:7], s38 offen offset:1024 sc1
    buffer_load_dwordx4 v[72:75], v250, s[4:7], s38 offen offset:2048 sc1
    buffer_load_dwordx4 v[76:79], v250, s[4:7], s38 offen offset:3072 sc1
    buffer_load_dwordx4 v[80:83], v250, s[4:7], s39 offen offset:0 sc1
    buffer_load_dwordx4 v[84:87], v250, s[4:7], s39 offen offset:1024 sc1
    s_waitcnt vmcnt(9)
    v_mfma_f32_16x16x32_bf16 v[16:19], v[160:163], v[48:51], v[16:19]
    v_mfma_f32_16x16x32_bf16 v[24:27], v[164:167], v[48:51], v[24:27]
    v_mfma_f32_16x16x32_bf16 v[32:35], v[168:171], v[48:51], v[32:35]
    v_mfma_f32_16x16x32_bf16 v[40:43], v[172:175], v[48:51], v[40:43]
    s_waitcnt vmcnt(8)
    v_mfma_f32_16x16x32_bf16 v[20:23], v[160:163], v[52:55], v[20:23]
    v_mfma_f32_16x16x32_bf16 v[28:31], v[164:167], v[52:55], v[28:31]
    v_mfma_f32_16x16x32_bf16 v[36:39], v[168:171], v[52:55], v[36:39]
    v_mfma_f32_16x16x32_bf16 v[44:47], v[172:175], v[52:55], v[44:47]
    s_waitcnt vmcnt(7)
    v_mfma_f32_16x16x32_bf16 v[16:19], v[176:179], v[56:59], v[16:19]
    v_mfma_f32_16x16x32_bf16 v[24:27], v[180:183], v[56:59], v[24:27]
    v_mfma_f32_16x16x32_bf16 v[32:35], v[184:187], v[56:59], v[32:35]
    v_mfma_f32_16x16x32_bf16 v[40:43], v[188:191], v[56:59], v[40:43]
    s_waitcnt vmcnt(6)
    v_mfma_f32_16x16x32_bf16 v[20:23], v[176:179], v[60:63], v[20:23]
    v_mfma_f32_16x16x32_bf16 v[28:31], v[180:183], v[60:63], v[28:31]
    v_mfma_f32_16x16x32_bf16 v[36:39], v[184:187], v[60:63], v[36:39]
    v_mfma_f32_16x16x32_bf16 v[44:47], v[188:191], v[60:63], v[44:47]
    s_waitcnt vmcnt(5)
    v_mfma_f32_16x16x32_bf16 v[16:19], v[192:195], v[64:67], v[16:19]
    v_mfma_f32_16x16x32_bf16 v[24:27], v[196:199], v[64:67], v[24:27]
    v_mfma_f32_16x16x32_bf16 v[32:35], v[200:203], v[64:67], v[32:35]
    v_mfma_f32_16x16x32_bf16 v[40:43], v[204:207], v[64:67], v[40:43]
    s_waitcnt vmcnt(4)
    v_mfma_f32_16x16x32_bf16 v[20:23], v[192:195], v[68:71], v[20:23]
    v_mfma_f32_16x16x32_bf16 v[28:31], v[196:199], v[68:71], v[28:31]
    v_mfma_f32_16x16x32_bf16 v[36:39], v[200:203], v[68:71], v[36:39]
    v_mfma_f32_16x16x32_bf16 v[44:47], v[204:207], v[68:71], v[44:47]
    s_waitcnt vmcnt(3)
    v_mfma_f32_16x16x32_bf16 v[16:19], v[208:211], v[72:75], v[16:19]
    v_mfma_f32_16x16x32_bf16 v[24:27], v[212:215], v[72:75], v[24:27]
    v_mfma_f32_16x16x32_bf16 v[32:35], v[216:219], v[72:75], v[32:35]
    v_mfma_f32_16x16x32_bf16 v[40:43], v[220:223], v[72:75], v[40:43]
    s_waitcnt vmcnt(2)
    v_mfma_f32_16x16x32_bf16 v[20:23], v[208:211], v[76:79], v[20:23]
    v_mfma_f32_16x16x32_bf16 v[28:31], v[212:215], v[76:79], v[28:31]
    v_mfma_f32_16x16x32_bf16 v[36:39], v[216:219], v[76:79], v[36:39]
    v_mfma_f32_16x16x32_bf16 v[44:47], v[220:223], v[76:79], v[44:47]
    s_waitcnt vmcnt(0)
    s_nop 0
    v_mfma_f32_16x16x32_bf16 v[16:19], v[88:91], v[80:83], v[16:19]
    v_mfma_f32_16x16x32_bf16 v[20:23], v[88:91], v[84:87], v[20:23]
    s_nop 0
    v_mfma_f32_16x16x32_bf16 v[24:27], v[92:95], v[80:83], v[24:27]
    v_mfma_f32_16x16x32_bf16 v[28:31], v[92:95], v[84:87], v[28:31]
    s_nop 0
    v_mfma_f32_16x16x32_bf16 v[32:35], v[96:99], v[80:83], v[32:35]
    v_mfma_f32_16x16x32_bf16 v[36:39], v[96:99], v[84:87], v[36:39]
    s_nop 0
    v_mfma_f32_16x16x32_bf16 v[40:43], v[100:103], v[80:83], v[40:43]
    v_mfma_f32_16x16x32_bf16 v[44:47], v[100:103], v[84:87], v[44:47]
    s_nop 1
    ds_write_b128 v8, v[16:19] offset:0
    ds_write_b128 v8, v[20:23] offset:4352
    ds_write_b128 v8, v[24:27] offset:64
    ds_write_b128 v8, v[28:31] offset:4416
    ds_write_b128 v8, v[32:35] offset:128
    ds_write_b128 v8, v[36:39] offset:4480
    s_nop 3
    ds_write_b128 v8, v[40:43] offset:192
    ds_write_b128 v8, v[44:47] offset:4544
    s_waitcnt lgkmcnt(0)
    s_barrier
    ds_read_b128 v[160:163], v9 offset:0
    ds_read_b128 v[164:167], v9 offset:16
    ds_read_b128 v[168:171], v9 offset:8704
    ds_read_b128 v[172:175], v9 offset:8720
    ds_read_b128 v[176:179], v9 offset:17408
    ds_read_b128 v[180:183], v9 offset:17424
    ds_read_b128 v[184:187], v9 offset:26112
    ds_read_b128 v[188:191], v9 offset:26128
    s_mul_i32 s36, s20, 28672
    s_waitcnt lgkmcnt(4)
    v_add_f32 v160, v160, v168
    v_add_f32 v161, v161, v169
    v_add_f32 v162, v162, v170
    v_add_f32 v163, v163, v171
    v_add_f32 v164, v164, v172
    v_add_f32 v165, v165, v173
    v_add_f32 v166, v166, v174
    v_add_f32 v167, v167, v175
    s_waitcnt lgkmcnt(2)
    v_add_f32 v160, v160, v176
    v_add_f32 v161, v161, v177
    v_add_f32 v162, v162, v178
    v_add_f32 v163, v163, v179
    v_add_f32 v164, v164, v180
    v_add_f32 v165, v165, v181
    v_add_f32 v166, v166, v182
    v_add_f32 v167, v167, v183
    s_waitcnt lgkmcnt(0)
    v_add_f32 v160, v160, v184
    v_add_f32 v161, v161, v185
    v_add_f32 v162, v162, v186
    v_add_f32 v163, v163, v187
    v_add_f32 v164, v164, v188
    v_add_f32 v165, v165, v189
    v_add_f32 v166, v166, v190
    v_add_f32 v167, v167, v191
    v_cvt_pk_bf16_f32 v192, v160, v161
    v_cvt_pk_bf16_f32 v193, v162, v163
    v_cvt_pk_bf16_f32 v194, v164, v165
    v_cvt_pk_bf16_f32 v195, v166, v167
    buffer_store_dwordx4 v[192:195], v10, s[8:11], s36 offen
    s_barrier
    s_add_u32 s20, s20, 6
    s_cmp_lt_u32 s20, 64
    s_cbranch_scc1 O2_loop
    s_branch L_next
L_team:
    s_lshr_b32 s18, s16, 1
    s_and_b32 s19, s16, 1
    s_sub_u32 s36, s16, 28
    s_cmp_ge_u32 s16, 28
    s_cselect_b32 s21, s36, s16
    s_mov_b32 s22, 15204352
    s_mov_b32 s20, 0
    s_mov_b32 s24, 14680064
    s_mov_b32 s25, 14745600
    s_mov_b32 s26, 14876672
    s_mov_b32 s27, 14811136
    v_and_b32 v60, 63, v0
    v_and_b32 v61, 15, v60
    v_lshrrev_b32 v62, 4, v60
    v_lshlrev_b32 v0, 4, v60
    v_and_b32 v63, 1, v60
    v_cmp_eq_u32 vcc, 1, v63
    v_mov_b32 v1, 0x44444444
    v_mov_b32 v63, 0xeeeeeeee
    v_cndmask_b32 v1, v1, v63, vcc
    v_mov_b32 v56, 0
    v_mov_b32 v57, 16512
    ds_write_b32 v57, v56
    s_waitcnt lgkmcnt(0)
    s_barrier
    s_cmp_eq_u32 s17, 3
    s_cbranch_scc1 W3_entry
    s_cmp_eq_u32 s17, 2
    s_cbranch_scc1 Y2_entry
    s_cmp_eq_u32 s17, 1
    s_cbranch_scc1 Y1_entry
    v_mov_b32 v57, 16512
Y0_wa:
    ds_read_b32 v56, v57
    s_waitcnt lgkmcnt(0)
    v_cmp_gt_u32 vcc, 1, v56
    s_cbranch_vccz Y0_wa_ok
    s_sleep 1
    s_sub_u32 s35, s35, 1
    s_cmp_lg_u32 s35, 0
    s_cbranch_scc1 Y0_wa
    s_branch L_team_done
Y0_wa_ok:
    s_mul_i32 s36, s16, 200704
    s_add_u32 s36, s36, 0
    buffer_load_dwordx4 a[0:3], v0, s[4:7], s36 offen offset:0 sc1
    buffer_load_dwordx4 a[4:7], v0, s[4:7], s36 offen offset:1024 sc1
    buffer_load_dwordx4 a[8:11], v0, s[4:7], s36 offen offset:2048 sc1
    buffer_load_dwordx4 a[12:15], v0, s[4:7], s36 offen offset:3072 sc1
    s_add_u32 s36, s36, 4096
    buffer_load_dwordx4 a[16:19], v0, s[4:7], s36 offen offset:0 sc1
    buffer_load_dwordx4 a[20:23], v0, s[4:7], s36 offen offset:1024 sc1
    buffer_load_dwordx4 a[24:27], v0, s[4:7], s36 offen offset:2048 sc1
    buffer_load_dwordx4 a[28:31], v0, s[4:7], s36 offen offset:3072 sc1
    s_add_u32 s36, s36, 4096
    buffer_load_dwordx4 a[32:35], v0, s[4:7], s36 offen offset:0 sc1
    buffer_load_dwordx4 a[36:39], v0, s[4:7], s36 offen offset:1024 sc1
    buffer_load_dwordx4 a[40:43], v0, s[4:7], s36 offen offset:2048 sc1
    buffer_load_dwordx4 a[44:47], v0, s[4:7], s36 offen offset:3072 sc1
    s_add_u32 s36, s36, 4096
    buffer_load_dwordx4 a[48:51], v0, s[4:7], s36 offen offset:0 sc1
    buffer_load_dwordx4 a[52:55], v0, s[4:7], s36 offen offset:1024 sc1
    buffer_load_dwordx4 a[56:59], v0, s[4:7], s36 offen offset:2048 sc1
    buffer_load_dwordx4 a[60:63], v0, s[4:7], s36 offen offset:3072 sc1
    s_add_u32 s36, s36, 4096
    buffer_load_dwordx4 a[64:67], v0, s[4:7], s36 offen offset:0 sc1
    buffer_load_dwordx4 a[68:71], v0, s[4:7], s36 offen offset:1024 sc1
    buffer_load_dwordx4 a[72:75], v0, s[4:7], s36 offen offset:2048 sc1
    buffer_load_dwordx4 a[76:79], v0, s[4:7], s36 offen offset:3072 sc1
    s_add_u32 s36, s36, 4096
    buffer_load_dwordx4 a[80:83], v0, s[4:7], s36 offen offset:0 sc1
    buffer_load_dwordx4 a[84:87], v0, s[4:7], s36 offen offset:1024 sc1
    buffer_load_dwordx4 a[88:91], v0, s[4:7], s36 offen offset:2048 sc1
    buffer_load_dwordx4 a[92:95], v0, s[4:7], s36 offen offset:3072 sc1
    s_add_u32 s36, s36, 4096
    buffer_load_dwordx4 a[96:99], v0, s[4:7], s36 offen offset:0 sc1
    buffer_load_dwordx4 a[100:103], v0, s[4:7], s36 offen offset:1024 sc1
    buffer_load_dwordx4 a[104:107], v0, s[4:7], s36 offen offset:2048 sc1
    buffer_load_dwordx4 a[108:111], v0, s[4:7], s36 offen offset:3072 sc1
    s_add_u32 s36, s36, 4096
    buffer_load_dwordx4 a[112:115], v0, s[4:7], s36 offen offset:0 sc1
    buffer_load_dwordx4 a[116:119], v0, s[4:7], s36 offen offset:1024 sc1
    buffer_load_dwordx4 a[120:123], v0, s[4:7], s36 offen offset:2048 sc1
    buffer_load_dwordx4 a[124:127], v0, s[4:7], s36 offen offset:3072 sc1
    s_add_u32 s36, s36, 4096
    buffer_load_dwordx4 a[128:131], v0, s[4:7], s36 offen offset:0 sc1
    buffer_load_dwordx4 a[132:135], v0, s[4:7], s36 offen offset:1024 sc1
    buffer_load_dwordx4 a[136:139], v0, s[4:7], s36 offen offset:2048 sc1
    buffer_load_dwordx4 a[140:143], v0, s[4:7], s36 offen offset:3072 sc1
    s_add_u32 s36, s36, 4096
    buffer_load_dwordx4 a[144:147], v0, s[4:7], s36 offen offset:0 sc1
    buffer_load_dwordx4 a[148:151], v0, s[4:7], s36 offen offset:1024 sc1
    buffer_load_dwordx4 a[152:155], v0, s[4:7], s36 offen offset:2048 sc1
    buffer_load_dwordx4 a[156:159], v0, s[4:7], s36 offen offset:3072 sc1
    s_add_u32 s36, s36, 4096
    buffer_load_dwordx4 a[160:163], v0, s[4:7], s36 offen offset:0 sc1
    buffer_load_dwordx4 a[164:167], v0, s[4:7], s36 offen offset:1024 sc1
    buffer_load_dwordx4 a[168:171], v0, s[4:7], s36 offen offset:2048 sc1
    buffer_load_dwordx4 a[172:175], v0, s[4:7], s36 offen offset:3072 sc1
    s_add_u32 s36, s36, 4096
    buffer_load_dwordx4 a[176:179], v0, s[4:7], s36 offen offset:0 sc1
    buffer_load_dwordx4 a[180:183], v0, s[4:7], s36 offen offset:1024 sc1
    buffer_load_dwordx4 a[184:187], v0, s[4:7], s36 offen offset:2048 sc1
    buffer_load_dwordx4 a[188:191], v0, s[4:7], s36 offen offset:3072 sc1
    s_add_u32 s36, s36, 4096
    buffer_load_dwordx4 a[192:195], v0, s[4:7], s36 offen offset:0 sc1
    buffer_load_dwordx4 a[196:199], v0, s[4:7], s36 offen offset:1024 sc1
    buffer_load_dwordx4 a[200:203], v0, s[4:7], s36 offen offset:2048 sc1
    buffer_load_dwordx4 a[204:207], v0, s[4:7], s36 offen offset:3072 sc1
    s_add_u32 s36, s36, 4096
    buffer_load_dwordx4 a[208:211], v0, s[4:7], s36 offen offset:0 sc1
    buffer_load_dwordx4 a[212:215], v0, s[4:7], s36 offen offset:1024 sc1
    buffer_load_dwordx4 a[216:219], v0, s[4:7], s36 offen offset:2048 sc1
    buffer_load_dwordx4 a[220:223], v0, s[4:7], s36 offen offset:3072 sc1
    v_mov_b32 v57, 16512
Y0_wb:
    ds_read_b32 v56, v57
    s_waitcnt lgkmcnt(0)
    v_cmp_gt_u32 vcc, 2, v56
    s_cbranch_vccz Y0_wb_ok
    s_sleep 1
    s_sub_u32 s35, s35, 1
    s_cmp_lg_u32 s35, 0
    s_cbranch_scc1 Y0_wb
    s_branch L_team_done
Y0_wb_ok:
    s_mul_i32 s36, s21, 229376
    s_add_u32 s36, s36, 7340032
    buffer_load_dwordx4 a[224:227], v0, s[4:7], s36 offen offset:0 sc1
    buffer_load_dwordx4 a[228:231], v0, s[4:7], s36 offen offset:1024 sc1
    buffer_load_dwordx4 a[232:235], v0, s[4:7], s36 offen offset:2048 sc1
    buffer_load_dwordx4 a[236:239], v0, s[4:7], s36 offen offset:3072 sc1
    s_add_u32 s36, s36, 4096
    buffer_load_dwordx4 a[240:243], v0, s[4:7], s36 offen offset:0 sc1
    buffer_load_dwordx4 a[244:247], v0, s[4:7], s36 offen offset:1024 sc1
    buffer_load_dwordx4 a[248:251], v0, s[4:7], s36 offen offset:2048 sc1
    buffer_load_dwordx4 a[252:255], v0, s[4:7], s36 offen offset:3072 sc1
    s_add_u32 s36, s36, 4096
    buffer_load_dwordx4 v[64:67], v0, s[4:7], s36 offen offset:0 sc1
    buffer_load_dwordx4 v[68:71], v0, s[4:7], s36 offen offset:1024 sc1
    buffer_load_dwordx4 v[72:75], v0, s[4:7], s36 offen offset:2048 sc1
    buffer_load_dwordx4 v[76:79], v0, s[4:7], s36 offen offset:3072 sc1
    s_add_u32 s36, s36, 4096
    buffer_load_dwordx4 v[80:83], v0, s[4:7], s36 offen offset:0 sc1
    buffer_load_dwordx4 v[84:87], v0, s[4:7], s36 offen offset:1024 sc1
    buffer_load_dwordx4 v[88:91], v0, s[4:7], s36 offen offset:2048 sc1
    buffer_load_dwordx4 v[92:95], v0, s[4:7], s36 offen offset:3072 sc1
    s_add_u32 s36, s36, 4096
    buffer_load_dwordx4 v[96:99], v0, s[4:7], s36 offen offset:0 sc1
    buffer_load_dwordx4 v[100:103], v0, s[4:7], s36 offen offset:1024 sc1
    buffer_load_dwordx4 v[104:107], v0, s[4:7], s36 offen offset:2048 sc1
    buffer_load_dwordx4 v[108:111], v0, s[4:7], s36 offen offset:3072 sc1
    s_add_u32 s36, s36, 4096
    buffer_load_dwordx4 v[112:115], v0, s[4:7], s36 offen offset:0 sc1
    buffer_load_dwordx4 v[116:119], v0, s[4:7], s36 offen offset:1024 sc1
    buffer_load_dwordx4 v[120:123], v0, s[4:7], s36 offen offset:2048 sc1
    buffer_load_dwordx4 v[124:127], v0, s[4:7], s36 offen offset:3072 sc1
    s_add_u32 s36, s36, 4096
    buffer_load_dwordx4 v[128:131], v0, s[4:7], s36 offen offset:0 sc1
    buffer_load_dwordx4 v[132:135], v0, s[4:7], s36 offen offset:1024 sc1
    buffer_load_dwordx4 v[136:139], v0, s[4:7], s36 offen offset:2048 sc1
    buffer_load_dwordx4 v[140:143], v0, s[4:7], s36 offen offset:3072 sc1
    s_add_u32 s36, s36, 4096
    buffer_load_dwordx4 v[144:147], v0, s[4:7], s36 offen offset:0 sc1
    buffer_load_dwordx4 v[148:151], v0, s[4:7], s36 offen offset:1024 sc1
    buffer_load_dwordx4 v[152:155], v0, s[4:7], s36 offen offset:2048 sc1
    buffer_load_dwordx4 v[156:159], v0, s[4:7], s36 offen offset:3072 sc1
    s_add_u32 s36, s36, 4096
    buffer_load_dwordx4 v[160:163], v0, s[4:7], s36 offen offset:0 sc1
    buffer_load_dwordx4 v[164:167], v0, s[4:7], s36 offen offset:1024 sc1
    buffer_load_dwordx4 v[168:171], v0, s[4:7], s36 offen offset:2048 sc1
    buffer_load_dwordx4 v[172:175], v0, s[4:7], s36 offen offset:3072 sc1
    s_add_u32 s36, s36, 4096
    buffer_load_dwordx4 v[176:179], v0, s[4:7], s36 offen offset:0 sc1
    buffer_load_dwordx4 v[180:183], v0, s[4:7], s36 offen offset:1024 sc1
    buffer_load_dwordx4 v[184:187], v0, s[4:7], s36 offen offset:2048 sc1
    buffer_load_dwordx4 v[188:191], v0, s[4:7], s36 offen offset:3072 sc1
    s_add_u32 s36, s36, 4096
    buffer_load_dwordx4 v[192:195], v0, s[4:7], s36 offen offset:0 sc1
    buffer_load_dwordx4 v[196:199], v0, s[4:7], s36 offen offset:1024 sc1
    buffer_load_dwordx4 v[200:203], v0, s[4:7], s36 offen offset:2048 sc1
    buffer_load_dwordx4 v[204:207], v0, s[4:7], s36 offen offset:3072 sc1
    s_add_u32 s36, s36, 4096
    buffer_load_dwordx4 v[208:211], v0, s[4:7], s36 offen offset:0 sc1
    buffer_load_dwordx4 v[212:215], v0, s[4:7], s36 offen offset:1024 sc1
    buffer_load_dwordx4 v[216:219], v0, s[4:7], s36 offen offset:2048 sc1
    buffer_load_dwordx4 v[220:223], v0, s[4:7], s36 offen offset:3072 sc1
    s_add_u32 s36, s36, 4096
    buffer_load_dwordx4 v[224:227], v0, s[4:7], s36 offen offset:0 sc1
    buffer_load_dwordx4 v[228:231], v0, s[4:7], s36 offen offset:1024 sc1
    buffer_load_dwordx4 v[232:235], v0, s[4:7], s36 offen offset:2048 sc1
    buffer_load_dwordx4 v[236:239], v0, s[4:7], s36 offen offset:3072 sc1
    s_add_u32 s36, s36, 4096
    buffer_load_dwordx4 v[240:243], v0, s[4:7], s36 offen offset:0 sc1
    buffer_load_dwordx4 v[244:247], v0, s[4:7], s36 offen offset:1024 sc1
    s_mul_i32 s36, s21, 229376
    s_add_u32 s36, s36, 7512064
    s_mov_b32 m0, 18432
    s_nop 0
    buffer_load_dwordx4 v0, s[4:7], s36 offen offset:0 sc1 lds
    buffer_load_dwordx4 v0, s[4:7], s36 offen offset:1024 sc1 lds
    buffer_load_dwordx4 v0, s[4:7], s36 offen offset:2048 sc1 lds
    buffer_load_dwordx4 v0, s[4:7], s36 offen offset:3072 sc1 lds
    s_mul_i32 s36, s21, 229376
    s_add_u32 s36, s36, 7516160
    s_mov_b32 m0, 22528
    s_nop 0
    buffer_load_dwordx4 v0, s[4:7], s36 offen offset:0 sc1 lds
    buffer_load_dwordx4 v0, s[4:7], s36 offen offset:1024 sc1 lds
    buffer_load_dwordx4 v0, s[4:7], s36 offen offset:2048 sc1 lds
    buffer_load_dwordx4 v0, s[4:7], s36 offen offset:3072 sc1 lds
    s_mul_i32 s36, s21, 229376
    s_add_u32 s36, s36, 7520256
    s_mov_b32 m0, 26624
    s_nop 0
    buffer_load_dwordx4 v0, s[4:7], s36 offen offset:0 sc1 lds
    buffer_load_dwordx4 v0, s[4:7], s36 offen offset:1024 sc1 lds
    buffer_load_dwordx4 v0, s[4:7], s36 offen offset:2048 sc1 lds
    buffer_load_dwordx4 v0, s[4:7], s36 offen offset:3072 sc1 lds
    s_mul_i32 s36, s21, 229376
    s_add_u32 s36, s36, 7524352
    s_mov_b32 m0, 30720
    s_nop 0
    buffer_load_dwordx4 v0, s[4:7], s36 offen offset:0 sc1 lds
    buffer_load_dwordx4 v0, s[4:7], s36 offen offset:1024 sc1 lds
    buffer_load_dwordx4 v0, s[4:7], s36 offen offset:2048 sc1 lds
    buffer_load_dwordx4 v0, s[4:7], s36 offen offset:3072 sc1 lds
    s_mul_i32 s36, s21, 229376
    s_add_u32 s36, s36, 7528448
    s_mov_b32 m0, 34816
    s_nop 0
    buffer_load_dwordx4 v0, s[4:7], s36 offen offset:0 sc1 lds
    buffer_load_dwordx4 v0, s[4:7], s36 offen offset:1024 sc1 lds
    buffer_load_dwordx4 v0, s[4:7], s36 offen offset:2048 sc1 lds
    buffer_load_dwordx4 v0, s[4:7], s36 offen offset:3072 sc1 lds
    s_mul_i32 s36, s21, 229376
    s_add_u32 s36, s36, 7532544
    s_mov_b32 m0, 38912
    s_nop 0
    buffer_load_dwordx4 v0, s[4:7], s36 offen offset:0 sc1 lds
    buffer_load_dwordx4 v0, s[4:7], s36 offen offset:1024 sc1 lds
    buffer_load_dwordx4 v0, s[4:7], s36 offen offset:2048 sc1 lds
    buffer_load_dwordx4 v0, s[4:7], s36 offen offset:3072 sc1 lds
    s_mul_i32 s36, s21, 229376
    s_add_u32 s36, s36, 7536640
    s_mov_b32 m0, 43008
    s_nop 0
    buffer_load_dwordx4 v0, s[4:7], s36 offen offset:0 sc1 lds
    buffer_load_dwordx4 v0, s[4:7], s36 offen offset:1024 sc1 lds
    buffer_load_dwordx4 v0, s[4:7], s36 offen offset:2048 sc1 lds
    buffer_load_dwordx4 v0, s[4:7], s36 offen offset:3072 sc1 lds
    s_mul_i32 s36, s21, 229376
    s_add_u32 s36, s36, 7395328
    s_mov_b32 m0, 47104
    s_nop 0
    buffer_load_dwordx4 v0, s[4:7], s36 offen offset:0 sc1 lds
    buffer_load_dwordx4 v0, s[4:7], s36 offen offset:1024 sc1 lds
    v_lshrrev_b32 v63, 3, v61
    v_lshlrev_b32 v3, 8, v63
    v_lshl_add_u32 v3, v62, 6, v3
    v_bfe_u32 v63, v61, 1, 1
    v_lshl_add_u32 v3, v63, 4, v3
    v_bfe_u32 v63, v61, 2, 1
    v_lshl_add_u32 v3, v63, 3, v3
    v_and_b32 v63, 1, v61
    v_lshl_add_u32 v3, v63, 2, v3
    v_add_u32 v3, 8192, v3
    v_add_u32 v5, 2048, v3
    v_lshrrev_b32 v63, 1, v62
    v_lshlrev_b32 v6, 8, v63
    v_lshl_add_u32 v6, v61, 4, v6
    v_and_b32 v63, 1, v62
    v_lshl_add_u32 v6, v63, 3, v6
    v_add_u32 v6, 12288, v6
    v_add_u32 v7, 18432, v0
    v_mov_b32 v4, 16448
    v_and_b32 v2, 31, v60
    v_lshlrev_b32 v2, 2, v2
    s_mul_i32 s31, s19, 14336
    s_add_u32 s31, s31, 25165824
    s_mov_b32 s46, 49152
    s_getpc_b64 s[40:41]
Y0_ref:
    v_lshlrev_b32 v56, 2, v0
    v_add_u32 v56, Y0_loop - Y0_ref, v56
    global_load_dword v57, v56, s[40:41]
    v_add_u32 v56, 4096, v56
    global_load_dword v57, v56, s[40:41]
    s_waitcnt vmcnt(0) lgkmcnt(0)
    s_barrier
    v_mov_b32 v58, 16384
    ds_read_b32 v58, v58
    s_waitcnt lgkmcnt(0)
    v_readfirstlane_b32 s23, v58
    s_cmp_lg_u32 s23, 0
    s_cbranch_scc1 Y0_far
Y0_loop:
    s_add_u32 s45, s24, 1024
    v_mov_b32 v12, 0
    v_mov_b32 v13, 0
    v_mov_b32 v14, 0
    v_mov_b32 v15, 0
    v_mov_b32 v16, 0
    v_mov_b32 v17, 0
    v_mov_b32 v18, 0
    v_mov_b32 v19, 0
    v_mov_b32 v20, 0
    v_mov_b32 v21, 0
    v_mov_b32 v22, 0
    v_mov_b32 v23, 0
    v_mov_b32 v24, 0
    v_mov_b32 v25, 0
    v_mov_b32 v26, 0
    v_mov_b32 v27, 0
    s_waitcnt vmcnt(0)
    s_mov_b32 m0, 1024
    s_barrier
    buffer_load_dwordx4 v0, s[4:7], s45 offen sc1 lds
    s_barrier
    buffer_load_dwordx4 v0, s[4:7], s45 offen offset:3072 sc1 lds
    s_barrier
    ds_read_b128 v[28:31], v0 offset:0
    s_waitcnt vmcnt(1)
    s_barrier
    ds_read_b128 v[32:35], v0 offset:1024
    ds_read_b128 v[36:39], v0 offset:2048
    ds_read_b128 v[52:55], v0 offset:6144
    s_waitcnt lgkmcnt(3)
    v_smfmac_f32_16x16x64_bf16 v[12:15], v[28:31], a[0:7], v1
    v_smfmac_f32_16x16x64_bf16 v[16:19], v[28:31], a[56:63], v1
    v_smfmac_f32_16x16x64_bf16 v[20:23], v[28:31], a[112:119], v1
    s_waitcnt vmcnt(0)
    s_barrier
    v_smfmac_f32_16x16x64_bf16 v[24:27], v[28:31], a[168:175], v1
    ds_read_b128 v[40:43], v0 offset:3072
    ds_read_b128 v[44:47], v0 offset:4096
    ds_read_b128 v[48:51], v0 offset:5120
Y0_y:
    s_waitcnt lgkmcnt(5)
    v_smfmac_f32_16x16x64_bf16 v[12:15], v[32:35], a[8:15], v1
    v_smfmac_f32_16x16x64_bf16 v[16:19], v[32:35], a[64:71], v1
    v_smfmac_f32_16x16x64_bf16 v[20:23], v[32:35], a[120:127], v1
    v_smfmac_f32_16x16x64_bf16 v[24:27], v[32:35], a[176:183], v1
    s_waitcnt lgkmcnt(4)
    v_smfmac_f32_16x16x64_bf16 v[12:15], v[36:39], a[16:23], v1
    v_smfmac_f32_16x16x64_bf16 v[16:19], v[36:39], a[72:79], v1
    s_waitcnt lgkmcnt(3)
    v_smfmac_f32_16x16x64_bf16 v[12:15], v[52:55], a[48:55], v1
    v_smfmac_f32_16x16x64_bf16 v[16:19], v[52:55], a[104:111], v1
    s_waitcnt lgkmcnt(2)
    v_smfmac_f32_16x16x64_bf16 v[12:15], v[40:43], a[24:31], v1
    v_smfmac_f32_16x16x64_bf16 v[16:19], v[40:43], a[80:87], v1
    s_waitcnt lgkmcnt(1)
    v_smfmac_f32_16x16x64_bf16 v[12:15], v[44:47], a[32:39], v1
    v_smfmac_f32_16x16x64_bf16 v[16:19], v[44:47], a[88:95], v1
    s_waitcnt lgkmcnt(0)
    v_smfmac_f32_16x16x64_bf16 v[12:15], v[48:51], a[40:47], v1
    v_smfmac_f32_16x16x64_bf16 v[16:19], v[48:51], a[96:103], v1
    v_smfmac_f32_16x16x64_bf16 v[20:23], v[36:39], a[128:135], v1
    s_nop 1
    v_smfmac_f32_16x16x64_bf16 v[24:27], v[36:39], a[184:191], v1
    s_nop 1
    v_smfmac_f32_16x16x64_bf16 v[20:23], v[52:55], a[160:167], v1
    v_add_f32 v12, v12, v13
    v_add_f32 v14, v14, v15
    v_smfmac_f32_16x16x64_bf16 v[24:27], v[52:55], a[216:223], v1
    v_add_f32 v16, v16, v17
    v_add_f32 v18, v18, v19
    v_smfmac_f32_16x16x64_bf16 v[20:23], v[40:43], a[136:143], v1
    v_cvt_pk_bf16_f32 v8, v12, v16
    v_cvt_pk_bf16_f32 v9, v14, v18
    v_smfmac_f32_16x16x64_bf16 v[24:27], v[40:43], a[192:199], v1
    ds_write2_b32 v3, v8, v9 offset0:0 offset1:8
    v_cmp_u_f32 vcc, v12, v14
    v_smfmac_f32_16x16x64_bf16 v[20:23], v[44:47], a[144:151], v1
    v_mov_b32 v12, 0
    v_mov_b32 v13, 0
    v_smfmac_f32_16x16x64_bf16 v[24:27], v[44:47], a[200:207], v1
    v_mov_b32 v14, 0
    v_mov_b32 v15, 0
    v_smfmac_f32_16x16x64_bf16 v[20:23], v[48:51], a[152:159], v1
    s_waitcnt lgkmcnt(0)
    s_barrier
    v_smfmac_f32_16x16x64_bf16 v[24:27], v[48:51], a[208:215], v1
    v_mov_b32 v16, 0
    v_mov_b32 v17, 0
    v_mov_b32 v18, 0
    v_mov_b32 v19, 0
    s_nop 1
    v_add_f32 v20, v20, v21
    v_add_f32 v22, v22, v23
    v_add_f32 v24, v24, v25
    v_add_f32 v26, v26, v27
    v_cvt_pk_bf16_f32 v10, v20, v24
    v_cvt_pk_bf16_f32 v11, v22, v26
    ds_write2_b32 v5, v10, v11 offset0:0 offset1:8
    s_cbranch_vccnz Y0_fail
Y0_yok:
    v_mov_b32 v20, 0
    v_mov_b32 v21, 0
    v_mov_b32 v22, 0
    v_mov_b32 v23, 0
    v_mov_b32 v24, 0
    v_mov_b32 v25, 0
    v_mov_b32 v26, 0
    v_mov_b32 v27, 0
    s_waitcnt lgkmcnt(0)
    s_barrier
    v_smfmac_f32_16x16x64_bf16 v[24:27], v[28:31], v[144:151], v1
    v_smfmac_f32_16x16x64_bf16 v[24:27], v[32:35], v[152:159], v1
    v_smfmac_f32_16x16x64_bf16 v[24:27], v[36:39], v[160:167], v1
    v_smfmac_f32_16x16x64_bf16 v[24:27], v[40:43], v[168:175], v1
    v_smfmac_f32_16x16x64_bf16 v[24:27], v[44:47], v[176:183], v1
    ds_read_b128 v[56:59], v7 offset:0
    ds_read_b128 v[60:63], v7 offset:1024
    v_smfmac_f32_16x16x64_bf16 v[24:27], v[48:51], v[184:191], v1
    ds_read_b128 v[248:251], v7 offset:2048
    ds_read_b128 v[252:255], v7 offset:3072
    v_smfmac_f32_16x16x64_bf16 v[24:27], v[52:55], v[192:199], v1
    v_smfmac_f32_16x16x64_bf16 v[12:15], v[28:31], a[224:231], v1
    v_smfmac_f32_16x16x64_bf16 v[16:19], v[28:31], v[88:95], v1
    s_waitcnt lgkmcnt(2)
    v_smfmac_f32_16x16x64_bf16 v[20:23], v[28:31], v[56:63], v1
    ds_read_b128 v[56:59], v7 offset:4096
    ds_read_b128 v[60:63], v7 offset:5120
    v_smfmac_f32_16x16x64_bf16 v[12:15], v[32:35], a[232:239], v1
    v_smfmac_f32_16x16x64_bf16 v[16:19], v[32:35], v[96:103], v1
    s_waitcnt lgkmcnt(2)
    v_smfmac_f32_16x16x64_bf16 v[20:23], v[32:35], v[248:255], v1
    ds_read_b128 v[248:251], v7 offset:6144
    ds_read_b128 v[252:255], v7 offset:7168
    v_smfmac_f32_16x16x64_bf16 v[12:15], v[36:39], a[240:247], v1
    v_smfmac_f32_16x16x64_bf16 v[16:19], v[36:39], v[104:111], v1
    s_waitcnt lgkmcnt(2)
    v_smfmac_f32_16x16x64_bf16 v[20:23], v[36:39], v[56:63], v1
    ds_read_b128 v[56:59], v7 offset:8192
    ds_read_b128 v[60:63], v7 offset:9216
    v_add_f32 v24, v24, v25
    v_add_f32 v26, v26, v27
    v_cvt_pk_bf16_f32 v10, v24, v26
    v_mov_b32 v24, 0
    v_mov_b32 v25, 0
    v_mov_b32 v26, 0
    v_mov_b32 v27, 0
    v_smfmac_f32_16x16x64_bf16 v[12:15], v[40:43], a[248:255], v1
    v_smfmac_f32_16x16x64_bf16 v[16:19], v[40:43], v[112:119], v1
    s_waitcnt lgkmcnt(2)
    v_smfmac_f32_16x16x64_bf16 v[20:23], v[40:43], v[248:255], v1
    ds_read_b128 v[248:251], v7 offset:10240
    ds_read_b128 v[252:255], v7 offset:11264
    v_smfmac_f32_16x16x64_bf16 v[12:15], v[44:47], v[64:71], v1
    v_smfmac_f32_16x16x64_bf16 v[16:19], v[44:47], v[120:127], v1
    s_waitcnt lgkmcnt(2)
    v_smfmac_f32_16x16x64_bf16 v[20:23], v[44:47], v[56:63], v1
    ds_read_b128 v[56:59], v7 offset:12288
    ds_read_b128 v[60:63], v7 offset:13312
    v_smfmac_f32_16x16x64_bf16 v[12:15], v[48:51], v[72:79], v1
    v_smfmac_f32_16x16x64_bf16 v[16:19], v[48:51], v[128:135], v1
    s_waitcnt lgkmcnt(2)
    v_smfmac_f32_16x16x64_bf16 v[20:23], v[48:51], v[248:255], v1
    ds_read_b128 v[248:251], v7 offset:14336
    ds_read_b128 v[252:255], v7 offset:15360
    v_smfmac_f32_16x16x64_bf16 v[12:15], v[52:55], v[80:87], v1
    v_smfmac_f32_16x16x64_bf16 v[16:19], v[52:55], v[136:143], v1
    s_waitcnt lgkmcnt(2)
    v_smfmac_f32_16x16x64_bf16 v[20:23], v[52:55], v[56:63], v1
    ds_read_b128 v[56:59], v7 offset:16384
    ds_read_b128 v[60:63], v7 offset:17408
    v_smfmac_f32_16x16x64_bf16 v[24:27], v[28:31], v[200:207], v1
    s_nop 3
    v_add_f32 v12, v12, v13
    v_add_f32 v14, v14, v15
    v_smfmac_f32_16x16x64_bf16 v[24:27], v[32:35], v[208:215], v1
    v_cvt_pk_bf16_f32 v8, v12, v14
    v_add_f32 v16, v16, v17
    v_add_f32 v18, v18, v19
    v_smfmac_f32_16x16x64_bf16 v[24:27], v[36:39], v[216:223], v1
    v_cvt_pk_bf16_f32 v9, v16, v18
    v_mov_b32 v12, 0
    v_mov_b32 v13, 0
    v_smfmac_f32_16x16x64_bf16 v[24:27], v[40:43], v[224:231], v1
    v_mov_b32 v14, 0
    v_mov_b32 v15, 0
    ds_write_b64 v6, v[8:9]
    v_smfmac_f32_16x16x64_bf16 v[24:27], v[44:47], v[232:239], v1
    v_add_f32 v20, v20, v21
    v_add_f32 v22, v22, v23
    v_cvt_pk_bf16_f32 v8, v20, v22
    v_smfmac_f32_16x16x64_bf16 v[24:27], v[48:51], v[240:247], v1
    s_waitcnt lgkmcnt(3)
    v_smfmac_f32_16x16x64_bf16 v[12:15], v[28:31], v[248:255], v1
    ds_read_b128 v[248:251], v7 offset:18432
    ds_read_b128 v[252:255], v7 offset:19456
    s_waitcnt lgkmcnt(3)
    v_smfmac_f32_16x16x64_bf16 v[12:15], v[32:35], v[56:63], v1
    ds_read_b128 v[56:59], v7 offset:20480
    ds_read_b128 v[60:63], v7 offset:21504
    s_waitcnt lgkmcnt(2)
    v_smfmac_f32_16x16x64_bf16 v[12:15], v[36:39], v[248:255], v1
    ds_read_b128 v[248:251], v7 offset:22528
    ds_read_b128 v[252:255], v7 offset:23552
    s_waitcnt lgkmcnt(2)
    v_smfmac_f32_16x16x64_bf16 v[12:15], v[40:43], v[56:63], v1
    ds_read_b128 v[56:59], v7 offset:24576
    ds_read_b128 v[60:63], v7 offset:25600
    s_waitcnt lgkmcnt(2)
    v_smfmac_f32_16x16x64_bf16 v[12:15], v[44:47], v[248:255], v1
    ds_read_b128 v[248:251], v7 offset:26624
    ds_read_b128 v[252:255], v7 offset:27648
    s_waitcnt lgkmcnt(2)
    v_smfmac_f32_16x16x64_bf16 v[12:15], v[48:51], v[56:63], v1
    ds_read_b128 v[56:59], v7 offset:28672
    ds_read_b128 v[60:63], v7 offset:29696
    s_waitcnt lgkmcnt(2)
    v_smfmac_f32_16x16x64_bf16 v[12:15], v[52:55], v[248:255], v1
    s_waitcnt lgkmcnt(0)
    v_smfmac_f32_16x16x64_bf16 v[24:27], v[52:55], v[56:63], v1
    s_nop 6
    v_add_f32 v12, v12, v13
    v_add_f32 v14, v14, v15
    v_cvt_pk_bf16_f32 v9, v12, v14
    v_add_f32 v24, v24, v25
    v_add_f32 v26, v26, v27
    v_cvt_pk_bf16_f32 v11, v24, v26
    ds_write_b64 v6, v[8:9] offset:3072
    ds_write_b64 v6, v[10:11] offset:512
    s_waitcnt lgkmcnt(0)
    s_barrier
    s_mov_b32 s26, s24
    s_mov_b32 s24, s25
    s_add_u32 s25, s25, 0x10000
    s_and_b32 s25, s25, 14876672
    s_add_u32 s20, s20, 1
    s_cmp_lt_u32 s20, 63
    s_cbranch_scc1 Y0_loop
    s_branch L_team_done
Y0_fail:
    v_max_u32 v56, v28, v29
    v_max3_u32 v56, v56, v30, v31
    v_max3_u32 v56, v56, v32, v33
    v_max3_u32 v56, v56, v34, v35
    v_max3_u32 v56, v56, v36, v37
    v_max3_u32 v56, v56, v38, v39
    v_max3_u32 v56, v56, v40, v41
    v_max3_u32 v56, v56, v42, v43
    v_max3_u32 v56, v56, v44, v45
    v_max3_u32 v56, v56, v46, v47
    v_max3_u32 v56, v56, v48, v49
    v_max3_u32 v56, v56, v50, v51
    v_max3_u32 v56, v56, v52, v53
    v_max3_u32 v56, v56, v54, v55
    v_cmp_eq_u32 vcc, -1, v56
    s_cbranch_vccz Y0_yok
    s_waitcnt lgkmcnt(0)
    s_sub_u32 s35, s35, 1
    s_cmp_eq_u32 s35, 0
    s_cbranch_scc1 L_team_done
    v_mov_b32 v12, 0
    v_mov_b32 v13, 0
    v_mov_b32 v14, 0
    v_mov_b32 v15, 0
    v_mov_b32 v16, 0
    v_mov_b32 v17, 0
    v_mov_b32 v18, 0
    v_mov_b32 v19, 0
    v_mov_b32 v20, 0
    v_mov_b32 v21, 0
    v_mov_b32 v22, 0
    v_mov_b32 v23, 0
    v_mov_b32 v24, 0
    v_mov_b32 v25, 0
    v_mov_b32 v26, 0
    v_mov_b32 v27, 0
    s_mov_b32 m0, 1024
    s_barrier
    buffer_load_dwordx4 v0, s[4:7], s45 offen sc1 lds
    buffer_load_dwordx4 v0, s[4:7], s45 offen offset:3072 sc1 lds
    s_waitcnt vmcnt(0)
    s_barrier
    ds_read_b128 v[28:31], v0 offset:0
    ds_read_b128 v[32:35], v0 offset:1024
    ds_read_b128 v[36:39], v0 offset:2048
    ds_read_b128 v[52:55], v0 offset:6144
    ds_read_b128 v[40:43], v0 offset:3072
    ds_read_b128 v[44:47], v0 offset:4096
    ds_read_b128 v[48:51], v0 offset:5120
    s_waitcnt lgkmcnt(6)
    v_smfmac_f32_16x16x64_bf16 v[12:15], v[28:31], a[0:7], v1
    v_smfmac_f32_16x16x64_bf16 v[16:19], v[28:31], a[56:63], v1
    v_smfmac_f32_16x16x64_bf16 v[20:23], v[28:31], a[112:119], v1
    v_smfmac_f32_16x16x64_bf16 v[24:27], v[28:31], a[168:175], v1
    s_branch Y0_y
Y0_far:
Y0f_loop:
    s_add_u32 s45, s24, 1024
    v_mov_b32 v12, 0
    v_mov_b32 v13, 0
    v_mov_b32 v14, 0
    v_mov_b32 v15, 0
    v_mov_b32 v16, 0
    v_mov_b32 v17, 0
    v_mov_b32 v18, 0
    v_mov_b32 v19, 0
    v_mov_b32 v20, 0
    v_mov_b32 v21, 0
    v_mov_b32 v22, 0
    v_mov_b32 v23, 0
    v_mov_b32 v24, 0
    v_mov_b32 v25, 0
    v_mov_b32 v26, 0
    v_mov_b32 v27, 0
    s_waitcnt vmcnt(0)
    s_mov_b32 m0, 1024
    s_barrier
    buffer_load_dwordx4 v0, s[4:7], s45 offen sc1 lds
    s_barrier
    buffer_load_dwordx4 v0, s[4:7], s45 offen offset:3072 sc1 lds
    s_barrier
    ds_read_b128 v[28:31], v0 offset:0
    s_waitcnt vmcnt(1)
    s_barrier
    ds_read_b128 v[32:35], v0 offset:1024
    ds_read_b128 v[36:39], v0 offset:2048
    ds_read_b128 v[52:55], v0 offset:6144
    s_waitcnt lgkmcnt(3)
    v_smfmac_f32_16x16x64_bf16 v[12:15], v[28:31], a[0:7], v1
    v_smfmac_f32_16x16x64_bf16 v[16:19], v[28:31], a[56:63], v1
    v_smfmac_f32_16x16x64_bf16 v[20:23], v[28:31], a[112:119], v1
    s_waitcnt vmcnt(0)
    s_barrier
    v_smfmac_f32_16x16x64_bf16 v[24:27], v[28:31], a[168:175], v1
    ds_read_b128 v[40:43], v0 offset:3072
    ds_read_b128 v[44:47], v0 offset:4096
    ds_read_b128 v[48:51], v0 offset:5120
Y0f_y:
    s_waitcnt lgkmcnt(5)
    v_smfmac_f32_16x16x64_bf16 v[12:15], v[32:35], a[8:15], v1
    v_smfmac_f32_16x16x64_bf16 v[16:19], v[32:35], a[64:71], v1
    v_smfmac_f32_16x16x64_bf16 v[20:23], v[32:35], a[120:127], v1
    v_smfmac_f32_16x16x64_bf16 v[24:27], v[32:35], a[176:183], v1
    s_waitcnt lgkmcnt(4)
    v_smfmac_f32_16x16x64_bf16 v[12:15], v[36:39], a[16:23], v1
    v_smfmac_f32_16x16x64_bf16 v[16:19], v[36:39], a[72:79], v1
    s_waitcnt lgkmcnt(3)
    v_smfmac_f32_16x16x64_bf16 v[12:15], v[52:55], a[48:55], v1
    v_smfmac_f32_16x16x64_bf16 v[16:19], v[52:55], a[104:111], v1
    s_waitcnt lgkmcnt(2)
    v_smfmac_f32_16x16x64_bf16 v[12:15], v[40:43], a[24:31], v1
    v_smfmac_f32_16x16x64_bf16 v[16:19], v[40:43], a[80:87], v1
    s_waitcnt lgkmcnt(1)
    v_smfmac_f32_16x16x64_bf16 v[12:15], v[44:47], a[32:39], v1
    v_smfmac_f32_16x16x64_bf16 v[16:19], v[44:47], a[88:95], v1
    s_waitcnt lgkmcnt(0)
    v_smfmac_f32_16x16x64_bf16 v[12:15], v[48:51], a[40:47], v1
    v_smfmac_f32_16x16x64_bf16 v[16:19], v[48:51], a[96:103], v1
    v_smfmac_f32_16x16x64_bf16 v[20:23], v[36:39], a[128:135], v1
    s_nop 1
    v_smfmac_f32_16x16x64_bf16 v[24:27], v[36:39], a[184:191], v1
    s_nop 1
    v_smfmac_f32_16x16x64_bf16 v[20:23], v[52:55], a[160:167], v1
    v_add_f32 v12, v12, v13
    v_add_f32 v14, v14, v15
    v_smfmac_f32_16x16x64_bf16 v[24:27], v[52:55], a[216:223], v1
    v_add_f32 v16, v16, v17
    v_add_f32 v18, v18, v19
    v_smfmac_f32_16x16x64_bf16 v[20:23], v[40:43], a[136:143], v1
    v_cvt_pk_bf16_f32 v8, v12, v16
    v_cvt_pk_bf16_f32 v9, v14, v18
    v_smfmac_f32_16x16x64_bf16 v[24:27], v[40:43], a[192:199], v1
    ds_write2_b32 v3, v8, v9 offset0:0 offset1:8
    v_cmp_u_f32 vcc, v12, v14
    v_smfmac_f32_16x16x64_bf16 v[20:23], v[44:47], a[144:151], v1
    v_mov_b32 v12, 0
    v_mov_b32 v13, 0
    v_smfmac_f32_16x16x64_bf16 v[24:27], v[44:47], a[200:207], v1
    v_mov_b32 v14, 0
    v_mov_b32 v15, 0
    v_smfmac_f32_16x16x64_bf16 v[20:23], v[48:51], a[152:159], v1
    s_waitcnt lgkmcnt(0)
    s_barrier
    v_smfmac_f32_16x16x64_bf16 v[24:27], v[48:51], a[208:215], v1
    v_mov_b32 v16, 0
    v_mov_b32 v17, 0
    v_mov_b32 v18, 0
    v_mov_b32 v19, 0
    s_nop 1
    v_add_f32 v20, v20, v21
    v_add_f32 v22, v22, v23
    v_add_f32 v24, v24, v25
    v_add_f32 v26, v26, v27
    v_cvt_pk_bf16_f32 v10, v20, v24
    v_cvt_pk_bf16_f32 v11, v22, v26
    ds_write2_b32 v5, v10, v11 offset0:0 offset1:8
    s_cbranch_vccnz Y0f_fail
Y0f_yok:
    v_mov_b32 v20, 0
    v_mov_b32 v21, 0
    v_mov_b32 v22, 0
    v_mov_b32 v23, 0
    v_mov_b32 v24, 0
    v_mov_b32 v25, 0
    v_mov_b32 v26, 0
    v_mov_b32 v27, 0
    s_waitcnt lgkmcnt(0)
    s_barrier
    v_smfmac_f32_16x16x64_bf16 v[24:27], v[28:31], v[144:151], v1
    v_smfmac_f32_16x16x64_bf16 v[24:27], v[32:35], v[152:159], v1
    v_smfmac_f32_16x16x64_bf16 v[24:27], v[36:39], v[160:167], v1
    v_smfmac_f32_16x16x64_bf16 v[24:27], v[40:43], v[168:175], v1
    v_smfmac_f32_16x16x64_bf16 v[24:27], v[44:47], v[176:183], v1
    ds_read_b128 v[56:59], v7 offset:0
    ds_read_b128 v[60:63], v7 offset:1024
    v_smfmac_f32_16x16x64_bf16 v[24:27], v[48:51], v[184:191], v1
    ds_read_b128 v[248:251], v7 offset:2048
    ds_read_b128 v[252:255], v7 offset:3072
    v_smfmac_f32_16x16x64_bf16 v[24:27], v[52:55], v[192:199], v1
    v_smfmac_f32_16x16x64_bf16 v[12:15], v[28:31], a[224:231], v1
    v_smfmac_f32_16x16x64_bf16 v[16:19], v[28:31], v[88:95], v1
    s_waitcnt lgkmcnt(2)
    v_smfmac_f32_16x16x64_bf16 v[20:23], v[28:31], v[56:63], v1
    ds_read_b128 v[56:59], v7 offset:4096
    ds_read_b128 v[60:63], v7 offset:5120
    v_smfmac_f32_16x16x64_bf16 v[12:15], v[32:35], a[232:239], v1
    v_smfmac_f32_16x16x64_bf16 v[16:19], v[32:35], v[96:103], v1
    s_waitcnt lgkmcnt(2)
    v_smfmac_f32_16x16x64_bf16 v[20:23], v[32:35], v[248:255], v1
    ds_read_b128 v[248:251], v7 offset:6144
    ds_read_b128 v[252:255], v7 offset:7168
    v_smfmac_f32_16x16x64_bf16 v[12:15], v[36:39], a[240:247], v1
    v_smfmac_f32_16x16x64_bf16 v[16:19], v[36:39], v[104:111], v1
    s_waitcnt lgkmcnt(2)
    v_smfmac_f32_16x16x64_bf16 v[20:23], v[36:39], v[56:63], v1
    ds_read_b128 v[56:59], v7 offset:8192
    ds_read_b128 v[60:63], v7 offset:9216
    v_add_f32 v24, v24, v25
    v_add_f32 v26, v26, v27
    v_cvt_pk_bf16_f32 v10, v24, v26
    v_mov_b32 v24, 0
    v_mov_b32 v25, 0
    v_mov_b32 v26, 0
    v_mov_b32 v27, 0
    v_smfmac_f32_16x16x64_bf16 v[12:15], v[40:43], a[248:255], v1
    v_smfmac_f32_16x16x64_bf16 v[16:19], v[40:43], v[112:119], v1
    s_waitcnt lgkmcnt(2)
    v_smfmac_f32_16x16x64_bf16 v[20:23], v[40:43], v[248:255], v1
    ds_read_b128 v[248:251], v7 offset:10240
    ds_read_b128 v[252:255], v7 offset:11264
    v_smfmac_f32_16x16x64_bf16 v[12:15], v[44:47], v[64:71], v1
    v_smfmac_f32_16x16x64_bf16 v[16:19], v[44:47], v[120:127], v1
    s_waitcnt lgkmcnt(2)
    v_smfmac_f32_16x16x64_bf16 v[20:23], v[44:47], v[56:63], v1
    ds_read_b128 v[56:59], v7 offset:12288
    ds_read_b128 v[60:63], v7 offset:13312
    v_smfmac_f32_16x16x64_bf16 v[12:15], v[48:51], v[72:79], v1
    v_smfmac_f32_16x16x64_bf16 v[16:19], v[48:51], v[128:135], v1
    s_waitcnt lgkmcnt(2)
    v_smfmac_f32_16x16x64_bf16 v[20:23], v[48:51], v[248:255], v1
    ds_read_b128 v[248:251], v7 offset:14336
    ds_read_b128 v[252:255], v7 offset:15360
    v_smfmac_f32_16x16x64_bf16 v[12:15], v[52:55], v[80:87], v1
    v_smfmac_f32_16x16x64_bf16 v[16:19], v[52:55], v[136:143], v1
    s_waitcnt lgkmcnt(2)
    v_smfmac_f32_16x16x64_bf16 v[20:23], v[52:55], v[56:63], v1
    ds_read_b128 v[56:59], v7 offset:16384
    ds_read_b128 v[60:63], v7 offset:17408
    v_smfmac_f32_16x16x64_bf16 v[24:27], v[28:31], v[200:207], v1
    s_nop 3
    v_add_f32 v12, v12, v13
    v_add_f32 v14, v14, v15
    v_smfmac_f32_16x16x64_bf16 v[24:27], v[32:35], v[208:215], v1
    v_cvt_pk_bf16_f32 v8, v12, v14
    v_add_f32 v16, v16, v17
    v_add_f32 v18, v18, v19
    v_smfmac_f32_16x16x64_bf16 v[24:27], v[36:39], v[216:223], v1
    v_cvt_pk_bf16_f32 v9, v16, v18
    v_mov_b32 v12, 0
    v_mov_b32 v13, 0
    v_smfmac_f32_16x16x64_bf16 v[24:27], v[40:43], v[224:231], v1
    v_mov_b32 v14, 0
    v_mov_b32 v15, 0
    ds_write_b64 v6, v[8:9]
    v_smfmac_f32_16x16x64_bf16 v[24:27], v[44:47], v[232:239], v1
    v_add_f32 v20, v20, v21
    v_add_f32 v22, v22, v23
    v_cvt_pk_bf16_f32 v8, v20, v22
    v_smfmac_f32_16x16x64_bf16 v[24:27], v[48:51], v[240:247], v1
    s_waitcnt lgkmcnt(3)
    v_smfmac_f32_16x16x64_bf16 v[12:15], v[28:31], v[248:255], v1
    ds_read_b128 v[248:251], v7 offset:18432
    ds_read_b128 v[252:255], v7 offset:19456
    s_waitcnt lgkmcnt(3)
    v_smfmac_f32_16x16x64_bf16 v[12:15], v[32:35], v[56:63], v1
    ds_read_b128 v[56:59], v7 offset:20480
    ds_read_b128 v[60:63], v7 offset:21504
    s_waitcnt lgkmcnt(2)
    v_smfmac_f32_16x16x64_bf16 v[12:15], v[36:39], v[248:255], v1
    ds_read_b128 v[248:251], v7 offset:22528
    ds_read_b128 v[252:255], v7 offset:23552
    s_waitcnt lgkmcnt(2)
    v_smfmac_f32_16x16x64_bf16 v[12:15], v[40:43], v[56:63], v1
    ds_read_b128 v[56:59], v7 offset:24576
    ds_read_b128 v[60:63], v7 offset:25600
    s_waitcnt lgkmcnt(2)
    v_smfmac_f32_16x16x64_bf16 v[12:15], v[44:47], v[248:255], v1
    ds_read_b128 v[248:251], v7 offset:26624
    ds_read_b128 v[252:255], v7 offset:27648
    s_waitcnt lgkmcnt(2)
    v_smfmac_f32_16x16x64_bf16 v[12:15], v[48:51], v[56:63], v1
    ds_read_b128 v[56:59], v7 offset:28672
    ds_read_b128 v[60:63], v7 offset:29696
    s_waitcnt lgkmcnt(2)
    v_smfmac_f32_16x16x64_bf16 v[12:15], v[52:55], v[248:255], v1
    s_waitcnt lgkmcnt(0)
    v_smfmac_f32_16x16x64_bf16 v[24:27], v[52:55], v[56:63], v1
    s_nop 6
    v_add_f32 v12, v12, v13
    v_add_f32 v14, v14, v15
    v_cvt_pk_bf16_f32 v9, v12, v14
    v_add_f32 v24, v24, v25
    v_add_f32 v26, v26, v27
    v_cvt_pk_bf16_f32 v11, v24, v26
    ds_write_b64 v6, v[8:9] offset:3072
    ds_write_b64 v6, v[10:11] offset:512
    s_waitcnt lgkmcnt(0)
    s_barrier
    s_mov_b32 s26, s24
    s_mov_b32 s24, s25
    s_add_u32 s25, s25, 0x10000
    s_and_b32 s25, s25, 14876672
    s_add_u32 s20, s20, 1
    s_cmp_lt_u32 s20, 63
    s_cbranch_scc1 Y0f_loop
    s_branch L_team_done
Y0f_fail:
    v_max_u32 v56, v28, v29
    v_max3_u32 v56, v56, v30, v31
    v_max3_u32 v56, v56, v32, v33
    v_max3_u32 v56, v56, v34, v35
    v_max3_u32 v56, v56, v36, v37
    v_max3_u32 v56, v56, v38, v39
    v_max3_u32 v56, v56, v40, v41
    v_max3_u32 v56, v56, v42, v43
    v_max3_u32 v56, v56, v44, v45
    v_max3_u32 v56, v56, v46, v47
    v_max3_u32 v56, v56, v48, v49
    v_max3_u32 v56, v56, v50, v51
    v_max3_u32 v56, v56, v52, v53
    v_max3_u32 v56, v56, v54, v55
    v_cmp_eq_u32 vcc, -1, v56
    s_cbranch_vccz Y0f_yok
    s_waitcnt lgkmcnt(0)
    s_sub_u32 s35, s35, 1
    s_cmp_eq_u32 s35, 0
    s_cbranch_scc1 L_team_done
    v_mov_b32 v12, 0
    v_mov_b32 v13, 0
    v_mov_b32 v14, 0
    v_mov_b32 v15, 0
    v_mov_b32 v16, 0
    v_mov_b32 v17, 0
    v_mov_b32 v18, 0
    v_mov_b32 v19, 0
    v_mov_b32 v20, 0
    v_mov_b32 v21, 0
    v_mov_b32 v22, 0
    v_mov_b32 v23, 0
    v_mov_b32 v24, 0
    v_mov_b32 v25, 0
    v_mov_b32 v26, 0
    v_mov_b32 v27, 0
    s_mov_b32 m0, 1024
    s_barrier
    buffer_load_dwordx4 v0, s[4:7], s45 offen sc1 lds
    buffer_load_dwordx4 v0, s[4:7], s45 offen offset:3072 sc1 lds
    s_waitcnt vmcnt(0)
    s_barrier
    ds_read_b128 v[28:31], v0 offset:0
    ds_read_b128 v[32:35], v0 offset:1024
    ds_read_b128 v[36:39], v0 offset:2048
    ds_read_b128 v[52:55], v0 offset:6144
    ds_read_b128 v[40:43], v0 offset:3072
    ds_read_b128 v[44:47], v0 offset:4096
    ds_read_b128 v[48:51], v0 offset:5120
    s_waitcnt lgkmcnt(6)
    v_smfmac_f32_16x16x64_bf16 v[12:15], v[28:31], a[0:7], v1
    v_smfmac_f32_16x16x64_bf16 v[16:19], v[28:31], a[56:63], v1
    v_smfmac_f32_16x16x64_bf16 v[20:23], v[28:31], a[112:119], v1
    v_smfmac_f32_16x16x64_bf16 v[24:27], v[28:31], a[168:175], v1
    s_branch Y0f_y
Y1_entry:
    v_mov_b32 v57, 16512
Y1_wa:
    ds_read_b32 v56, v57
    s_waitcnt lgkmcnt(0)
    v_cmp_gt_u32 vcc, 1, v56
    s_cbranch_vccz Y1_wa_ok
    s_sleep 1
    s_sub_u32 s35, s35, 1
    s_cmp_lg_u32 s35, 0
    s_cbranch_scc1 Y1_wa
    s_branch L_team_done
Y1_wa_ok:
    s_mul_i32 s36, s16, 200704
    s_add_u32 s36, s36, 57344
    buffer_load_dwordx4 a[0:3], v0, s[4:7], s36 offen offset:0 sc1
    buffer_load_dwordx4 a[4:7], v0, s[4:7], s36 offen offset:1024 sc1
    buffer_load_dwordx4 a[8:11], v0, s[4:7], s36 offen offset:2048 sc1
    buffer_load_dwordx4 a[12:15], v0, s[4:7], s36 offen offset:3072 sc1
    s_add_u32 s36, s36, 4096
    buffer_load_dwordx4 a[16:19], v0, s[4:7], s36 offen offset:0 sc1
    buffer_load_dwordx4 a[20:23], v0, s[4:7], s36 offen offset:1024 sc1
    buffer_load_dwordx4 a[24:27], v0, s[4:7], s36 offen offset:2048 sc1
    buffer_load_dwordx4 a[28:31], v0, s[4:7], s36 offen offset:3072 sc1
    s_add_u32 s36, s36, 4096
    buffer_load_dwordx4 a[32:35], v0, s[4:7], s36 offen offset:0 sc1
    buffer_load_dwordx4 a[36:39], v0, s[4:7], s36 offen offset:1024 sc1
    buffer_load_dwordx4 a[40:43], v0, s[4:7], s36 offen offset:2048 sc1
    buffer_load_dwordx4 a[44:47], v0, s[4:7], s36 offen offset:3072 sc1
    s_add_u32 s36, s36, 4096
    buffer_load_dwordx4 a[48:51], v0, s[4:7], s36 offen offset:0 sc1
    buffer_load_dwordx4 a[52:55], v0, s[4:7], s36 offen offset:1024 sc1
    buffer_load_dwordx4 a[56:59], v0, s[4:7], s36 offen offset:2048 sc1
    buffer_load_dwordx4 a[60:63], v0, s[4:7], s36 offen offset:3072 sc1
    s_add_u32 s36, s36, 4096
    buffer_load_dwordx4 a[64:67], v0, s[4:7], s36 offen offset:0 sc1
    buffer_load_dwordx4 a[68:71], v0, s[4:7], s36 offen offset:1024 sc1
    buffer_load_dwordx4 a[72:75], v0, s[4:7], s36 offen offset:2048 sc1
    buffer_load_dwordx4 a[76:79], v0, s[4:7], s36 offen offset:3072 sc1
    s_add_u32 s36, s36, 4096
    buffer_load_dwordx4 a[80:83], v0, s[4:7], s36 offen offset:0 sc1
    buffer_load_dwordx4 a[84:87], v0, s[4:7], s36 offen offset:1024 sc1
    buffer_load_dwordx4 a[88:91], v0, s[4:7], s36 offen offset:2048 sc1
    buffer_load_dwordx4 a[92:95], v0, s[4:7], s36 offen offset:3072 sc1
    s_add_u32 s36, s36, 4096
    buffer_load_dwordx4 a[96:99], v0, s[4:7], s36 offen offset:0 sc1
    buffer_load_dwordx4 a[100:103], v0, s[4:7], s36 offen offset:1024 sc1
    buffer_load_dwordx4 a[104:107], v0, s[4:7], s36 offen offset:2048 sc1
    buffer_load_dwordx4 a[108:111], v0, s[4:7], s36 offen offset:3072 sc1
    s_add_u32 s36, s36, 4096
    buffer_load_dwordx4 a[112:115], v0, s[4:7], s36 offen offset:0 sc1
    buffer_load_dwordx4 a[116:119], v0, s[4:7], s36 offen offset:1024 sc1
    buffer_load_dwordx4 a[120:123], v0, s[4:7], s36 offen offset:2048 sc1
    buffer_load_dwordx4 a[124:127], v0, s[4:7], s36 offen offset:3072 sc1
    s_add_u32 s36, s36, 4096
    buffer_load_dwordx4 a[128:131], v0, s[4:7], s36 offen offset:0 sc1
    buffer_load_dwordx4 a[132:135], v0, s[4:7], s36 offen offset:1024 sc1
    buffer_load_dwordx4 a[136:139], v0, s[4:7], s36 offen offset:2048 sc1
    buffer_load_dwordx4 a[140:143], v0, s[4:7], s36 offen offset:3072 sc1
    s_add_u32 s36, s36, 4096
    buffer_load_dwordx4 a[144:147], v0, s[4:7], s36 offen offset:0 sc1
    buffer_load_dwordx4 a[148:151], v0, s[4:7], s36 offen offset:1024 sc1
    buffer_load_dwordx4 a[152:155], v0, s[4:7], s36 offen offset:2048 sc1
    buffer_load_dwordx4 a[156:159], v0, s[4:7], s36 offen offset:3072 sc1
    s_add_u32 s36, s36, 4096
    buffer_load_dwordx4 a[160:163], v0, s[4:7], s36 offen offset:0 sc1
    buffer_load_dwordx4 a[164:167], v0, s[4:7], s36 offen offset:1024 sc1
    buffer_load_dwordx4 a[168:171], v0, s[4:7], s36 offen offset:2048 sc1
    buffer_load_dwordx4 a[172:175], v0, s[4:7], s36 offen offset:3072 sc1
    s_add_u32 s36, s36, 4096
    buffer_load_dwordx4 a[176:179], v0, s[4:7], s36 offen offset:0 sc1
    buffer_load_dwordx4 a[180:183], v0, s[4:7], s36 offen offset:1024 sc1
    buffer_load_dwordx4 a[184:187], v0, s[4:7], s36 offen offset:2048 sc1
    buffer_load_dwordx4 a[188:191], v0, s[4:7], s36 offen offset:3072 sc1
    s_add_u32 s36, s36, 4096
    buffer_load_dwordx4 a[192:195], v0, s[4:7], s36 offen offset:0 sc1
    buffer_load_dwordx4 a[196:199], v0, s[4:7], s36 offen offset:1024 sc1
    buffer_load_dwordx4 a[200:203], v0, s[4:7], s36 offen offset:2048 sc1
    buffer_load_dwordx4 a[204:207], v0, s[4:7], s36 offen offset:3072 sc1
    s_add_u32 s36, s36, 4096
    buffer_load_dwordx4 a[208:211], v0, s[4:7], s36 offen offset:0 sc1
    buffer_load_dwordx4 a[212:215], v0, s[4:7], s36 offen offset:1024 sc1
    buffer_load_dwordx4 a[216:219], v0, s[4:7], s36 offen offset:2048 sc1
    buffer_load_dwordx4 a[220:223], v0, s[4:7], s36 offen offset:3072 sc1
    v_mov_b32 v57, 16512
Y1_wb:
    ds_read_b32 v56, v57
    s_waitcnt lgkmcnt(0)
    v_cmp_gt_u32 vcc, 2, v56
    s_cbranch_vccz Y1_wb_ok
    s_sleep 1
    s_sub_u32 s35, s35, 1
    s_cmp_lg_u32 s35, 0
    s_cbranch_scc1 Y1_wb
    s_branch L_team_done
Y1_wb_ok:
    s_mul_i32 s36, s21, 229376
    s_add_u32 s36, s36, 7397376
    buffer_load_dwordx4 a[224:227], v0, s[4:7], s36 offen offset:0 sc1
    buffer_load_dwordx4 a[228:231], v0, s[4:7], s36 offen offset:1024 sc1
    buffer_load_dwordx4 a[232:235], v0, s[4:7], s36 offen offset:2048 sc1
    buffer_load_dwordx4 a[236:239], v0, s[4:7], s36 offen offset:3072 sc1
    s_add_u32 s36, s36, 4096
    buffer_load_dwordx4 a[240:243], v0, s[4:7], s36 offen offset:0 sc1
    buffer_load_dwordx4 a[244:247], v0, s[4:7], s36 offen offset:1024 sc1
    buffer_load_dwordx4 a[248:251], v0, s[4:7], s36 offen offset:2048 sc1
    buffer_load_dwordx4 a[252:255], v0, s[4:7], s36 offen offset:3072 sc1
    s_add_u32 s36, s36, 4096
    buffer_load_dwordx4 v[64:67], v0, s[4:7], s36 offen offset:0 sc1
    buffer_load_dwordx4 v[68:71], v0, s[4:7], s36 offen offset:1024 sc1
    buffer_load_dwordx4 v[72:75], v0, s[4:7], s36 offen offset:2048 sc1
    buffer_load_dwordx4 v[76:79], v0, s[4:7], s36 offen offset:3072 sc1
    s_add_u32 s36, s36, 4096
    buffer_load_dwordx4 v[80:83], v0, s[4:7], s36 offen offset:0 sc1
    buffer_load_dwordx4 v[84:87], v0, s[4:7], s36 offen offset:1024 sc1
    buffer_load_dwordx4 v[88:91], v0, s[4:7], s36 offen offset:2048 sc1
    buffer_load_dwordx4 v[92:95], v0, s[4:7], s36 offen offset:3072 sc1
    s_add_u32 s36, s36, 4096
    buffer_load_dwordx4 v[96:99], v0, s[4:7], s36 offen offset:0 sc1
    buffer_load_dwordx4 v[100:103], v0, s[4:7], s36 offen offset:1024 sc1
    buffer_load_dwordx4 v[104:107], v0, s[4:7], s36 offen offset:2048 sc1
    buffer_load_dwordx4 v[108:111], v0, s[4:7], s36 offen offset:3072 sc1
    s_add_u32 s36, s36, 4096
    buffer_load_dwordx4 v[112:115], v0, s[4:7], s36 offen offset:0 sc1
    buffer_load_dwordx4 v[116:119], v0, s[4:7], s36 offen offset:1024 sc1
    buffer_load_dwordx4 v[120:123], v0, s[4:7], s36 offen offset:2048 sc1
    buffer_load_dwordx4 v[124:127], v0, s[4:7], s36 offen offset:3072 sc1
    s_add_u32 s36, s36, 4096
    buffer_load_dwordx4 v[128:131], v0, s[4:7], s36 offen offset:0 sc1
    buffer_load_dwordx4 v[132:135], v0, s[4:7], s36 offen offset:1024 sc1
    buffer_load_dwordx4 v[136:139], v0, s[4:7], s36 offen offset:2048 sc1
    buffer_load_dwordx4 v[140:143], v0, s[4:7], s36 offen offset:3072 sc1
    s_add_u32 s36, s36, 4096
    buffer_load_dwordx4 v[144:147], v0, s[4:7], s36 offen offset:0 sc1
    buffer_load_dwordx4 v[148:151], v0, s[4:7], s36 offen offset:1024 sc1
    buffer_load_dwordx4 v[152:155], v0, s[4:7], s36 offen offset:2048 sc1
    buffer_load_dwordx4 v[156:159], v0, s[4:7], s36 offen offset:3072 sc1
    s_add_u32 s36, s36, 4096
    buffer_load_dwordx4 v[160:163], v0, s[4:7], s36 offen offset:0 sc1
    buffer_load_dwordx4 v[164:167], v0, s[4:7], s36 offen offset:1024 sc1
    buffer_load_dwordx4 v[168:171], v0, s[4:7], s36 offen offset:2048 sc1
    buffer_load_dwordx4 v[172:175], v0, s[4:7], s36 offen offset:3072 sc1
    s_add_u32 s36, s36, 4096
    buffer_load_dwordx4 v[176:179], v0, s[4:7], s36 offen offset:0 sc1
    buffer_load_dwordx4 v[180:183], v0, s[4:7], s36 offen offset:1024 sc1
    buffer_load_dwordx4 v[184:187], v0, s[4:7], s36 offen offset:2048 sc1
    buffer_load_dwordx4 v[188:191], v0, s[4:7], s36 offen offset:3072 sc1
    s_add_u32 s36, s36, 4096
    buffer_load_dwordx4 v[192:195], v0, s[4:7], s36 offen offset:0 sc1
    buffer_load_dwordx4 v[196:199], v0, s[4:7], s36 offen offset:1024 sc1
    buffer_load_dwordx4 v[200:203], v0, s[4:7], s36 offen offset:2048 sc1
    buffer_load_dwordx4 v[204:207], v0, s[4:7], s36 offen offset:3072 sc1
    s_add_u32 s36, s36, 4096
    buffer_load_dwordx4 v[208:211], v0, s[4:7], s36 offen offset:0 sc1
    buffer_load_dwordx4 v[212:215], v0, s[4:7], s36 offen offset:1024 sc1
    buffer_load_dwordx4 v[216:219], v0, s[4:7], s36 offen offset:2048 sc1
    buffer_load_dwordx4 v[220:223], v0, s[4:7], s36 offen offset:3072 sc1
    s_add_u32 s36, s36, 4096
    buffer_load_dwordx4 v[224:227], v0, s[4:7], s36 offen offset:0 sc1
    buffer_load_dwordx4 v[228:231], v0, s[4:7], s36 offen offset:1024 sc1
    buffer_load_dwordx4 v[232:235], v0, s[4:7], s36 offen offset:2048 sc1
    buffer_load_dwordx4 v[236:239], v0, s[4:7], s36 offen offset:3072 sc1
    s_add_u32 s36, s36, 4096
    buffer_load_dwordx4 v[240:243], v0, s[4:7], s36 offen offset:0 sc1
    buffer_load_dwordx4 v[244:247], v0, s[4:7], s36 offen offset:1024 sc1
    s_mul_i32 s36, s21, 229376
    s_add_u32 s36, s36, 7540736
    s_mov_b32 m0, 79872
    s_nop 0
    buffer_load_dwordx4 v0, s[4:7], s36 offen offset:0 sc1 lds
    buffer_load_dwordx4 v0, s[4:7], s36 offen offset:1024 sc1 lds
    buffer_load_dwordx4 v0, s[4:7], s36 offen offset:2048 sc1 lds
    buffer_load_dwordx4 v0, s[4:7], s36 offen offset:3072 sc1 lds
    s_mul_i32 s36, s21, 229376
    s_add_u32 s36, s36, 7544832
    s_mov_b32 m0, 83968
    s_nop 0
    buffer_load_dwordx4 v0, s[4:7], s36 offen offset:0 sc1 lds
    buffer_load_dwordx4 v0, s[4:7], s36 offen offset:1024 sc1 lds
    buffer_load_dwordx4 v0, s[4:7], s36 offen offset:2048 sc1 lds
    buffer_load_dwordx4 v0, s[4:7], s36 offen offset:3072 sc1 lds
    s_mul_i32 s36, s21, 229376
    s_add_u32 s36, s36, 7548928
    s_mov_b32 m0, 88064
    s_nop 0
    buffer_load_dwordx4 v0, s[4:7], s36 offen offset:0 sc1 lds
    buffer_load_dwordx4 v0, s[4:7], s36 offen offset:1024 sc1 lds
    buffer_load_dwordx4 v0, s[4:7], s36 offen offset:2048 sc1 lds
    buffer_load_dwordx4 v0, s[4:7], s36 offen offset:3072 sc1 lds
    s_mul_i32 s36, s21, 229376
    s_add_u32 s36, s36, 7553024
    s_mov_b32 m0, 92160
    s_nop 0
    buffer_load_dwordx4 v0, s[4:7], s36 offen offset:0 sc1 lds
    buffer_load_dwordx4 v0, s[4:7], s36 offen offset:1024 sc1 lds
    buffer_load_dwordx4 v0, s[4:7], s36 offen offset:2048 sc1 lds
    buffer_load_dwordx4 v0, s[4:7], s36 offen offset:3072 sc1 lds
    s_mul_i32 s36, s21, 229376
    s_add_u32 s36, s36, 7557120
    s_mov_b32 m0, 96256
    s_nop 0
    buffer_load_dwordx4 v0, s[4:7], s36 offen offset:0 sc1 lds
    buffer_load_dwordx4 v0, s[4:7], s36 offen offset:1024 sc1 lds
    buffer_load_dwordx4 v0, s[4:7], s36 offen offset:2048 sc1 lds
    buffer_load_dwordx4 v0, s[4:7], s36 offen offset:3072 sc1 lds
    s_mul_i32 s36, s21, 229376
    s_add_u32 s36, s36, 7561216
    s_mov_b32 m0, 100352
    s_nop 0
    buffer_load_dwordx4 v0, s[4:7], s36 offen offset:0 sc1 lds
    buffer_load_dwordx4 v0, s[4:7], s36 offen offset:1024 sc1 lds
    buffer_load_dwordx4 v0, s[4:7], s36 offen offset:2048 sc1 lds
    buffer_load_dwordx4 v0, s[4:7], s36 offen offset:3072 sc1 lds
    s_mul_i32 s36, s21, 229376
    s_add_u32 s36, s36, 7565312
    s_mov_b32 m0, 104448
    s_nop 0
    buffer_load_dwordx4 v0, s[4:7], s36 offen offset:0 sc1 lds
    buffer_load_dwordx4 v0, s[4:7], s36 offen offset:1024 sc1 lds
    buffer_load_dwordx4 v0, s[4:7], s36 offen offset:2048 sc1 lds
    buffer_load_dwordx4 v0, s[4:7], s36 offen offset:3072 sc1 lds
    s_mul_i32 s36, s21, 229376
    s_add_u32 s36, s36, 7452672
    s_mov_b32 m0, 108544
    s_nop 0
    buffer_load_dwordx4 v0, s[4:7], s36 offen offset:0 sc1 lds
    buffer_load_dwordx4 v0, s[4:7], s36 offen offset:1024 sc1 lds
    v_lshrrev_b32 v63, 3, v61
    v_lshlrev_b32 v3, 8, v63
    v_lshl_add_u32 v3, v62, 6, v3
    v_bfe_u32 v63, v61, 1, 1
    v_lshl_add_u32 v3, v63, 4, v3
    v_bfe_u32 v63, v61, 2, 1
    v_lshl_add_u32 v3, v63, 3, v3
    v_and_b32 v63, 1, v61
    v_lshl_add_u32 v3, v63, 2, v3
    v_add_u32 v3, 8704, v3
    v_add_u32 v5, 2048, v3
    v_lshrrev_b32 v63, 1, v62
    v_lshlrev_b32 v6, 8, v63
    v_lshl_add_u32 v6, v61, 4, v6
    v_and_b32 v63, 1, v62
    v_lshl_add_u32 v6, v63, 3, v6
    v_add_u32 v6, 13312, v6
    v_add_u32 v7, 79872, v0
    v_mov_b32 v4, 16448
    v_and_b32 v2, 31, v60
    v_lshlrev_b32 v2, 2, v2
    s_mul_i32 s31, s19, 14336
    s_add_u32 s31, s31, 25165824
    s_mov_b32 s46, 49152
    s_getpc_b64 s[40:41]
Y1_ref:
    v_lshlrev_b32 v56, 2, v0
    v_add_u32 v56, Y1_loop - Y1_ref, v56
    global_load_dword v57, v56, s[40:41]
    v_add_u32 v56, 4096, v56
    global_load_dword v57, v56, s[40:41]
    s_waitcnt vmcnt(0) lgkmcnt(0)
    s_cmp_lg_u32 s16, 0
    s_cbranch_scc1 Y1_nogo
    v_mov_b32 v56, 1
    v_mov_b32 v57, 192
    buffer_store_dword v56, v57, s[12:15], 0 offen sc1
Y1_nogo:
    s_barrier
    v_mov_b32 v58, 16384
    ds_read_b32 v58, v58
    s_waitcnt lgkmcnt(0)
    v_readfirstlane_b32 s23, v58
    s_cmp_lg_u32 s23, 0
    s_cbranch_scc1 Y1_far
Y1_loop:
    s_add_u32 s45, s24, 2048
    v_mov_b32 v12, 0
    v_mov_b32 v13, 0
    v_mov_b32 v14, 0
    v_mov_b32 v15, 0
    v_mov_b32 v16, 0
    v_mov_b32 v17, 0
    v_mov_b32 v18, 0
    v_mov_b32 v19, 0
    v_mov_b32 v20, 0
    v_mov_b32 v21, 0
    v_mov_b32 v22, 0
    v_mov_b32 v23, 0
    v_mov_b32 v24, 0
    v_mov_b32 v25, 0
    v_mov_b32 v26, 0
    v_mov_b32 v27, 0
    s_waitcnt vmcnt(0)
    s_mov_b32 m0, 2048
    s_barrier
    buffer_load_dwordx4 v0, s[4:7], s45 offen sc1 lds
    s_barrier
    buffer_load_dwordx4 v0, s[4:7], s45 offen offset:3072 sc1 lds
    s_barrier
    ds_read_b128 v[28:31], v0 offset:0
    s_waitcnt vmcnt(1)
    s_barrier
    ds_read_b128 v[32:35], v0 offset:1024
    ds_read_b128 v[36:39], v0 offset:2048
    ds_read_b128 v[52:55], v0 offset:6144
    s_waitcnt lgkmcnt(3)
    v_smfmac_f32_16x16x64_bf16 v[12:15], v[28:31], a[0:7], v1
    v_smfmac_f32_16x16x64_bf16 v[16:19], v[28:31], a[56:63], v1
    v_smfmac_f32_16x16x64_bf16 v[20:23], v[28:31], a[112:119], v1
    s_waitcnt vmcnt(0)
    s_barrier
    v_smfmac_f32_16x16x64_bf16 v[24:27], v[28:31], a[168:175], v1
    ds_read_b128 v[40:43], v0 offset:3072
    ds_read_b128 v[44:47], v0 offset:4096
    ds_read_b128 v[48:51], v0 offset:5120
Y1_y:
    s_waitcnt lgkmcnt(5)
    v_smfmac_f32_16x16x64_bf16 v[12:15], v[32:35], a[8:15], v1
    v_smfmac_f32_16x16x64_bf16 v[16:19], v[32:35], a[64:71], v1
    v_smfmac_f32_16x16x64_bf16 v[20:23], v[32:35], a[120:127], v1
    v_smfmac_f32_16x16x64_bf16 v[24:27], v[32:35], a[176:183], v1
    s_waitcnt lgkmcnt(4)
    v_smfmac_f32_16x16x64_bf16 v[12:15], v[36:39], a[16:23], v1
    v_smfmac_f32_16x16x64_bf16 v[16:19], v[36:39], a[72:79], v1
    s_waitcnt lgkmcnt(3)
    v_smfmac_f32_16x16x64_bf16 v[12:15], v[52:55], a[48:55], v1
    v_smfmac_f32_16x16x64_bf16 v[16:19], v[52:55], a[104:111], v1
    s_waitcnt lgkmcnt(2)
    v_smfmac_f32_16x16x64_bf16 v[12:15], v[40:43], a[24:31], v1
    v_smfmac_f32_16x16x64_bf16 v[16:19], v[40:43], a[80:87], v1
    s_waitcnt lgkmcnt(1)
    v_smfmac_f32_16x16x64_bf16 v[12:15], v[44:47], a[32:39], v1
    v_smfmac_f32_16x16x64_bf16 v[16:19], v[44:47], a[88:95], v1
    s_waitcnt lgkmcnt(0)
    v_smfmac_f32_16x16x64_bf16 v[12:15], v[48:51], a[40:47], v1
    v_smfmac_f32_16x16x64_bf16 v[16:19], v[48:51], a[96:103], v1
    v_smfmac_f32_16x16x64_bf16 v[20:23], v[36:39], a[128:135], v1
    s_nop 1
    v_smfmac_f32_16x16x64_bf16 v[24:27], v[36:39], a[184:191], v1
    s_nop 1
    v_smfmac_f32_16x16x64_bf16 v[20:23], v[52:55], a[160:167], v1
    v_add_f32 v12, v12, v13
    v_add_f32 v14, v14, v15
    v_smfmac_f32_16x16x64_bf16 v[24:27], v[52:55], a[216:223], v1
    v_add_f32 v16, v16, v17
    v_add_f32 v18, v18, v19
    v_smfmac_f32_16x16x64_bf16 v[20:23], v[40:43], a[136:143], v1
    v_cvt_pk_bf16_f32 v8, v12, v16
    v_cvt_pk_bf16_f32 v9, v14, v18
    v_smfmac_f32_16x16x64_bf16 v[24:27], v[40:43], a[192:199], v1
    ds_write2_b32 v3, v8, v9 offset0:0 offset1:8
    v_cmp_u_f32 vcc, v12, v14
    v_smfmac_f32_16x16x64_bf16 v[20:23], v[44:47], a[144:151], v1
    v_mov_b32 v12, 0
    v_mov_b32 v13, 0
    v_smfmac_f32_16x16x64_bf16 v[24:27], v[44:47], a[200:207], v1
    v_mov_b32 v14, 0
    v_mov_b32 v15, 0
    v_smfmac_f32_16x16x64_bf16 v[20:23], v[48:51], a[152:159], v1
    s_waitcnt lgkmcnt(0)
    s_barrier
    v_smfmac_f32_16x16x64_bf16 v[24:27], v[48:51], a[208:215], v1
    v_mov_b32 v16, 0
    v_mov_b32 v17, 0
    v_mov_b32 v18, 0
    v_mov_b32 v19, 0
    s_nop 1
    v_add_f32 v20, v20, v21
    v_add_f32 v22, v22, v23
    v_add_f32 v24, v24, v25
    v_add_f32 v26, v26, v27
    v_cvt_pk_bf16_f32 v10, v20, v24
    v_cvt_pk_bf16_f32 v11, v22, v26
    ds_write2_b32 v5, v10, v11 offset0:0 offset1:8
    s_cbranch_vccnz Y1_fail
Y1_yok:
    v_mov_b32 v20, 0
    v_mov_b32 v21, 0
    v_mov_b32 v22, 0
    v_mov_b32 v23, 0
    v_mov_b32 v24, 0
    v_mov_b32 v25, 0
    v_mov_b32 v26, 0
    v_mov_b32 v27, 0
    s_waitcnt lgkmcnt(0)
    s_barrier
    v_smfmac_f32_16x16x64_bf16 v[24:27], v[28:31], v[144:151], v1
    v_smfmac_f32_16x16x64_bf16 v[24:27], v[32:35], v[152:159], v1
    v_smfmac_f32_16x16x64_bf16 v[24:27], v[36:39], v[160:167], v1
    v_smfmac_f32_16x16x64_bf16 v[24:27], v[40:43], v[168:175], v1
    v_smfmac_f32_16x16x64_bf16 v[24:27], v[44:47], v[176:183], v1
    ds_read_b128 v[56:59], v7 offset:0
    ds_read_b128 v[60:63], v7 offset:1024
    v_smfmac_f32_16x16x64_bf16 v[24:27], v[48:51], v[184:191], v1
    ds_read_b128 v[248:251], v7 offset:2048
    ds_read_b128 v[252:255], v7 offset:3072
    v_smfmac_f32_16x16x64_bf16 v[24:27], v[52:55], v[192:199], v1
    v_smfmac_f32_16x16x64_bf16 v[12:15], v[28:31], a[224:231], v1
    v_smfmac_f32_16x16x64_bf16 v[16:19], v[28:31], v[88:95], v1
    s_waitcnt lgkmcnt(2)
    v_smfmac_f32_16x16x64_bf16 v[20:23], v[28:31], v[56:63], v1
    ds_read_b128 v[56:59], v7 offset:4096
    ds_read_b128 v[60:63], v7 offset:5120
    v_smfmac_f32_16x16x64_bf16 v[12:15], v[32:35], a[232:239], v1
    v_smfmac_f32_16x16x64_bf16 v[16:19], v[32:35], v[96:103], v1
    s_waitcnt lgkmcnt(2)
    v_smfmac_f32_16x16x64_bf16 v[20:23], v[32:35], v[248:255], v1
    ds_read_b128 v[248:251], v7 offset:6144
    ds_read_b128 v[252:255], v7 offset:7168
    v_smfmac_f32_16x16x64_bf16 v[12:15], v[36:39], a[240:247], v1
    v_smfmac_f32_16x16x64_bf16 v[16:19], v[36:39], v[104:111], v1
    s_waitcnt lgkmcnt(2)
    v_smfmac_f32_16x16x64_bf16 v[20:23], v[36:39], v[56:63], v1
    ds_read_b128 v[56:59], v7 offset:8192
    ds_read_b128 v[60:63], v7 offset:9216
    v_add_f32 v24, v24, v25
    v_add_f32 v26, v26, v27
    v_cvt_pk_bf16_f32 v10, v24, v26
    v_mov_b32 v24, 0
    v_mov_b32 v25, 0
    v_mov_b32 v26, 0
    v_mov_b32 v27, 0
    v_smfmac_f32_16x16x64_bf16 v[12:15], v[40:43], a[248:255], v1
    v_smfmac_f32_16x16x64_bf16 v[16:19], v[40:43], v[112:119], v1
    s_waitcnt lgkmcnt(2)
    v_smfmac_f32_16x16x64_bf16 v[20:23], v[40:43], v[248:255], v1
    ds_read_b128 v[248:251], v7 offset:10240
    ds_read_b128 v[252:255], v7 offset:11264
    v_smfmac_f32_16x16x64_bf16 v[12:15], v[44:47], v[64:71], v1
    v_smfmac_f32_16x16x64_bf16 v[16:19], v[44:47], v[120:127], v1
    s_waitcnt lgkmcnt(2)
    v_smfmac_f32_16x16x64_bf16 v[20:23], v[44:47], v[56:63], v1
    ds_read_b128 v[56:59], v7 offset:12288
    ds_read_b128 v[60:63], v7 offset:13312
    v_smfmac_f32_16x16x64_bf16 v[12:15], v[48:51], v[72:79], v1
    v_smfmac_f32_16x16x64_bf16 v[16:19], v[48:51], v[128:135], v1
    s_waitcnt lgkmcnt(2)
    v_smfmac_f32_16x16x64_bf16 v[20:23], v[48:51], v[248:255], v1
    ds_read_b128 v[248:251], v7 offset:14336
    ds_read_b128 v[252:255], v7 offset:15360
    v_smfmac_f32_16x16x64_bf16 v[12:15], v[52:55], v[80:87], v1
    v_smfmac_f32_16x16x64_bf16 v[16:19], v[52:55], v[136:143], v1
    s_waitcnt lgkmcnt(2)
    v_smfmac_f32_16x16x64_bf16 v[20:23], v[52:55], v[56:63], v1
    ds_read_b128 v[56:59], v7 offset:16384
    ds_read_b128 v[60:63], v7 offset:17408
    v_smfmac_f32_16x16x64_bf16 v[24:27], v[28:31], v[200:207], v1
    s_nop 3
    v_add_f32 v12, v12, v13
    v_add_f32 v14, v14, v15
    v_smfmac_f32_16x16x64_bf16 v[24:27], v[32:35], v[208:215], v1
    v_cvt_pk_bf16_f32 v8, v12, v14
    v_add_f32 v16, v16, v17
    v_add_f32 v18, v18, v19
    v_smfmac_f32_16x16x64_bf16 v[24:27], v[36:39], v[216:223], v1
    v_cvt_pk_bf16_f32 v9, v16, v18
    v_mov_b32 v12, 0
    v_mov_b32 v13, 0
    v_smfmac_f32_16x16x64_bf16 v[24:27], v[40:43], v[224:231], v1
    v_mov_b32 v14, 0
    v_mov_b32 v15, 0
    ds_write_b64 v6, v[8:9]
    v_smfmac_f32_16x16x64_bf16 v[24:27], v[44:47], v[232:239], v1
    v_add_f32 v20, v20, v21
    v_add_f32 v22, v22, v23
    v_cvt_pk_bf16_f32 v8, v20, v22
    v_smfmac_f32_16x16x64_bf16 v[24:27], v[48:51], v[240:247], v1
    s_waitcnt lgkmcnt(3)
    v_smfmac_f32_16x16x64_bf16 v[12:15], v[28:31], v[248:255], v1
    ds_read_b128 v[248:251], v7 offset:18432
    ds_read_b128 v[252:255], v7 offset:19456
    s_waitcnt lgkmcnt(3)
    v_smfmac_f32_16x16x64_bf16 v[12:15], v[32:35], v[56:63], v1
    ds_read_b128 v[56:59], v7 offset:20480
    ds_read_b128 v[60:63], v7 offset:21504
    s_waitcnt lgkmcnt(2)
    v_smfmac_f32_16x16x64_bf16 v[12:15], v[36:39], v[248:255], v1
    ds_read_b128 v[248:251], v7 offset:22528
    ds_read_b128 v[252:255], v7 offset:23552
    s_waitcnt lgkmcnt(2)
    v_smfmac_f32_16x16x64_bf16 v[12:15], v[40:43], v[56:63], v1
    ds_read_b128 v[56:59], v7 offset:24576
    ds_read_b128 v[60:63], v7 offset:25600
    s_waitcnt lgkmcnt(2)
    v_smfmac_f32_16x16x64_bf16 v[12:15], v[44:47], v[248:255], v1
    ds_read_b128 v[248:251], v7 offset:26624
    ds_read_b128 v[252:255], v7 offset:27648
    s_waitcnt lgkmcnt(2)
    v_smfmac_f32_16x16x64_bf16 v[12:15], v[48:51], v[56:63], v1
    ds_read_b128 v[56:59], v7 offset:28672
    ds_read_b128 v[60:63], v7 offset:29696
    s_waitcnt lgkmcnt(2)
    v_smfmac_f32_16x16x64_bf16 v[12:15], v[52:55], v[248:255], v1
    s_waitcnt lgkmcnt(0)
    v_smfmac_f32_16x16x64_bf16 v[24:27], v[52:55], v[56:63], v1
    s_nop 6
    v_add_f32 v12, v12, v13
    v_add_f32 v14, v14, v15
    v_cvt_pk_bf16_f32 v9, v12, v14
    v_add_f32 v24, v24, v25
    v_add_f32 v26, v26, v27
    v_cvt_pk_bf16_f32 v11, v24, v26
    ds_write_b64 v6, v[8:9] offset:2560
    ds_write_b64 v6, v[10:11] offset:512
    s_waitcnt lgkmcnt(0)
    s_barrier
    s_mov_b32 s26, s24
    s_mov_b32 s24, s25
    s_add_u32 s25, s25, 0x10000
    s_and_b32 s25, s25, 14876672
    s_add_u32 s20, s20, 1
    s_cmp_lt_u32 s20, 63
    s_cbranch_scc1 Y1_loop
    s_branch L_team_done
Y1_fail:
    v_max_u32 v56, v28, v29
    v_max3_u32 v56, v56, v30, v31
    v_max3_u32 v56, v56, v32, v33
    v_max3_u32 v56, v56, v34, v35
    v_max3_u32 v56, v56, v36, v37
    v_max3_u32 v56, v56, v38, v39
    v_max3_u32 v56, v56, v40, v41
    v_max3_u32 v56, v56, v42, v43
    v_max3_u32 v56, v56, v44, v45
    v_max3_u32 v56, v56, v46, v47
    v_max3_u32 v56, v56, v48, v49
    v_max3_u32 v56, v56, v50, v51
    v_max3_u32 v56, v56, v52, v53
    v_max3_u32 v56, v56, v54, v55
    v_cmp_eq_u32 vcc, -1, v56
    s_cbranch_vccz Y1_yok
    s_waitcnt lgkmcnt(0)
    s_sub_u32 s35, s35, 1
    s_cmp_eq_u32 s35, 0
    s_cbranch_scc1 L_team_done
    v_mov_b32 v12, 0
    v_mov_b32 v13, 0
    v_mov_b32 v14, 0
    v_mov_b32 v15, 0
    v_mov_b32 v16, 0
    v_mov_b32 v17, 0
    v_mov_b32 v18, 0
    v_mov_b32 v19, 0
    v_mov_b32 v20, 0
    v_mov_b32 v21, 0
    v_mov_b32 v22, 0
    v_mov_b32 v23, 0
    v_mov_b32 v24, 0
    v_mov_b32 v25, 0
    v_mov_b32 v26, 0
    v_mov_b32 v27, 0
    s_mov_b32 m0, 2048
    s_barrier
    buffer_load_dwordx4 v0, s[4:7], s45 offen sc1 lds
    buffer_load_dwordx4 v0, s[4:7], s45 offen offset:3072 sc1 lds
    s_waitcnt vmcnt(0)
    s_barrier
    ds_read_b128 v[28:31], v0 offset:0
    ds_read_b128 v[32:35], v0 offset:1024
    ds_read_b128 v[36:39], v0 offset:2048
    ds_read_b128 v[52:55], v0 offset:6144
    ds_read_b128 v[40:43], v0 offset:3072
    ds_read_b128 v[44:47], v0 offset:4096
    ds_read_b128 v[48:51], v0 offset:5120
    s_waitcnt lgkmcnt(6)
    v_smfmac_f32_16x16x64_bf16 v[12:15], v[28:31], a[0:7], v1
    v_smfmac_f32_16x16x64_bf16 v[16:19], v[28:31], a[56:63], v1
    v_smfmac_f32_16x16x64_bf16 v[20:23], v[28:31], a[112:119], v1
    v_smfmac_f32_16x16x64_bf16 v[24:27], v[28:31], a[168:175], v1
    s_branch Y1_y
Y1_far:
Y1f_loop:
    s_add_u32 s45, s24, 2048
    v_mov_b32 v12, 0
    v_mov_b32 v13, 0
    v_mov_b32 v14, 0
    v_mov_b32 v15, 0
    v_mov_b32 v16, 0
    v_mov_b32 v17, 0
    v_mov_b32 v18, 0
    v_mov_b32 v19, 0
    v_mov_b32 v20, 0
    v_mov_b32 v21, 0
    v_mov_b32 v22, 0
    v_mov_b32 v23, 0
    v_mov_b32 v24, 0
    v_mov_b32 v25, 0
    v_mov_b32 v26, 0
    v_mov_b32 v27, 0
    s_waitcnt vmcnt(0)
    s_mov_b32 m0, 2048
    s_barrier
    buffer_load_dwordx4 v0, s[4:7], s45 offen sc1 lds
    s_barrier
    buffer_load_dwordx4 v0, s[4:7], s45 offen offset:3072 sc1 lds
    s_barrier
    ds_read_b128 v[28:31], v0 offset:0
    s_waitcnt vmcnt(1)
    s_barrier
    ds_read_b128 v[32:35], v0 offset:1024
    ds_read_b128 v[36:39], v0 offset:2048
    ds_read_b128 v[52:55], v0 offset:6144
    s_waitcnt lgkmcnt(3)
    v_smfmac_f32_16x16x64_bf16 v[12:15], v[28:31], a[0:7], v1
    v_smfmac_f32_16x16x64_bf16 v[16:19], v[28:31], a[56:63], v1
    v_smfmac_f32_16x16x64_bf16 v[20:23], v[28:31], a[112:119], v1
    s_waitcnt vmcnt(0)
    s_barrier
    v_smfmac_f32_16x16x64_bf16 v[24:27], v[28:31], a[168:175], v1
    ds_read_b128 v[40:43], v0 offset:3072
    ds_read_b128 v[44:47], v0 offset:4096
    ds_read_b128 v[48:51], v0 offset:5120
Y1f_y:
    s_waitcnt lgkmcnt(5)
    v_smfmac_f32_16x16x64_bf16 v[12:15], v[32:35], a[8:15], v1
    v_smfmac_f32_16x16x64_bf16 v[16:19], v[32:35], a[64:71], v1
    v_smfmac_f32_16x16x64_bf16 v[20:23], v[32:35], a[120:127], v1
    v_smfmac_f32_16x16x64_bf16 v[24:27], v[32:35], a[176:183], v1
    s_waitcnt lgkmcnt(4)
    v_smfmac_f32_16x16x64_bf16 v[12:15], v[36:39], a[16:23], v1
    v_smfmac_f32_16x16x64_bf16 v[16:19], v[36:39], a[72:79], v1
    s_waitcnt lgkmcnt(3)
    v_smfmac_f32_16x16x64_bf16 v[12:15], v[52:55], a[48:55], v1
    v_smfmac_f32_16x16x64_bf16 v[16:19], v[52:55], a[104:111], v1
    s_waitcnt lgkmcnt(2)
    v_smfmac_f32_16x16x64_bf16 v[12:15], v[40:43], a[24:31], v1
    v_smfmac_f32_16x16x64_bf16 v[16:19], v[40:43], a[80:87], v1
    s_waitcnt lgkmcnt(1)
    v_smfmac_f32_16x16x64_bf16 v[12:15], v[44:47], a[32:39], v1
    v_smfmac_f32_16x16x64_bf16 v[16:19], v[44:47], a[88:95], v1
    s_waitcnt lgkmcnt(0)
    v_smfmac_f32_16x16x64_bf16 v[12:15], v[48:51], a[40:47], v1
    v_smfmac_f32_16x16x64_bf16 v[16:19], v[48:51], a[96:103], v1
    v_smfmac_f32_16x16x64_bf16 v[20:23], v[36:39], a[128:135], v1
    s_nop 1
    v_smfmac_f32_16x16x64_bf16 v[24:27], v[36:39], a[184:191], v1
    s_nop 1
    v_smfmac_f32_16x16x64_bf16 v[20:23], v[52:55], a[160:167], v1
    v_add_f32 v12, v12, v13
    v_add_f32 v14, v14, v15
    v_smfmac_f32_16x16x64_bf16 v[24:27], v[52:55], a[216:223], v1
    v_add_f32 v16, v16, v17
    v_add_f32 v18, v18, v19
    v_smfmac_f32_16x16x64_bf16 v[20:23], v[40:43], a[136:143], v1
    v_cvt_pk_bf16_f32 v8, v12, v16
    v_cvt_pk_bf16_f32 v9, v14, v18
    v_smfmac_f32_16x16x64_bf16 v[24:27], v[40:43], a[192:199], v1
    ds_write2_b32 v3, v8, v9 offset0:0 offset1:8
    v_cmp_u_f32 vcc, v12, v14
    v_smfmac_f32_16x16x64_bf16 v[20:23], v[44:47], a[144:151], v1
    v_mov_b32 v12, 0
    v_mov_b32 v13, 0
    v_smfmac_f32_16x16x64_bf16 v[24:27], v[44:47], a[200:207], v1
    v_mov_b32 v14, 0
    v_mov_b32 v15, 0
    v_smfmac_f32_16x16x64_bf16 v[20:23], v[48:51], a[152:159], v1
    s_waitcnt lgkmcnt(0)
    s_barrier
    v_smfmac_f32_16x16x64_bf16 v[24:27], v[48:51], a[208:215], v1
    v_mov_b32 v16, 0
    v_mov_b32 v17, 0
    v_mov_b32 v18, 0
    v_mov_b32 v19, 0
    s_nop 1
    v_add_f32 v20, v20, v21
    v_add_f32 v22, v22, v23
    v_add_f32 v24, v24, v25
    v_add_f32 v26, v26, v27
    v_cvt_pk_bf16_f32 v10, v20, v24
    v_cvt_pk_bf16_f32 v11, v22, v26
    ds_write2_b32 v5, v10, v11 offset0:0 offset1:8
    s_cbranch_vccnz Y1f_fail
Y1f_yok:
    v_mov_b32 v20, 0
    v_mov_b32 v21, 0
    v_mov_b32 v22, 0
    v_mov_b32 v23, 0
    v_mov_b32 v24, 0
    v_mov_b32 v25, 0
    v_mov_b32 v26, 0
    v_mov_b32 v27, 0
    s_waitcnt lgkmcnt(0)
    s_barrier
    v_smfmac_f32_16x16x64_bf16 v[24:27], v[28:31], v[144:151], v1
    v_smfmac_f32_16x16x64_bf16 v[24:27], v[32:35], v[152:159], v1
    v_smfmac_f32_16x16x64_bf16 v[24:27], v[36:39], v[160:167], v1
    v_smfmac_f32_16x16x64_bf16 v[24:27], v[40:43], v[168:175], v1
    v_smfmac_f32_16x16x64_bf16 v[24:27], v[44:47], v[176:183], v1
    ds_read_b128 v[56:59], v7 offset:0
    ds_read_b128 v[60:63], v7 offset:1024
    v_smfmac_f32_16x16x64_bf16 v[24:27], v[48:51], v[184:191], v1
    ds_read_b128 v[248:251], v7 offset:2048
    ds_read_b128 v[252:255], v7 offset:3072
    v_smfmac_f32_16x16x64_bf16 v[24:27], v[52:55], v[192:199], v1
    v_smfmac_f32_16x16x64_bf16 v[12:15], v[28:31], a[224:231], v1
    v_smfmac_f32_16x16x64_bf16 v[16:19], v[28:31], v[88:95], v1
    s_waitcnt lgkmcnt(2)
    v_smfmac_f32_16x16x64_bf16 v[20:23], v[28:31], v[56:63], v1
    ds_read_b128 v[56:59], v7 offset:4096
    ds_read_b128 v[60:63], v7 offset:5120
    v_smfmac_f32_16x16x64_bf16 v[12:15], v[32:35], a[232:239], v1
    v_smfmac_f32_16x16x64_bf16 v[16:19], v[32:35], v[96:103], v1
    s_waitcnt lgkmcnt(2)
    v_smfmac_f32_16x16x64_bf16 v[20:23], v[32:35], v[248:255], v1
    ds_read_b128 v[248:251], v7 offset:6144
    ds_read_b128 v[252:255], v7 offset:7168
    v_smfmac_f32_16x16x64_bf16 v[12:15], v[36:39], a[240:247], v1
    v_smfmac_f32_16x16x64_bf16 v[16:19], v[36:39], v[104:111], v1
    s_waitcnt lgkmcnt(2)
    v_smfmac_f32_16x16x64_bf16 v[20:23], v[36:39], v[56:63], v1
    ds_read_b128 v[56:59], v7 offset:8192
    ds_read_b128 v[60:63], v7 offset:9216
    v_add_f32 v24, v24, v25
    v_add_f32 v26, v26, v27
    v_cvt_pk_bf16_f32 v10, v24, v26
    v_mov_b32 v24, 0
    v_mov_b32 v25, 0
    v_mov_b32 v26, 0
    v_mov_b32 v27, 0
    v_smfmac_f32_16x16x64_bf16 v[12:15], v[40:43], a[248:255], v1
    v_smfmac_f32_16x16x64_bf16 v[16:19], v[40:43], v[112:119], v1
    s_waitcnt lgkmcnt(2)
    v_smfmac_f32_16x16x64_bf16 v[20:23], v[40:43], v[248:255], v1
    ds_read_b128 v[248:251], v7 offset:10240
    ds_read_b128 v[252:255], v7 offset:11264
    v_smfmac_f32_16x16x64_bf16 v[12:15], v[44:47], v[64:71], v1
    v_smfmac_f32_16x16x64_bf16 v[16:19], v[44:47], v[120:127], v1
    s_waitcnt lgkmcnt(2)
    v_smfmac_f32_16x16x64_bf16 v[20:23], v[44:47], v[56:63], v1
    ds_read_b128 v[56:59], v7 offset:12288
    ds_read_b128 v[60:63], v7 offset:13312
    v_smfmac_f32_16x16x64_bf16 v[12:15], v[48:51], v[72:79], v1
    v_smfmac_f32_16x16x64_bf16 v[16:19], v[48:51], v[128:135], v1
    s_waitcnt lgkmcnt(2)
    v_smfmac_f32_16x16x64_bf16 v[20:23], v[48:51], v[248:255], v1
    ds_read_b128 v[248:251], v7 offset:14336
    ds_read_b128 v[252:255], v7 offset:15360
    v_smfmac_f32_16x16x64_bf16 v[12:15], v[52:55], v[80:87], v1
    v_smfmac_f32_16x16x64_bf16 v[16:19], v[52:55], v[136:143], v1
    s_waitcnt lgkmcnt(2)
    v_smfmac_f32_16x16x64_bf16 v[20:23], v[52:55], v[56:63], v1
    ds_read_b128 v[56:59], v7 offset:16384
    ds_read_b128 v[60:63], v7 offset:17408
    v_smfmac_f32_16x16x64_bf16 v[24:27], v[28:31], v[200:207], v1
    s_nop 3
    v_add_f32 v12, v12, v13
    v_add_f32 v14, v14, v15
    v_smfmac_f32_16x16x64_bf16 v[24:27], v[32:35], v[208:215], v1
    v_cvt_pk_bf16_f32 v8, v12, v14
    v_add_f32 v16, v16, v17
    v_add_f32 v18, v18, v19
    v_smfmac_f32_16x16x64_bf16 v[24:27], v[36:39], v[216:223], v1
    v_cvt_pk_bf16_f32 v9, v16, v18
    v_mov_b32 v12, 0
    v_mov_b32 v13, 0
    v_smfmac_f32_16x16x64_bf16 v[24:27], v[40:43], v[224:231], v1
    v_mov_b32 v14, 0
    v_mov_b32 v15, 0
    ds_write_b64 v6, v[8:9]
    v_smfmac_f32_16x16x64_bf16 v[24:27], v[44:47], v[232:239], v1
    v_add_f32 v20, v20, v21
    v_add_f32 v22, v22, v23
    v_cvt_pk_bf16_f32 v8, v20, v22
    v_smfmac_f32_16x16x64_bf16 v[24:27], v[48:51], v[240:247], v1
    s_waitcnt lgkmcnt(3)
    v_smfmac_f32_16x16x64_bf16 v[12:15], v[28:31], v[248:255], v1
    ds_read_b128 v[248:251], v7 offset:18432
    ds_read_b128 v[252:255], v7 offset:19456
    s_waitcnt lgkmcnt(3)
    v_smfmac_f32_16x16x64_bf16 v[12:15], v[32:35], v[56:63], v1
    ds_read_b128 v[56:59], v7 offset:20480
    ds_read_b128 v[60:63], v7 offset:21504
    s_waitcnt lgkmcnt(2)
    v_smfmac_f32_16x16x64_bf16 v[12:15], v[36:39], v[248:255], v1
    ds_read_b128 v[248:251], v7 offset:22528
    ds_read_b128 v[252:255], v7 offset:23552
    s_waitcnt lgkmcnt(2)
    v_smfmac_f32_16x16x64_bf16 v[12:15], v[40:43], v[56:63], v1
    ds_read_b128 v[56:59], v7 offset:24576
    ds_read_b128 v[60:63], v7 offset:25600
    s_waitcnt lgkmcnt(2)
    v_smfmac_f32_16x16x64_bf16 v[12:15], v[44:47], v[248:255], v1
    ds_read_b128 v[248:251], v7 offset:26624
    ds_read_b128 v[252:255], v7 offset:27648
    s_waitcnt lgkmcnt(2)
    v_smfmac_f32_16x16x64_bf16 v[12:15], v[48:51], v[56:63], v1
    ds_read_b128 v[56:59], v7 offset:28672
    ds_read_b128 v[60:63], v7 offset:29696
    s_waitcnt lgkmcnt(2)
    v_smfmac_f32_16x16x64_bf16 v[12:15], v[52:55], v[248:255], v1
    s_waitcnt lgkmcnt(0)
    v_smfmac_f32_16x16x64_bf16 v[24:27], v[52:55], v[56:63], v1
    s_nop 6
    v_add_f32 v12, v12, v13
    v_add_f32 v14, v14, v15
    v_cvt_pk_bf16_f32 v9, v12, v14
    v_add_f32 v24, v24, v25
    v_add_f32 v26, v26, v27
    v_cvt_pk_bf16_f32 v11, v24, v26
    ds_write_b64 v6, v[8:9] offset:2560
    ds_write_b64 v6, v[10:11] offset:512
    s_waitcnt lgkmcnt(0)
    s_barrier
    s_mov_b32 s26, s24
    s_mov_b32 s24, s25
    s_add_u32 s25, s25, 0x10000
    s_and_b32 s25, s25, 14876672
    s_add_u32 s20, s20, 1
    s_cmp_lt_u32 s20, 63
    s_cbranch_scc1 Y1f_loop
    s_branch L_team_done
Y1f_fail:
    v_max_u32 v56, v28, v29
    v_max3_u32 v56, v56, v30, v31
    v_max3_u32 v56, v56, v32, v33
    v_max3_u32 v56, v56, v34, v35
    v_max3_u32 v56, v56, v36, v37
    v_max3_u32 v56, v56, v38, v39
    v_max3_u32 v56, v56, v40, v41
    v_max3_u32 v56, v56, v42, v43
    v_max3_u32 v56, v56, v44, v45
    v_max3_u32 v56, v56, v46, v47
    v_max3_u32 v56, v56, v48, v49
    v_max3_u32 v56, v56, v50, v51
    v_max3_u32 v56, v56, v52, v53
    v_max3_u32 v56, v56, v54, v55
    v_cmp_eq_u32 vcc, -1, v56
    s_cbranch_vccz Y1f_yok
    s_waitcnt lgkmcnt(0)
    s_sub_u32 s35, s35, 1
    s_cmp_eq_u32 s35, 0
    s_cbranch_scc1 L_team_done
    v_mov_b32 v12, 0
    v_mov_b32 v13, 0
    v_mov_b32 v14, 0
    v_mov_b32 v15, 0
    v_mov_b32 v16, 0
    v_mov_b32 v17, 0
    v_mov_b32 v18, 0
    v_mov_b32 v19, 0
    v_mov_b32 v20, 0
    v_mov_b32 v21, 0
    v_mov_b32 v22, 0
    v_mov_b32 v23, 0
    v_mov_b32 v24, 0
    v_mov_b32 v25, 0
    v_mov_b32 v26, 0
    v_mov_b32 v27, 0
    s_mov_b32 m0, 2048
    s_barrier
    buffer_load_dwordx4 v0, s[4:7], s45 offen sc1 lds
    buffer_load_dwordx4 v0, s[4:7], s45 offen offset:3072 sc1 lds
    s_waitcnt vmcnt(0)
    s_barrier
    ds_read_b128 v[28:31], v0 offset:0
    ds_read_b128 v[32:35], v0 offset:1024
    ds_read_b128 v[36:39], v0 offset:2048
    ds_read_b128 v[52:55], v0 offset:6144
    ds_read_b128 v[40:43], v0 offset:3072
    ds_read_b128 v[44:47], v0 offset:4096
    ds_read_b128 v[48:51], v0 offset:5120
    s_waitcnt lgkmcnt(6)
    v_smfmac_f32_16x16x64_bf16 v[12:15], v[28:31], a[0:7], v1
    v_smfmac_f32_16x16x64_bf16 v[16:19], v[28:31], a[56:63], v1
    v_smfmac_f32_16x16x64_bf16 v[20:23], v[28:31], a[112:119], v1
    v_smfmac_f32_16x16x64_bf16 v[24:27], v[28:31], a[168:175], v1
    s_branch Y1f_y
Y2_entry:
    v_mov_b32 v57, 16512
Y2_wa:
    ds_read_b32 v56, v57
    s_waitcnt lgkmcnt(0)
    v_cmp_gt_u32 vcc, 1, v56
    s_cbranch_vccz Y2_wa_ok
    s_sleep 1
    s_sub_u32 s35, s35, 1
    s_cmp_lg_u32 s35, 0
    s_cbranch_scc1 Y2_wa
    s_branch L_team_done
Y2_wa_ok:
    s_mul_i32 s36, s16, 200704
    s_add_u32 s36, s36, 114688
    buffer_load_dwordx4 a[0:3], v0, s[4:7], s36 offen offset:0 sc1
    buffer_load_dwordx4 a[4:7], v0, s[4:7], s36 offen offset:1024 sc1
    buffer_load_dwordx4 a[8:11], v0, s[4:7], s36 offen offset:2048 sc1
    buffer_load_dwordx4 a[12:15], v0, s[4:7], s36 offen offset:3072 sc1
    s_add_u32 s36, s36, 4096
    buffer_load_dwordx4 a[16:19], v0, s[4:7], s36 offen offset:0 sc1
    buffer_load_dwordx4 a[20:23], v0, s[4:7], s36 offen offset:1024 sc1
    buffer_load_dwordx4 a[24:27], v0, s[4:7], s36 offen offset:2048 sc1
    buffer_load_dwordx4 a[28:31], v0, s[4:7], s36 offen offset:3072 sc1
    s_add_u32 s36, s36, 4096
    buffer_load_dwordx4 a[32:35], v0, s[4:7], s36 offen offset:0 sc1
    buffer_load_dwordx4 a[36:39], v0, s[4:7], s36 offen offset:1024 sc1
    buffer_load_dwordx4 a[40:43], v0, s[4:7], s36 offen offset:2048 sc1
    buffer_load_dwordx4 a[44:47], v0, s[4:7], s36 offen offset:3072 sc1
    s_add_u32 s36, s36, 4096
    buffer_load_dwordx4 a[48:51], v0, s[4:7], s36 offen offset:0 sc1
    buffer_load_dwordx4 a[52:55], v0, s[4:7], s36 offen offset:1024 sc1
    buffer_load_dwordx4 a[56:59], v0, s[4:7], s36 offen offset:2048 sc1
    buffer_load_dwordx4 a[60:63], v0, s[4:7], s36 offen offset:3072 sc1
    s_add_u32 s36, s36, 4096
    buffer_load_dwordx4 a[64:67], v0, s[4:7], s36 offen offset:0 sc1
    buffer_load_dwordx4 a[68:71], v0, s[4:7], s36 offen offset:1024 sc1
    buffer_load_dwordx4 a[72:75], v0, s[4:7], s36 offen offset:2048 sc1
    buffer_load_dwordx4 a[76:79], v0, s[4:7], s36 offen offset:3072 sc1
    s_add_u32 s36, s36, 4096
    buffer_load_dwordx4 a[80:83], v0, s[4:7], s36 offen offset:0 sc1
    buffer_load_dwordx4 a[84:87], v0, s[4:7], s36 offen offset:1024 sc1
    buffer_load_dwordx4 a[88:91], v0, s[4:7], s36 offen offset:2048 sc1
    buffer_load_dwordx4 a[92:95], v0, s[4:7], s36 offen offset:3072 sc1
    s_add_u32 s36, s36, 4096
    buffer_load_dwordx4 a[96:99], v0, s[4:7], s36 offen offset:0 sc1
    buffer_load_dwordx4 a[100:103], v0, s[4:7], s36 offen offset:1024 sc1
    buffer_load_dwordx4 a[104:107], v0, s[4:7], s36 offen offset:2048 sc1
    buffer_load_dwordx4 a[108:111], v0, s[4:7], s36 offen offset:3072 sc1
    s_add_u32 s36, s36, 4096
    buffer_load_dwordx4 a[112:115], v0, s[4:7], s36 offen offset:0 sc1
    buffer_load_dwordx4 a[116:119], v0, s[4:7], s36 offen offset:1024 sc1
    buffer_load_dwordx4 a[120:123], v0, s[4:7], s36 offen offset:2048 sc1
    buffer_load_dwordx4 a[124:127], v0, s[4:7], s36 offen offset:3072 sc1
    s_add_u32 s36, s36, 4096
    buffer_load_dwordx4 a[128:131], v0, s[4:7], s36 offen offset:0 sc1
    buffer_load_dwordx4 a[132:135], v0, s[4:7], s36 offen offset:1024 sc1
    buffer_load_dwordx4 a[136:139], v0, s[4:7], s36 offen offset:2048 sc1
    buffer_load_dwordx4 a[140:143], v0, s[4:7], s36 offen offset:3072 sc1
    s_add_u32 s36, s36, 4096
    buffer_load_dwordx4 a[144:147], v0, s[4:7], s36 offen offset:0 sc1
    buffer_load_dwordx4 a[148:151], v0, s[4:7], s36 offen offset:1024 sc1
    buffer_load_dwordx4 a[152:155], v0, s[4:7], s36 offen offset:2048 sc1
    buffer_load_dwordx4 a[156:159], v0, s[4:7], s36 offen offset:3072 sc1
    s_add_u32 s36, s36, 4096
    buffer_load_dwordx4 a[160:163], v0, s[4:7], s36 offen offset:0 sc1
    buffer_load_dwordx4 a[164:167], v0, s[4:7], s36 offen offset:1024 sc1
    buffer_load_dwordx4 a[168:171], v0, s[4:7], s36 offen offset:2048 sc1
    buffer_load_dwordx4 a[172:175], v0, s[4:7], s36 offen offset:3072 sc1
    s_add_u32 s36, s36, 4096
    buffer_load_dwordx4 a[176:179], v0, s[4:7], s36 offen offset:0 sc1
    buffer_load_dwordx4 a[180:183], v0, s[4:7], s36 offen offset:1024 sc1
    buffer_load_dwordx4 a[184:187], v0, s[4:7], s36 offen offset:2048 sc1
    buffer_load_dwordx4 a[188:191], v0, s[4:7], s36 offen offset:3072 sc1
    s_add_u32 s36, s36, 4096
    buffer_load_dwordx4 a[192:195], v0, s[4:7], s36 offen offset:0 sc1
    buffer_load_dwordx4 a[196:199], v0, s[4:7], s36 offen offset:1024 sc1
    buffer_load_dwordx4 a[200:203], v0, s[4:7], s36 offen offset:2048 sc1
    buffer_load_dwordx4 a[204:207], v0, s[4:7], s36 offen offset:3072 sc1
    s_add_u32 s36, s36, 4096
    buffer_load_dwordx4 a[208:211], v0, s[4:7], s36 offen offset:0 sc1
    buffer_load_dwordx4 a[212:215], v0, s[4:7], s36 offen offset:1024 sc1
    buffer_load_dwordx4 a[216:219], v0, s[4:7], s36 offen offset:2048 sc1
    buffer_load_dwordx4 a[220:223], v0, s[4:7], s36 offen offset:3072 sc1
    v_mov_b32 v57, 16512
Y2_wb:
    ds_read_b32 v56, v57
    s_waitcnt lgkmcnt(0)
    v_cmp_gt_u32 vcc, 2, v56
    s_cbranch_vccz Y2_wb_ok
    s_sleep 1
    s_sub_u32 s35, s35, 1
    s_cmp_lg_u32 s35, 0
    s_cbranch_scc1 Y2_wb
    s_branch L_team_done
Y2_wb_ok:
    s_mul_i32 s36, s21, 229376
    s_add_u32 s36, s36, 7454720
    buffer_load_dwordx4 a[224:227], v0, s[4:7], s36 offen offset:0 sc1
    buffer_load_dwordx4 a[228:231], v0, s[4:7], s36 offen offset:1024 sc1
    buffer_load_dwordx4 a[232:235], v0, s[4:7], s36 offen offset:2048 sc1
    buffer_load_dwordx4 a[236:239], v0, s[4:7], s36 offen offset:3072 sc1
    s_add_u32 s36, s36, 4096
    buffer_load_dwordx4 a[240:243], v0, s[4:7], s36 offen offset:0 sc1
    buffer_load_dwordx4 a[244:247], v0, s[4:7], s36 offen offset:1024 sc1
    buffer_load_dwordx4 a[248:251], v0, s[4:7], s36 offen offset:2048 sc1
    buffer_load_dwordx4 a[252:255], v0, s[4:7], s36 offen offset:3072 sc1
    s_add_u32 s36, s36, 4096
    buffer_load_dwordx4 v[64:67], v0, s[4:7], s36 offen offset:0 sc1
    buffer_load_dwordx4 v[68:71], v0, s[4:7], s36 offen offset:1024 sc1
    buffer_load_dwordx4 v[72:75], v0, s[4:7], s36 offen offset:2048 sc1
    buffer_load_dwordx4 v[76:79], v0, s[4:7], s36 offen offset:3072 sc1
    s_add_u32 s36, s36, 4096
    buffer_load_dwordx4 v[80:83], v0, s[4:7], s36 offen offset:0 sc1
    buffer_load_dwordx4 v[84:87], v0, s[4:7], s36 offen offset:1024 sc1
    buffer_load_dwordx4 v[88:91], v0, s[4:7], s36 offen offset:2048 sc1
    buffer_load_dwordx4 v[92:95], v0, s[4:7], s36 offen offset:3072 sc1
    s_add_u32 s36, s36, 4096
    buffer_load_dwordx4 v[96:99], v0, s[4:7], s36 offen offset:0 sc1
    buffer_load_dwordx4 v[100:103], v0, s[4:7], s36 offen offset:1024 sc1
    buffer_load_dwordx4 v[104:107], v0, s[4:7], s36 offen offset:2048 sc1
    buffer_load_dwordx4 v[108:111], v0, s[4:7], s36 offen offset:3072 sc1
    s_add_u32 s36, s36, 4096
    buffer_load_dwordx4 v[112:115], v0, s[4:7], s36 offen offset:0 sc1
    buffer_load_dwordx4 v[116:119], v0, s[4:7], s36 offen offset:1024 sc1
    buffer_load_dwordx4 v[120:123], v0, s[4:7], s36 offen offset:2048 sc1
    buffer_load_dwordx4 v[124:127], v0, s[4:7], s36 offen offset:3072 sc1
    s_add_u32 s36, s36, 4096
    buffer_load_dwordx4 v[128:131], v0, s[4:7], s36 offen offset:0 sc1
    buffer_load_dwordx4 v[132:135], v0, s[4:7], s36 offen offset:1024 sc1
    buffer_load_dwordx4 v[136:139], v0, s[4:7], s36 offen offset:2048 sc1
    buffer_load_dwordx4 v[140:143], v0, s[4:7], s36 offen offset:3072 sc1
    s_add_u32 s36, s36, 4096
    buffer_load_dwordx4 v[144:147], v0, s[4:7], s36 offen offset:0 sc1
    buffer_load_dwordx4 v[148:151], v0, s[4:7], s36 offen offset:1024 sc1
    buffer_load_dwordx4 v[152:155], v0, s[4:7], s36 offen offset:2048 sc1
    buffer_load_dwordx4 v[156:159], v0, s[4:7], s36 offen offset:3072 sc1
    s_add_u32 s36, s36, 4096
    buffer_load_dwordx4 v[160:163], v0, s[4:7], s36 offen offset:0 sc1
    buffer_load_dwordx4 v[164:167], v0, s[4:7], s36 offen offset:1024 sc1
    buffer_load_dwordx4 v[168:171], v0, s[4:7], s36 offen offset:2048 sc1
    buffer_load_dwordx4 v[172:175], v0, s[4:7], s36 offen offset:3072 sc1
    s_add_u32 s36, s36, 4096
    buffer_load_dwordx4 v[176:179], v0, s[4:7], s36 offen offset:0 sc1
    buffer_load_dwordx4 v[180:183], v0, s[4:7], s36 offen offset:1024 sc1
    buffer_load_dwordx4 v[184:187], v0, s[4:7], s36 offen offset:2048 sc1
    buffer_load_dwordx4 v[188:191], v0, s[4:7], s36 offen offset:3072 sc1
    s_add_u32 s36, s36, 4096
    buffer_load_dwordx4 v[192:195], v0, s[4:7], s36 offen offset:0 sc1
    buffer_load_dwordx4 v[196:199], v0, s[4:7], s36 offen offset:1024 sc1
    buffer_load_dwordx4 v[200:203], v0, s[4:7], s36 offen offset:2048 sc1
    buffer_load_dwordx4 v[204:207], v0, s[4:7], s36 offen offset:3072 sc1
    s_add_u32 s36, s36, 4096
    buffer_load_dwordx4 v[208:211], v0, s[4:7], s36 offen offset:0 sc1
    buffer_load_dwordx4 v[212:215], v0, s[4:7], s36 offen offset:1024 sc1
    buffer_load_dwordx4 v[216:219], v0, s[4:7], s36 offen offset:2048 sc1
    buffer_load_dwordx4 v[220:223], v0, s[4:7], s36 offen offset:3072 sc1
    s_add_u32 s36, s36, 4096
    buffer_load_dwordx4 v[224:227], v0, s[4:7], s36 offen offset:0 sc1
    buffer_load_dwordx4 v[228:231], v0, s[4:7], s36 offen offset:1024 sc1
    buffer_load_dwordx4 v[232:235], v0, s[4:7], s36 offen offset:2048 sc1
    buffer_load_dwordx4 v[236:239], v0, s[4:7], s36 offen offset:3072 sc1
    s_add_u32 s36, s36, 4096
    buffer_load_dwordx4 v[240:243], v0, s[4:7], s36 offen offset:0 sc1
    buffer_load_dwordx4 v[244:247], v0, s[4:7], s36 offen offset:1024 sc1
    buffer_load_dwordx4 v[248:251], v0, s[4:7], s36 offen offset:2048 sc1
    buffer_load_dwordx4 v[252:255], v0, s[4:7], s36 offen offset:3072 sc1
    v_lshrrev_b32 v63, 3, v61
    v_lshlrev_b32 v3, 8, v63
    v_lshl_add_u32 v3, v62, 6, v3
    v_bfe_u32 v63, v61, 1, 1
    v_lshl_add_u32 v3, v63, 4, v3
    v_bfe_u32 v63, v61, 2, 1
    v_lshl_add_u32 v3, v63, 3, v3
    v_and_b32 v63, 1, v61
    v_lshl_add_u32 v3, v63, 2, v3
    v_add_u32 v3, 9216, v3
    v_add_u32 v5, 2048, v3
    v_lshrrev_b32 v63, 1, v62
    v_lshlrev_b32 v6, 8, v63
    v_lshl_add_u32 v6, v61, 4, v6
    v_and_b32 v63, 1, v62
    v_lshl_add_u32 v6, v63, 3, v6
    v_add_u32 v6, 14336, v6
    v_add_u32 v7, 0, v0
    v_mov_b32 v4, 16448
    v_and_b32 v2, 31, v60
    v_lshlrev_b32 v2, 2, v2
    s_mul_i32 s31, s19, 14336
    s_add_u32 s31, s31, 25165824
    s_mov_b32 s46, 49152
    v_mov_b32 v57, 16512
Y2_ws:
    ds_read_b32 v56, v57
    s_waitcnt lgkmcnt(0)
    v_cmp_gt_u32 vcc, 3, v56
    s_cbranch_vccz Y2_ws_ok
    s_sleep 1
    s_sub_u32 s35, s35, 1
    s_cmp_lg_u32 s35, 0
    s_cbranch_scc1 Y2_ws
    s_branch L_team_done
Y2_ws_ok:
    s_add_u32 m0, s46, 0
    s_add_u32 s38, s31, 0
    buffer_load_dwordx4 v0, s[4:7], s38 offen offset:0 sc1 lds
    buffer_load_dwordx4 v0, s[4:7], s38 offen offset:1024 sc1 lds
    buffer_load_dwordx4 v0, s[4:7], s38 offen offset:2048 sc1 lds
    buffer_load_dwordx4 v0, s[4:7], s38 offen offset:3072 sc1 lds
    s_add_u32 m0, s46, 4096
    s_add_u32 s38, s31, 4096
    buffer_load_dwordx4 v0, s[4:7], s38 offen offset:0 sc1 lds
    buffer_load_dwordx4 v0, s[4:7], s38 offen offset:1024 sc1 lds
    buffer_load_dwordx4 v0, s[4:7], s38 offen offset:2048 sc1 lds
    buffer_load_dwordx4 v0, s[4:7], s38 offen offset:3072 sc1 lds
    s_add_u32 m0, s46, 8192
    s_add_u32 s38, s31, 8192
    buffer_load_dwordx4 v0, s[4:7], s38 offen offset:0 sc1 lds
    buffer_load_dwordx4 v0, s[4:7], s38 offen offset:1024 sc1 lds
    buffer_load_dwordx4 v0, s[4:7], s38 offen offset:2048 sc1 lds
    buffer_load_dwordx4 v0, s[4:7], s38 offen offset:3072 sc1 lds
    s_add_u32 m0, s46, 12288
    s_add_u32 s38, s31, 12288
    buffer_load_dwordx4 v0, s[4:7], s38 offen offset:0 sc1 lds
    buffer_load_dwordx4 v0, s[4:7], s38 offen offset:1024 sc1 lds
    s_add_u32 s31, s31, 28672
    s_xor_b32 s46, s46, 0x1c000
    v_min_u32 v56, 14, v60
    v_lshlrev_b32 v56, 21, v56
    s_mov_b32 s36, 33554432
    buffer_load_dword v57, v56, s[4:7], s36 offen sc1
    v_lshlrev_b32 v56, 16, v62
    v_lshl_add_u32 v56, v61, 4, v56
    s_mul_i32 s36, s16, 1280
    s_add_u32 s36, s36, 14680064
    buffer_load_dwordx4 v[12:15], v56, s[4:7], s36 offen offset:0 sc1
    buffer_load_dwordx4 v[12:15], v56, s[4:7], s36 offen offset:256 sc1
    buffer_load_dwordx4 v[12:15], v56, s[4:7], s36 offen offset:512 sc1
    buffer_load_dwordx4 v[12:15], v56, s[4:7], s36 offen offset:768 sc1
    buffer_load_dwordx4 v[12:15], v56, s[4:7], s36 offen offset:1024 sc1
    s_getpc_b64 s[40:41]
Y2_ref:
    v_lshlrev_b32 v56, 2, v0
    v_add_u32 v56, Y2_loop - Y2_ref, v56
    global_load_dword v57, v56, s[40:41]
    v_add_u32 v56, 4096, v56
    global_load_dword v57, v56, s[40:41]
    s_waitcnt vmcnt(0) lgkmcnt(0)
    s_barrier
    v_mov_b32 v58, 16384
    ds_read_b32 v58, v58
    s_waitcnt lgkmcnt(0)
    v_readfirstlane_b32 s23, v58
    s_cmp_lg_u32 s23, 0
    s_cbranch_scc1 Y2_far
Y2_loop:
    s_add_u32 s45, s24, 0
    v_mov_b32 v12, 0
    v_mov_b32 v13, 0
    v_mov_b32 v14, 0
    v_mov_b32 v15, 0
    v_mov_b32 v16, 0
    v_mov_b32 v17, 0
    v_mov_b32 v18, 0
    v_mov_b32 v19, 0
    v_mov_b32 v20, 0
    v_mov_b32 v21, 0
    v_mov_b32 v22, 0
    v_mov_b32 v23, 0
    v_mov_b32 v24, 0
    v_mov_b32 v25, 0
    v_mov_b32 v26, 0
    v_mov_b32 v27, 0
    s_mul_i32 s39, s20, 0x01010101
    v_mov_b32 v57, -1
    v_mov_b32 v58, -1
    v_mov_b32 v59, -1
    v_mov_b32 v60, -1
Y2_go:
    ds_read_b32 v56, v4
    s_waitcnt lgkmcnt(0)
    v_cmp_gt_u32 vcc, s20, v56
    s_cbranch_vccz Y2_go_ok
    s_sub_u32 s35, s35, 1
    s_cmp_lg_u32 s35, 0
    s_cbranch_scc1 Y2_go
    s_branch L_team_done
Y2_go_ok:
    s_mov_b32 m0, 0
    s_mov_b64 exec, 0xff
    buffer_load_dword v56, v2, s[4:7], s22 offen offset:0 sc1
    v_cmp_ne_u32 vcc, s39, v57
    s_cbranch_vccz Y2_fok
    buffer_load_dword v57, v2, s[4:7], s22 offen offset:0 sc1
    v_cmp_ne_u32 vcc, s39, v58
    s_cbranch_vccz Y2_fok
    buffer_load_dword v58, v2, s[4:7], s22 offen offset:0 sc1
    v_cmp_ne_u32 vcc, s39, v59
    s_cbranch_vccz Y2_fok
    buffer_load_dword v59, v2, s[4:7], s22 offen offset:0 sc1
    v_cmp_ne_u32 vcc, s39, v60
    s_cbranch_vccz Y2_fok
    buffer_load_dword v60, v2, s[4:7], s22 offen offset:0 sc1
    s_waitcnt vmcnt(4)
    v_cmp_ne_u32 vcc, s39, v56
    s_cbranch_vccz Y2_fok
Y2_fpoll:
    buffer_load_dword v56, v2, s[4:7], s22 offen offset:0 sc1
    s_waitcnt vmcnt(4)
    v_cmp_ne_u32 vcc, s39, v57
    s_cbranch_vccz Y2_fok
    buffer_load_dword v57, v2, s[4:7], s22 offen offset:0 sc1
    s_waitcnt vmcnt(4)
    v_cmp_ne_u32 vcc, s39, v58
    s_cbranch_vccz Y2_fok
    buffer_load_dword v58, v2, s[4:7], s22 offen offset:0 sc1
    s_waitcnt vmcnt(4)
    v_cmp_ne_u32 vcc, s39, v59
    s_cbranch_vccz Y2_fok
    buffer_load_dword v59, v2, s[4:7], s22 offen offset:0 sc1
    s_waitcnt vmcnt(4)
    v_cmp_ne_u32 vcc, s39, v60
    s_cbranch_vccz Y2_fok
    buffer_load_dword v60, v2, s[4:7], s22 offen offset:0 sc1
    s_waitcnt vmcnt(4)
    v_cmp_ne_u32 vcc, s39, v56
    s_cbranch_vccz Y2_fok
    buffer_load_dword v56, v2, s[4:7], s22 offen offset:0 sc1
    s_waitcnt vmcnt(4)
    v_cmp_ne_u32 vcc, s39, v57
    s_cbranch_vccz Y2_fok
    buffer_load_dword v57, v2, s[4:7], s22 offen offset:0 sc1
    s_waitcnt vmcnt(4)
    v_cmp_ne_u32 vcc, s39, v58
    s_cbranch_vccz Y2_fok
    buffer_load_dword v58, v2, s[4:7], s22 offen offset:0 sc1
    s_waitcnt vmcnt(4)
    v_cmp_ne_u32 vcc, s39, v59
    s_cbranch_vccz Y2_fok
    buffer_load_dword v59, v2, s[4:7], s22 offen offset:0 sc1
    s_waitcnt vmcnt(4)
    v_cmp_ne_u32 vcc, s39, v60
    s_cbranch_vccz Y2_fok
    buffer_load_dword v60, v2, s[4:7], s22 offen offset:0 sc1
    s_waitcnt vmcnt(4)
    v_cmp_ne_u32 vcc, s39, v56
    s_cbranch_vccz Y2_fok
    s_sub_u32 s35, s35, 1
    s_cmp_lg_u32 s35, 0
    s_cbranch_scc1 Y2_fpoll
    s_branch L_team_done
Y2_fok:
    s_mov_b64 exec, -1
    buffer_load_dwordx4 v0, s[4:7], s45 offen sc1 lds
    s_barrier
    s_barrier
    buffer_load_dwordx4 v0, s[4:7], s45 offen offset:3072 sc1 lds
    s_waitcnt vmcnt(1)
    s_barrier
    ds_read_b128 v[28:31], v0 offset:0
    s_waitcnt vmcnt(1)
    s_barrier
    ds_read_b128 v[32:35], v0 offset:1024
    ds_read_b128 v[36:39], v0 offset:2048
    ds_read_b128 v[52:55], v0 offset:6144
    s_waitcnt lgkmcnt(3)
    v_smfmac_f32_16x16x64_bf16 v[12:15], v[28:31], a[0:7], v1
    v_smfmac_f32_16x16x64_bf16 v[16:19], v[28:31], a[56:63], v1
    v_smfmac_f32_16x16x64_bf16 v[20:23], v[28:31], a[112:119], v1
    s_waitcnt vmcnt(0)
    s_barrier
    v_smfmac_f32_16x16x64_bf16 v[24:27], v[28:31], a[168:175], v1
    ds_read_b128 v[40:43], v0 offset:3072
    ds_read_b128 v[44:47], v0 offset:4096
    ds_read_b128 v[48:51], v0 offset:5120
Y2_y:
    s_waitcnt lgkmcnt(5)
    v_smfmac_f32_16x16x64_bf16 v[12:15], v[32:35], a[8:15], v1
    v_smfmac_f32_16x16x64_bf16 v[16:19], v[32:35], a[64:71], v1
    v_smfmac_f32_16x16x64_bf16 v[20:23], v[32:35], a[120:127], v1
    v_smfmac_f32_16x16x64_bf16 v[24:27], v[32:35], a[176:183], v1
    s_waitcnt lgkmcnt(4)
    v_smfmac_f32_16x16x64_bf16 v[12:15], v[36:39], a[16:23], v1
    v_smfmac_f32_16x16x64_bf16 v[16:19], v[36:39], a[72:79], v1
    s_waitcnt lgkmcnt(3)
    v_smfmac_f32_16x16x64_bf16 v[12:15], v[52:55], a[48:55], v1
    v_smfmac_f32_16x16x64_bf16 v[16:19], v[52:55], a[104:111], v1
    s_waitcnt lgkmcnt(2)
    v_smfmac_f32_16x16x64_bf16 v[12:15], v[40:43], a[24:31], v1
    v_smfmac_f32_16x16x64_bf16 v[16:19], v[40:43], a[80:87], v1
    s_waitcnt lgkmcnt(1)
    v_smfmac_f32_16x16x64_bf16 v[12:15], v[44:47], a[32:39], v1
    v_smfmac_f32_16x16x64_bf16 v[16:19], v[44:47], a[88:95], v1
    s_waitcnt lgkmcnt(0)
    v_smfmac_f32_16x16x64_bf16 v[12:15], v[48:51], a[40:47], v1
    v_smfmac_f32_16x16x64_bf16 v[16:19], v[48:51], a[96:103], v1
    v_smfmac_f32_16x16x64_bf16 v[20:23], v[36:39], a[128:135], v1
    s_nop 1
    v_smfmac_f32_16x16x64_bf16 v[24:27], v[36:39], a[184:191], v1
    s_nop 1
    v_smfmac_f32_16x16x64_bf16 v[20:23], v[52:55], a[160:167], v1
    v_add_f32 v12, v12, v13
    v_add_f32 v14, v14, v15
    v_smfmac_f32_16x16x64_bf16 v[24:27], v[52:55], a[216:223], v1
    v_add_f32 v16, v16, v17
    v_add_f32 v18, v18, v19
    v_smfmac_f32_16x16x64_bf16 v[20:23], v[40:43], a[136:143], v1
    v_cvt_pk_bf16_f32 v8, v12, v16
    v_cvt_pk_bf16_f32 v9, v14, v18
    v_smfmac_f32_16x16x64_bf16 v[24:27], v[40:43], a[192:199], v1
    ds_write2_b32 v3, v8, v9 offset0:0 offset1:8
    v_cmp_u_f32 vcc, v12, v14
    v_smfmac_f32_16x16x64_bf16 v[20:23], v[44:47], a[144:151], v1
    v_mov_b32 v12, 0
    v_mov_b32 v13, 0
    v_smfmac_f32_16x16x64_bf16 v[24:27], v[44:47], a[200:207], v1
    v_mov_b32 v14, 0
    v_mov_b32 v15, 0
    v_smfmac_f32_16x16x64_bf16 v[20:23], v[48:51], a[152:159], v1
    s_waitcnt lgkmcnt(0)
    s_barrier
    v_smfmac_f32_16x16x64_bf16 v[24:27], v[48:51], a[208:215], v1
    v_mov_b32 v16, 0
    v_mov_b32 v17, 0
    v_mov_b32 v18, 0
    v_mov_b32 v19, 0
    s_nop 1
    v_add_f32 v20, v20, v21
    v_add_f32 v22, v22, v23
    v_add_f32 v24, v24, v25
    v_add_f32 v26, v26, v27
    v_cvt_pk_bf16_f32 v10, v20, v24
    v_cvt_pk_bf16_f32 v11, v22, v26
    ds_write2_b32 v5, v10, v11 offset0:0 offset1:8
    s_cbranch_vccnz Y2_fail
Y2_yok:
    v_mov_b32 v20, 0
    v_mov_b32 v21, 0
    v_mov_b32 v22, 0
    v_mov_b32 v23, 0
    v_mov_b32 v24, 0
    v_mov_b32 v25, 0
    v_mov_b32 v26, 0
    v_mov_b32 v27, 0
    s_waitcnt lgkmcnt(0)
    s_barrier
    v_smfmac_f32_16x16x64_bf16 v[12:15], v[28:31], a[224:231], v1
    v_smfmac_f32_16x16x64_bf16 v[12:15], v[32:35], a[232:239], v1
    v_smfmac_f32_16x16x64_bf16 v[12:15], v[36:39], a[240:247], v1
    v_smfmac_f32_16x16x64_bf16 v[12:15], v[40:43], a[248:255], v1
    v_smfmac_f32_16x16x64_bf16 v[12:15], v[44:47], v[64:71], v1
    v_smfmac_f32_16x16x64_bf16 v[12:15], v[48:51], v[72:79], v1
    v_smfmac_f32_16x16x64_bf16 v[12:15], v[52:55], v[80:87], v1
    v_smfmac_f32_16x16x64_bf16 v[16:19], v[28:31], v[88:95], v1
    v_smfmac_f32_16x16x64_bf16 v[16:19], v[32:35], v[96:103], v1
    v_smfmac_f32_16x16x64_bf16 v[16:19], v[36:39], v[104:111], v1
    v_smfmac_f32_16x16x64_bf16 v[16:19], v[40:43], v[112:119], v1
    v_smfmac_f32_16x16x64_bf16 v[16:19], v[44:47], v[120:127], v1
    s_nop 2
    v_add_f32 v12, v12, v13
    v_smfmac_f32_16x16x64_bf16 v[16:19], v[48:51], v[128:135], v1
    v_add_f32 v14, v14, v15
    v_smfmac_f32_16x16x64_bf16 v[16:19], v[52:55], v[136:143], v1
    v_cvt_pk_bf16_f32 v8, v12, v14
    v_smfmac_f32_16x16x64_bf16 v[20:23], v[28:31], v[144:151], v1
    v_smfmac_f32_16x16x64_bf16 v[20:23], v[32:35], v[152:159], v1
    v_smfmac_f32_16x16x64_bf16 v[20:23], v[36:39], v[160:167], v1
    v_smfmac_f32_16x16x64_bf16 v[20:23], v[40:43], v[168:175], v1
    v_smfmac_f32_16x16x64_bf16 v[20:23], v[44:47], v[176:183], v1
    s_nop 2
    v_add_f32 v16, v16, v17
    v_smfmac_f32_16x16x64_bf16 v[20:23], v[48:51], v[184:191], v1
    v_add_f32 v18, v18, v19
    v_smfmac_f32_16x16x64_bf16 v[20:23], v[52:55], v[192:199], v1
    v_cvt_pk_bf16_f32 v9, v16, v18
    v_smfmac_f32_16x16x64_bf16 v[24:27], v[28:31], v[200:207], v1
    v_smfmac_f32_16x16x64_bf16 v[24:27], v[32:35], v[208:215], v1
    v_smfmac_f32_16x16x64_bf16 v[24:27], v[36:39], v[216:223], v1
    v_smfmac_f32_16x16x64_bf16 v[24:27], v[40:43], v[224:231], v1
    v_smfmac_f32_16x16x64_bf16 v[24:27], v[44:47], v[232:239], v1
    s_nop 2
    v_add_f32 v20, v20, v21
    v_smfmac_f32_16x16x64_bf16 v[24:27], v[48:51], v[240:247], v1
    v_add_f32 v22, v22, v23
    v_smfmac_f32_16x16x64_bf16 v[24:27], v[52:55], v[248:255], v1
    v_cvt_pk_bf16_f32 v10, v20, v22
    s_nop 7
    v_add_f32 v24, v24, v25
    v_add_f32 v26, v26, v27
    v_cvt_pk_bf16_f32 v11, v24, v26
    ds_write_b64 v6, v[8:9]
    ds_write_b64 v6, v[10:11] offset:512
    s_waitcnt lgkmcnt(0)
    s_barrier
    s_add_u32 m0, s46, 0
    s_add_u32 s38, s31, 0
    buffer_load_dwordx4 v0, s[4:7], s38 offen offset:0 sc1 lds
    buffer_load_dwordx4 v0, s[4:7], s38 offen offset:1024 sc1 lds
    buffer_load_dwordx4 v0, s[4:7], s38 offen offset:2048 sc1 lds
    buffer_load_dwordx4 v0, s[4:7], s38 offen offset:3072 sc1 lds
    s_add_u32 m0, s46, 4096
    s_add_u32 s38, s31, 4096
    buffer_load_dwordx4 v0, s[4:7], s38 offen offset:0 sc1 lds
    buffer_load_dwordx4 v0, s[4:7], s38 offen offset:1024 sc1 lds
    buffer_load_dwordx4 v0, s[4:7], s38 offen offset:2048 sc1 lds
    buffer_load_dwordx4 v0, s[4:7], s38 offen offset:3072 sc1 lds
    s_add_u32 m0, s46, 8192
    s_add_u32 s38, s31, 8192
    buffer_load_dwordx4 v0, s[4:7], s38 offen offset:0 sc1 lds
    buffer_load_dwordx4 v0, s[4:7], s38 offen offset:1024 sc1 lds
    buffer_load_dwordx4 v0, s[4:7], s38 offen offset:2048 sc1 lds
    buffer_load_dwordx4 v0, s[4:7], s38 offen offset:3072 sc1 lds
    s_add_u32 m0, s46, 12288
    s_add_u32 s38, s31, 12288
    buffer_load_dwordx4 v0, s[4:7], s38 offen offset:0 sc1 lds
    buffer_load_dwordx4 v0, s[4:7], s38 offen offset:1024 sc1 lds
    s_add_u32 s31, s31, 28672
    s_xor_b32 s46, s46, 0x1c000
    s_mov_b32 s26, s24
    s_mov_b32 s24, s25
    s_add_u32 s25, s25, 0x10000
    s_and_b32 s25, s25, 14876672
    s_add_u32 s20, s20, 1
    s_cmp_lt_u32 s20, 63
    s_cbranch_scc1 Y2_loop
    s_branch L_team_done
Y2_fail:
    v_max_u32 v56, v28, v29
    v_max3_u32 v56, v56, v30, v31
    v_max3_u32 v56, v56, v32, v33
    v_max3_u32 v56, v56, v34, v35
    v_max3_u32 v56, v56, v36, v37
    v_max3_u32 v56, v56, v38, v39
    v_max3_u32 v56, v56, v40, v41
    v_max3_u32 v56, v56, v42, v43
    v_max3_u32 v56, v56, v44, v45
    v_max3_u32 v56, v56, v46, v47
    v_max3_u32 v56, v56, v48, v49
    v_max3_u32 v56, v56, v50, v51
    v_max3_u32 v56, v56, v52, v53
    v_max3_u32 v56, v56, v54, v55
    v_cmp_eq_u32 vcc, -1, v56
    s_cbranch_vccz Y2_yok
    s_waitcnt lgkmcnt(0)
    s_sub_u32 s35, s35, 1
    s_cmp_eq_u32 s35, 0
    s_cbranch_scc1 L_team_done
    v_mov_b32 v12, 0
    v_mov_b32 v13, 0
    v_mov_b32 v14, 0
    v_mov_b32 v15, 0
    v_mov_b32 v16, 0
    v_mov_b32 v17, 0
    v_mov_b32 v18, 0
    v_mov_b32 v19, 0
    v_mov_b32 v20, 0
    v_mov_b32 v21, 0
    v_mov_b32 v22, 0
    v_mov_b32 v23, 0
    v_mov_b32 v24, 0
    v_mov_b32 v25, 0
    v_mov_b32 v26, 0
    v_mov_b32 v27, 0
    s_mov_b32 m0, 0
    s_barrier
    buffer_load_dwordx4 v0, s[4:7], s45 offen sc1 lds
    buffer_load_dwordx4 v0, s[4:7], s45 offen offset:3072 sc1 lds
    s_waitcnt vmcnt(0)
    s_barrier
    ds_read_b128 v[28:31], v0 offset:0
    ds_read_b128 v[32:35], v0 offset:1024
    ds_read_b128 v[36:39], v0 offset:2048
    ds_read_b128 v[52:55], v0 offset:6144
    ds_read_b128 v[40:43], v0 offset:3072
    ds_read_b128 v[44:47], v0 offset:4096
    ds_read_b128 v[48:51], v0 offset:5120
    s_waitcnt lgkmcnt(6)
    v_smfmac_f32_16x16x64_bf16 v[12:15], v[28:31], a[0:7], v1
    v_smfmac_f32_16x16x64_bf16 v[16:19], v[28:31], a[56:63], v1
    v_smfmac_f32_16x16x64_bf16 v[20:23], v[28:31], a[112:119], v1
    v_smfmac_f32_16x16x64_bf16 v[24:27], v[28:31], a[168:175], v1
    s_branch Y2_y
Y2_far:
Y2f_loop:
    s_add_u32 s45, s24, 0
    v_mov_b32 v12, 0
    v_mov_b32 v13, 0
    v_mov_b32 v14, 0
    v_mov_b32 v15, 0
    v_mov_b32 v16, 0
    v_mov_b32 v17, 0
    v_mov_b32 v18, 0
    v_mov_b32 v19, 0
    v_mov_b32 v20, 0
    v_mov_b32 v21, 0
    v_mov_b32 v22, 0
    v_mov_b32 v23, 0
    v_mov_b32 v24, 0
    v_mov_b32 v25, 0
    v_mov_b32 v26, 0
    v_mov_b32 v27, 0
    s_mul_i32 s39, s20, 0x01010101
    v_mov_b32 v57, -1
    v_mov_b32 v58, -1
    v_mov_b32 v59, -1
    v_mov_b32 v60, -1
Y2f_go:
    ds_read_b32 v56, v4
    s_waitcnt lgkmcnt(0)
    v_cmp_gt_u32 vcc, s20, v56
    s_cbranch_vccz Y2f_go_ok
    s_sub_u32 s35, s35, 1
    s_cmp_lg_u32 s35, 0
    s_cbranch_scc1 Y2f_go
    s_branch L_team_done
Y2f_go_ok:
    s_mov_b32 m0, 0
    s_mov_b64 exec, 0xff
    buffer_load_dword v56, v2, s[4:7], s22 offen offset:0 sc1
    v_cmp_ne_u32 vcc, s39, v57
    s_cbranch_vccz Y2f_fok
    buffer_load_dword v57, v2, s[4:7], s22 offen offset:0 sc1
    v_cmp_ne_u32 vcc, s39, v58
    s_cbranch_vccz Y2f_fok
    buffer_load_dword v58, v2, s[4:7], s22 offen offset:0 sc1
    v_cmp_ne_u32 vcc, s39, v59
    s_cbranch_vccz Y2f_fok
    buffer_load_dword v59, v2, s[4:7], s22 offen offset:0 sc1
    v_cmp_ne_u32 vcc, s39, v60
    s_cbranch_vccz Y2f_fok
    buffer_load_dword v60, v2, s[4:7], s22 offen offset:0 sc1
    s_waitcnt vmcnt(4)
    v_cmp_ne_u32 vcc, s39, v56
    s_cbranch_vccz Y2f_fok
Y2f_fpoll:
    buffer_load_dword v56, v2, s[4:7], s22 offen offset:0 sc1
    s_waitcnt vmcnt(4)
    v_cmp_ne_u32 vcc, s39, v57
    s_cbranch_vccz Y2f_fok
    buffer_load_dword v57, v2, s[4:7], s22 offen offset:0 sc1
    s_waitcnt vmcnt(4)
    v_cmp_ne_u32 vcc, s39, v58
    s_cbranch_vccz Y2f_fok
    buffer_load_dword v58, v2, s[4:7], s22 offen offset:0 sc1
    s_waitcnt vmcnt(4)
    v_cmp_ne_u32 vcc, s39, v59
    s_cbranch_vccz Y2f_fok
    buffer_load_dword v59, v2, s[4:7], s22 offen offset:0 sc1
    s_waitcnt vmcnt(4)
    v_cmp_ne_u32 vcc, s39, v60
    s_cbranch_vccz Y2f_fok
    buffer_load_dword v60, v2, s[4:7], s22 offen offset:0 sc1
    s_waitcnt vmcnt(4)
    v_cmp_ne_u32 vcc, s39, v56
    s_cbranch_vccz Y2f_fok
    buffer_load_dword v56, v2, s[4:7], s22 offen offset:0 sc1
    s_waitcnt vmcnt(4)
    v_cmp_ne_u32 vcc, s39, v57
    s_cbranch_vccz Y2f_fok
    buffer_load_dword v57, v2, s[4:7], s22 offen offset:0 sc1
    s_waitcnt vmcnt(4)
    v_cmp_ne_u32 vcc, s39, v58
    s_cbranch_vccz Y2f_fok
    buffer_load_dword v58, v2, s[4:7], s22 offen offset:0 sc1
    s_waitcnt vmcnt(4)
    v_cmp_ne_u32 vcc, s39, v59
    s_cbranch_vccz Y2f_fok
    buffer_load_dword v59, v2, s[4:7], s22 offen offset:0 sc1
    s_waitcnt vmcnt(4)
    v_cmp_ne_u32 vcc, s39, v60
    s_cbranch_vccz Y2f_fok
    buffer_load_dword v60, v2, s[4:7], s22 offen offset:0 sc1
    s_waitcnt vmcnt(4)
    v_cmp_ne_u32 vcc, s39, v56
    s_cbranch_vccz Y2f_fok
    s_sub_u32 s35, s35, 1
    s_cmp_lg_u32 s35, 0
    s_cbranch_scc1 Y2f_fpoll
    s_branch L_team_done
Y2f_fok:
    s_mov_b64 exec, -1
    buffer_load_dwordx4 v0, s[4:7], s45 offen sc1 lds
    s_barrier
    s_barrier
    buffer_load_dwordx4 v0, s[4:7], s45 offen offset:3072 sc1 lds
    s_waitcnt vmcnt(1)
    s_barrier
    ds_read_b128 v[28:31], v0 offset:0
    s_waitcnt vmcnt(1)
    s_barrier
    ds_read_b128 v[32:35], v0 offset:1024
    ds_read_b128 v[36:39], v0 offset:2048
    ds_read_b128 v[52:55], v0 offset:6144
    s_waitcnt lgkmcnt(3)
    v_smfmac_f32_16x16x64_bf16 v[12:15], v[28:31], a[0:7], v1
    v_smfmac_f32_16x16x64_bf16 v[16:19], v[28:31], a[56:63], v1
    v_smfmac_f32_16x16x64_bf16 v[20:23], v[28:31], a[112:119], v1
    s_waitcnt vmcnt(0)
    s_barrier
    v_smfmac_f32_16x16x64_bf16 v[24:27], v[28:31], a[168:175], v1
    ds_read_b128 v[40:43], v0 offset:3072
    ds_read_b128 v[44:47], v0 offset:4096
    ds_read_b128 v[48:51], v0 offset:5120
Y2f_y:
    s_waitcnt lgkmcnt(5)
    v_smfmac_f32_16x16x64_bf16 v[12:15], v[32:35], a[8:15], v1
    v_smfmac_f32_16x16x64_bf16 v[16:19], v[32:35], a[64:71], v1
    v_smfmac_f32_16x16x64_bf16 v[20:23], v[32:35], a[120:127], v1
    v_smfmac_f32_16x16x64_bf16 v[24:27], v[32:35], a[176:183], v1
    s_waitcnt lgkmcnt(4)
    v_smfmac_f32_16x16x64_bf16 v[12:15], v[36:39], a[16:23], v1
    v_smfmac_f32_16x16x64_bf16 v[16:19], v[36:39], a[72:79], v1
    s_waitcnt lgkmcnt(3)
    v_smfmac_f32_16x16x64_bf16 v[12:15], v[52:55], a[48:55], v1
    v_smfmac_f32_16x16x64_bf16 v[16:19], v[52:55], a[104:111], v1
    s_waitcnt lgkmcnt(2)
    v_smfmac_f32_16x16x64_bf16 v[12:15], v[40:43], a[24:31], v1
    v_smfmac_f32_16x16x64_bf16 v[16:19], v[40:43], a[80:87], v1
    s_waitcnt lgkmcnt(1)
    v_smfmac_f32_16x16x64_bf16 v[12:15], v[44:47], a[32:39], v1
    v_smfmac_f32_16x16x64_bf16 v[16:19], v[44:47], a[88:95], v1
    s_waitcnt lgkmcnt(0)
    v_smfmac_f32_16x16x64_bf16 v[12:15], v[48:51], a[40:47], v1
    v_smfmac_f32_16x16x64_bf16 v[16:19], v[48:51], a[96:103], v1
    v_smfmac_f32_16x16x64_bf16 v[20:23], v[36:39], a[128:135], v1
    s_nop 1
    v_smfmac_f32_16x16x64_bf16 v[24:27], v[36:39], a[184:191], v1
    s_nop 1
    v_smfmac_f32_16x16x64_bf16 v[20:23], v[52:55], a[160:167], v1
    v_add_f32 v12, v12, v13
    v_add_f32 v14, v14, v15
    v_smfmac_f32_16x16x64_bf16 v[24:27], v[52:55], a[216:223], v1
    v_add_f32 v16, v16, v17
    v_add_f32 v18, v18, v19
    v_smfmac_f32_16x16x64_bf16 v[20:23], v[40:43], a[136:143], v1
    v_cvt_pk_bf16_f32 v8, v12, v16
    v_cvt_pk_bf16_f32 v9, v14, v18
    v_smfmac_f32_16x16x64_bf16 v[24:27], v[40:43], a[192:199], v1
    ds_write2_b32 v3, v8, v9 offset0:0 offset1:8
    v_cmp_u_f32 vcc, v12, v14
    v_smfmac_f32_16x16x64_bf16 v[20:23], v[44:47], a[144:151], v1
    v_mov_b32 v12, 0
    v_mov_b32 v13, 0
    v_smfmac_f32_16x16x64_bf16 v[24:27], v[44:47], a[200:207], v1
    v_mov_b32 v14, 0
    v_mov_b32 v15, 0
    v_smfmac_f32_16x16x64_bf16 v[20:23], v[48:51], a[152:159], v1
    s_waitcnt lgkmcnt(0)
    s_barrier
    v_smfmac_f32_16x16x64_bf16 v[24:27], v[48:51], a[208:215], v1
    v_mov_b32 v16, 0
    v_mov_b32 v17, 0
    v_mov_b32 v18, 0
    v_mov_b32 v19, 0
    s_nop 1
    v_add_f32 v20, v20, v21
    v_add_f32 v22, v22, v23
    v_add_f32 v24, v24, v25
    v_add_f32 v26, v26, v27
    v_cvt_pk_bf16_f32 v10, v20, v24
    v_cvt_pk_bf16_f32 v11, v22, v26
    ds_write2_b32 v5, v10, v11 offset0:0 offset1:8
    s_cbranch_vccnz Y2f_fail
Y2f_yok:
    v_mov_b32 v20, 0
    v_mov_b32 v21, 0
    v_mov_b32 v22, 0
    v_mov_b32 v23, 0
    v_mov_b32 v24, 0
    v_mov_b32 v25, 0
    v_mov_b32 v26, 0
    v_mov_b32 v27, 0
    s_waitcnt lgkmcnt(0)
    s_barrier
    v_smfmac_f32_16x16x64_bf16 v[12:15], v[28:31], a[224:231], v1
    v_smfmac_f32_16x16x64_bf16 v[12:15], v[32:35], a[232:239], v1
    v_smfmac_f32_16x16x64_bf16 v[12:15], v[36:39], a[240:247], v1
    v_smfmac_f32_16x16x64_bf16 v[12:15], v[40:43], a[248:255], v1
    v_smfmac_f32_16x16x64_bf16 v[12:15], v[44:47], v[64:71], v1
    v_smfmac_f32_16x16x64_bf16 v[12:15], v[48:51], v[72:79], v1
    v_smfmac_f32_16x16x64_bf16 v[12:15], v[52:55], v[80:87], v1
    v_smfmac_f32_16x16x64_bf16 v[16:19], v[28:31], v[88:95], v1
    v_smfmac_f32_16x16x64_bf16 v[16:19], v[32:35], v[96:103], v1
    v_smfmac_f32_16x16x64_bf16 v[16:19], v[36:39], v[104:111], v1
    v_smfmac_f32_16x16x64_bf16 v[16:19], v[40:43], v[112:119], v1
    v_smfmac_f32_16x16x64_bf16 v[16:19], v[44:47], v[120:127], v1
    s_nop 2
    v_add_f32 v12, v12, v13
    v_smfmac_f32_16x16x64_bf16 v[16:19], v[48:51], v[128:135], v1
    v_add_f32 v14, v14, v15
    v_smfmac_f32_16x16x64_bf16 v[16:19], v[52:55], v[136:143], v1
    v_cvt_pk_bf16_f32 v8, v12, v14
    v_smfmac_f32_16x16x64_bf16 v[20:23], v[28:31], v[144:151], v1
    v_smfmac_f32_16x16x64_bf16 v[20:23], v[32:35], v[152:159], v1
    v_smfmac_f32_16x16x64_bf16 v[20:23], v[36:39], v[160:167], v1
    v_smfmac_f32_16x16x64_bf16 v[20:23], v[40:43], v[168:175], v1
    v_smfmac_f32_16x16x64_bf16 v[20:23], v[44:47], v[176:183], v1
    s_nop 2
    v_add_f32 v16, v16, v17
    v_smfmac_f32_16x16x64_bf16 v[20:23], v[48:51], v[184:191], v1
    v_add_f32 v18, v18, v19
    v_smfmac_f32_16x16x64_bf16 v[20:23], v[52:55], v[192:199], v1
    v_cvt_pk_bf16_f32 v9, v16, v18
    v_smfmac_f32_16x16x64_bf16 v[24:27], v[28:31], v[200:207], v1
    v_smfmac_f32_16x16x64_bf16 v[24:27], v[32:35], v[208:215], v1
    v_smfmac_f32_16x16x64_bf16 v[24:27], v[36:39], v[216:223], v1
    v_smfmac_f32_16x16x64_bf16 v[24:27], v[40:43], v[224:231], v1
    v_smfmac_f32_16x16x64_bf16 v[24:27], v[44:47], v[232:239], v1
    s_nop 2
    v_add_f32 v20, v20, v21
    v_smfmac_f32_16x16x64_bf16 v[24:27], v[48:51], v[240:247], v1
    v_add_f32 v22, v22, v23
    v_smfmac_f32_16x16x64_bf16 v[24:27], v[52:55], v[248:255], v1
    v_cvt_pk_bf16_f32 v10, v20, v22
    s_nop 7
    v_add_f32 v24, v24, v25
    v_add_f32 v26, v26, v27
    v_cvt_pk_bf16_f32 v11, v24, v26
    ds_write_b64 v6, v[8:9]
    ds_write_b64 v6, v[10:11] offset:512
    s_waitcnt lgkmcnt(0)
    s_barrier
    s_add_u32 m0, s46, 0
    s_add_u32 s38, s31, 0
    buffer_load_dwordx4 v0, s[4:7], s38 offen offset:0 sc1 lds
    buffer_load_dwordx4 v0, s[4:7], s38 offen offset:1024 sc1 lds
    buffer_load_dwordx4 v0, s[4:7], s38 offen offset:2048 sc1 lds
    buffer_load_dwordx4 v0, s[4:7], s38 offen offset:3072 sc1 lds
    s_add_u32 m0, s46, 4096
    s_add_u32 s38, s31, 4096
    buffer_load_dwordx4 v0, s[4:7], s38 offen offset:0 sc1 lds
    buffer_load_dwordx4 v0, s[4:7], s38 offen offset:1024 sc1 lds
    buffer_load_dwordx4 v0, s[4:7], s38 offen offset:2048 sc1 lds
    buffer_load_dwordx4 v0, s[4:7], s38 offen offset:3072 sc1 lds
    s_add_u32 m0, s46, 8192
    s_add_u32 s38, s31, 8192
    buffer_load_dwordx4 v0, s[4:7], s38 offen offset:0 sc1 lds
    buffer_load_dwordx4 v0, s[4:7], s38 offen offset:1024 sc1 lds
    buffer_load_dwordx4 v0, s[4:7], s38 offen offset:2048 sc1 lds
    buffer_load_dwordx4 v0, s[4:7], s38 offen offset:3072 sc1 lds
    s_add_u32 m0, s46, 12288
    s_add_u32 s38, s31, 12288
    buffer_load_dwordx4 v0, s[4:7], s38 offen offset:0 sc1 lds
    buffer_load_dwordx4 v0, s[4:7], s38 offen offset:1024 sc1 lds
    s_add_u32 s31, s31, 28672
    s_xor_b32 s46, s46, 0x1c000
    s_mov_b32 s26, s24
    s_mov_b32 s24, s25
    s_add_u32 s25, s25, 0x10000
    s_and_b32 s25, s25, 14876672
    s_add_u32 s20, s20, 1
    s_cmp_lt_u32 s20, 63
    s_cbranch_scc1 Y2f_loop
    s_branch L_team_done
Y2f_fail:
    v_max_u32 v56, v28, v29
    v_max3_u32 v56, v56, v30, v31
    v_max3_u32 v56, v56, v32, v33
    v_max3_u32 v56, v56, v34, v35
    v_max3_u32 v56, v56, v36, v37
    v_max3_u32 v56, v56, v38, v39
    v_max3_u32 v56, v56, v40, v41
    v_max3_u32 v56, v56, v42, v43
    v_max3_u32 v56, v56, v44, v45
    v_max3_u32 v56, v56, v46, v47
    v_max3_u32 v56, v56, v48, v49
    v_max3_u32 v56, v56, v50, v51
    v_max3_u32 v56, v56, v52, v53
    v_max3_u32 v56, v56, v54, v55
    v_cmp_eq_u32 vcc, -1, v56
    s_cbranch_vccz Y2f_yok
    s_waitcnt lgkmcnt(0)
    s_sub_u32 s35, s35, 1
    s_cmp_eq_u32 s35, 0
    s_cbranch_scc1 L_team_done
    v_mov_b32 v12, 0
    v_mov_b32 v13, 0
    v_mov_b32 v14, 0
    v_mov_b32 v15, 0
    v_mov_b32 v16, 0
    v_mov_b32 v17, 0
    v_mov_b32 v18, 0
    v_mov_b32 v19, 0
    v_mov_b32 v20, 0
    v_mov_b32 v21, 0
    v_mov_b32 v22, 0
    v_mov_b32 v23, 0
    v_mov_b32 v24, 0
    v_mov_b32 v25, 0
    v_mov_b32 v26, 0
    v_mov_b32 v27, 0
    s_mov_b32 m0, 0
    s_barrier
    buffer_load_dwordx4 v0, s[4:7], s45 offen sc1 lds
    buffer_load_dwordx4 v0, s[4:7], s45 offen offset:3072 sc1 lds
    s_waitcnt vmcnt(0)
    s_barrier
    ds_read_b128 v[28:31], v0 offset:0
    ds_read_b128 v[32:35], v0 offset:1024
    ds_read_b128 v[36:39], v0 offset:2048
    ds_read_b128 v[52:55], v0 offset:6144
    ds_read_b128 v[40:43], v0 offset:3072
    ds_read_b128 v[44:47], v0 offset:4096
    ds_read_b128 v[48:51], v0 offset:5120
    s_waitcnt lgkmcnt(6)
    v_smfmac_f32_16x16x64_bf16 v[12:15], v[28:31], a[0:7], v1
    v_smfmac_f32_16x16x64_bf16 v[16:19], v[28:31], a[56:63], v1
    v_smfmac_f32_16x16x64_bf16 v[20:23], v[28:31], a[112:119], v1
    v_smfmac_f32_16x16x64_bf16 v[24:27], v[28:31], a[168:175], v1
    s_branch Y2f_y
W3_entry:
    v_mbcnt_lo_u32_b32 v57, -1, 0
    v_and_b32 v57, 0, v57
    v_lshlrev_b32 v57, 7, v57
    s_mov_b32 s41, 15237120
    s_lshr_b32 s40, s18, 2
    s_lshl_b32 s40, s40, 7
    s_add_u32 s41, s41, s40
    s_mov_b64 exec, 1
WD_38:
    buffer_load_dword v56, v57, s[4:7], s41 offen sc1
    s_waitcnt vmcnt(0)
    v_cmp_gt_u32 vcc, 0x40, v56
    s_cbranch_vccz WD_38_ok
    s_sub_u32 s35, s35, 1
    s_cmp_lg_u32 s35, 0
    s_cbranch_scc1 WD_38
    s_branch L_team_done
WD_38_ok:
    s_mov_b64 exec, -1
    v_mov_b32 v56, 1
    v_mov_b32 v57, 16512
    ds_write_b32 v57, v56
    s_mov_b64 exec, 1
    v_mov_b32 v57, 0
W3_seats:
    buffer_load_dword v56, v57, s[12:15], 0 offen sc0 sc1
    s_waitcnt vmcnt(0)
    v_readfirstlane_b32 s36, v56
    s_and_b32 s37, s36, 0xffff
    s_cmp_ge_u32 s37, 32
    s_cbranch_scc1 W3_seats_ok
    s_sub_u32 s35, s35, 1
    s_cmp_lg_u32 s35, 0
    s_cbranch_scc1 W3_seats
    s_branch L_team_done
W3_seats_ok:
    s_mov_b64 exec, -1
    s_lshr_b32 s23, s36, 16
    v_mov_b32 v56, s23
    v_mov_b32 v57, 16384
    ds_write_b32 v57, v56
    v_lshrrev_b32 v63, 3, v61
    v_lshlrev_b32 v3, 8, v63
    v_lshl_add_u32 v3, v62, 6, v3
    v_bfe_u32 v63, v61, 1, 1
    v_lshl_add_u32 v3, v63, 4, v3
    v_bfe_u32 v63, v61, 2, 1
    v_lshl_add_u32 v3, v63, 3, v3
    v_and_b32 v63, 1, v61
    v_lshl_add_u32 v3, v63, 2, v3
    v_add_u32 v3, 11776, v3
    s_add_u32 s36, s16, 0
    s_and_b32 s36, s36, 7
    s_lshl_b32 s37, s36, 11
    v_add_u32 v176, s37, v0
    s_lshl_b32 s37, s36, 10
    s_add_u32 s37, s37, 10240
    v_add_u32 v148, s37, v0
    s_add_u32 s36, s16, 1
    s_and_b32 s36, s36, 7
    s_lshl_b32 s37, s36, 11
    v_add_u32 v177, s37, v0
    s_lshl_b32 s37, s36, 10
    s_add_u32 s37, s37, 10240
    v_add_u32 v149, s37, v0
    s_add_u32 s36, s16, 2
    s_and_b32 s36, s36, 7
    s_lshl_b32 s37, s36, 11
    v_add_u32 v178, s37, v0
    s_lshl_b32 s37, s36, 10
    s_add_u32 s37, s37, 10240
    v_add_u32 v150, s37, v0
    s_add_u32 s36, s16, 3
    s_and_b32 s36, s36, 7
    s_lshl_b32 s37, s36, 11
    v_add_u32 v179, s37, v0
    s_lshl_b32 s37, s36, 10
    s_add_u32 s37, s37, 10240
    v_add_u32 v151, s37, v0
    s_add_u32 s36, s16, 4
    s_and_b32 s36, s36, 7
    s_lshl_b32 s37, s36, 11
    v_add_u32 v180, s37, v0
    s_lshl_b32 s37, s36, 10
    s_add_u32 s37, s37, 10240
    v_add_u32 v152, s37, v0
    s_add_u32 s36, s16, 5
    s_and_b32 s36, s36, 7
    s_lshl_b32 s37, s36, 11
    v_add_u32 v181, s37, v0
    s_lshl_b32 s37, s36, 10
    s_add_u32 s37, s37, 10240
    v_add_u32 v153, s37, v0
    s_add_u32 s36, s16, 6
    s_and_b32 s36, s36, 7
    s_lshl_b32 s37, s36, 11
    v_add_u32 v182, s37, v0
    s_lshl_b32 s37, s36, 10
    s_add_u32 s37, s37, 10240
    v_add_u32 v154, s37, v0
    s_add_u32 s36, s16, 7
    s_and_b32 s36, s36, 7
    s_lshl_b32 s37, s36, 11
    v_add_u32 v183, s37, v0
    s_lshl_b32 s37, s36, 10
    s_add_u32 s37, s37, 10240
    v_add_u32 v155, s37, v0
    v_add_u32 v156, 8192, v0
    v_add_u32 v186, 49152, v0
    v_and_b32 v173, 7, v61
    v_lshlrev_b32 v173, 5, v173
    v_lshrrev_b32 v63, 1, v62
    v_lshl_add_u32 v173, v63, 8, v173
    v_and_b32 v63, 1, v62
    v_lshl_add_u32 v173, v63, 3, v173
    s_mul_i32 s36, s19, 3584
    v_add_u32 v173, s36, v173
    v_add_u32 v174, 2048, v173
    v_mul_u32_u24 v6, 320, v63
    v_lshl_add_u32 v6, v61, 2, v6
    v_lshrrev_b32 v63, 1, v62
    v_cmp_eq_u32 vcc, s19, v63
    v_cmp_gt_u32 s[40:41], 8, v61
    s_xor_b32 s36, s16, 1
    s_mul_i32 s36, s36, 640
    s_add_u32 s36, s36, 20480
    v_add_u32 v59, s36, v6
    v_add_u32 v6, 16640, v6
    v_mov_b32 v58, 2146435072
    v_mov_b32 v57, 17664
    v_cndmask_b32 v170, v59, v58, vcc
    v_cndmask_b32 v6, v57, v6, vcc
    v_cndmask_b32 v171, v58, v170, s[40:41]
    v_cndmask_b32 v172, v57, v6, s[40:41]
    v_cmp_gt_u32 vcc, 10, v61
    v_mov_b32 v63, 0x7f800000
    v_mov_b32 v9, 0x42800000
    v_mul_u32_u24 v2, 160, v62
    v_cndmask_b32 v9, v63, v9, vcc
    v_cndmask_b32 v63, 0, v61, vcc
    v_lshl_add_u32 v2, v63, 4, v2
    s_mul_i32 s36, s16, 640
    s_add_u32 s36, s36, 20480
    v_add_u32 v147, s36, v2
    v_add_u32 v2, 16640, v2
    v_mov_b32 v63, 18176
    v_cndmask_b32 v2, v63, v2, vcc
    v_mov_b32 v68, 0xf149f2ca
    v_mov_b32 v69, 0xf149f2ca
    v_mov_b32 v70, 0xf149f2ca
    v_mov_b32 v71, 0xf149f2ca
    ds_write_b128 v63, v[68:71]
    v_cndmask_b32 v10, v58, v147, vcc
    v_lshrrev_b32 v59, 1, v61
    s_lshl_b32 s36, s18, 2
    s_add_u32 s36, s36, 15
    v_add_u32 v59, s36, v59
    v_mov_b32 v57, s18
    v_cmp_gt_u32 s[40:41], 2, v61
    s_nop 1
    v_cndmask_b32 v59, v59, v57, s[40:41]
    v_lshrrev_b32 v57, 1, v59
    v_lshlrev_b32 v4, 8, v57
    v_and_b32 v57, 1, v59
    v_lshl_add_u32 v4, v57, 4, v4
    v_and_b32 v57, 1, v61
    v_lshl_add_u32 v4, v57, 3, v4
    v_lshl_add_u32 v4, v62, 5, v4
    s_lshl_b32 s36, s19, 7
    s_add_u32 s36, s36, 8192
    v_add_u32 v4, s36, v4
    v_cndmask_b32 v4, v58, v4, vcc
    v_cmp_eq_u32 vcc, 0, v60
    s_nop 0
    v_mov_b32 v57, s16
    v_cndmask_b32 v143, v58, v57, vcc
    v_and_b32 v57, 7, v60
    v_lshlrev_b32 v142, 2, v57
    v_mov_b32 v144, 0
    v_mov_b32 v185, 16448
    ds_write_b32 v185, v144
    v_and_b32 v58, 1, v61
    v_lshl_add_u32 v59, v62, 1, v58
    v_lshlrev_b32 v5, 5, v59
    v_bfe_u32 v57, v61, 1, 1
    v_lshl_add_u32 v5, v57, 4, v5
    v_lshrrev_b32 v57, 2, v61
    v_lshl_add_u32 v5, v57, 2, v5
    s_lshl_b32 s36, s16, 8
    v_add_u32 v5, s36, v5
    v_lshlrev_b32 v158, 4, v59
    v_bfe_u32 v57, v61, 3, 1
    v_lshl_add_u32 v158, v57, 7, v158
    v_bfe_u32 v57, v61, 1, 2
    v_lshl_add_u32 v158, v57, 2, v158
    v_add_u32 v158, s36, v158
    v_mov_b32 v184, 0
    v_cmp_eq_u32 vcc, 1, v58
    v_mov_b32 v8, 0x01000504
    v_mov_b32 v57, 0x07060302
    v_cndmask_b32 v8, v8, v57, vcc
    v_mul_u32_u24 v59, 896, v59
    v_lshrrev_b32 v57, 1, v61
    v_lshl_add_u32 v59, v57, 2, v59
    s_lshl_b32 s36, s21, 5
    v_add_u32 v59, s36, v59
    buffer_load_dword v157, v59, s[60:63], 0 offen
    v_min_u32 v145, 13, v60
    v_lshlrev_b32 v145, 6, v145
    s_lshl_b32 s37, s21, 14
    s_add_u32 s30, s37, 33554432
    s_mul_i32 s47, s16, 896
    s_add_u32 s47, s47, 25194496
    s_mov_b32 s33, 15728640
    s_mov_b32 s44, 1035512379
    s_cmp_eq_u32 s16, 31
    s_cselect_b32 s51, 56, 0
    s_cselect_b32 s36, 0, 2146435072
    v_mov_b32 v187, s36
    s_sub_u32 s49, s19, 1
    s_not_b32 s48, s49
    s_mov_b32 s32, 15269888
    s_cmp_lt_u32 s16, 28
    s_cbranch_scc1 W3_real
    v_mov_b32 v148, 2146435072
    v_mov_b32 v149, 2146435072
    v_mov_b32 v150, 2146435072
    v_mov_b32 v151, 2146435072
    v_mov_b32 v152, 2146435072
    v_mov_b32 v153, 2146435072
    v_mov_b32 v154, 2146435072
    v_mov_b32 v155, 2146435072
    v_mov_b32 v156, 2146435072
    v_mov_b32 v176, 2146435072
    v_mov_b32 v177, 2146435072
    v_mov_b32 v178, 2146435072
    v_mov_b32 v179, 2146435072
    v_mov_b32 v180, 2146435072
    v_mov_b32 v181, 2146435072
    v_mov_b32 v182, 2146435072
    v_mov_b32 v183, 2146435072
W3_real:
    v_mov_b32 v12, 0
    v_mov_b32 v13, 0
    v_mov_b32 v14, 0
    v_mov_b32 v15, 0
    v_mov_b32 v16, 0
    v_mov_b32 v17, 0
    v_mov_b32 v18, 0
    v_mov_b32 v19, 0
    v_mov_b32 v20, 0
    v_mov_b32 v21, 0
    v_mov_b32 v22, 0
    v_mov_b32 v23, 0
    v_mov_b32 v24, 0
    v_mov_b32 v25, 0
    v_mov_b32 v26, 0
    v_mov_b32 v27, 0
    v_mov_b32 v28, 0
    v_mov_b32 v29, 0
    v_mov_b32 v30, 0
    v_mov_b32 v31, 0
    v_mov_b32 v60, -1
    v_mov_b32 v84, 0
    v_mov_b32 v88, 0
    v_mov_b32 v61, -1
    v_mov_b32 v85, 0
    v_mov_b32 v89, 0
    v_mov_b32 v62, -1
    v_mov_b32 v86, 0
    v_mov_b32 v90, 0
    v_mov_b32 v63, -1
    v_mov_b32 v87, 0
    v_mov_b32 v91, 0
    v_mov_b32 v136, 0
    v_mov_b32 v137, 0
    v_mov_b32 v138, 0
    v_mov_b32 v139, 0
    v_mov_b32 v140, 0
    v_mov_b32 v141, 0
    ds_write_b128 v0, v[12:15] offset:9216
    s_waitcnt vmcnt(0)
    s_cmp_lg_u32 s23, 0
    s_cbranch_scc1 W3i_far
    buffer_store_byte v144, v143, s[4:7], s22 offen
    buffer_store_byte v144, v143, s[4:7], s22 offen offset:2048
    s_mov_b32 s36, 14680064
    buffer_store_dwordx4 v[60:63], v10, s[4:7], s36 offen
    buffer_store_dwordx2 v[60:61], v4, s[4:7], s36 offen
    buffer_store_dword v157, v5, s[4:7], s36 offen
    s_mov_b32 s36, 14745600
    buffer_store_dwordx4 v[60:63], v10, s[4:7], s36 offen
    buffer_store_dwordx2 v[60:61], v4, s[4:7], s36 offen
    buffer_store_dword v60, v5, s[4:7], s36 offen
    s_mov_b32 s36, 14811136
    buffer_store_dwordx4 v[60:63], v10, s[4:7], s36 offen
    buffer_store_dwordx2 v[60:61], v4, s[4:7], s36 offen
    buffer_store_dword v60, v5, s[4:7], s36 offen
    s_mov_b32 s36, 14876672
    buffer_store_dwordx4 v[60:63], v10, s[4:7], s36 offen
    buffer_store_dwordx2 v[60:61], v4, s[4:7], s36 offen
    buffer_store_dword v60, v5, s[4:7], s36 offen
    s_branch W3_inited
W3i_far:
    buffer_store_byte v144, v143, s[4:7], s22 offen sc1
    buffer_store_byte v144, v143, s[4:7], s22 offen offset:2048 sc1
    s_mov_b32 s36, 14680064
    buffer_store_dwordx4 v[60:63], v10, s[4:7], s36 offen sc1
    buffer_store_dwordx2 v[60:61], v4, s[4:7], s36 offen sc1
    buffer_store_dword v157, v5, s[4:7], s36 offen sc1
    s_mov_b32 s36, 14745600
    buffer_store_dwordx4 v[60:63], v10, s[4:7], s36 offen sc1
    buffer_store_dwordx2 v[60:61], v4, s[4:7], s36 offen sc1
    buffer_store_dword v60, v5, s[4:7], s36 offen sc1
    s_mov_b32 s36, 14811136
    buffer_store_dwordx4 v[60:63], v10, s[4:7], s36 offen sc1
    buffer_store_dwordx2 v[60:61], v4, s[4:7], s36 offen sc1
    buffer_store_dword v60, v5, s[4:7], s36 offen sc1
    s_mov_b32 s36, 14876672
    buffer_store_dwordx4 v[60:63], v10, s[4:7], s36 offen sc1
    buffer_store_dwordx2 v[60:61], v4, s[4:7], s36 offen sc1
    buffer_store_dword v60, v5, s[4:7], s36 offen sc1
W3_inited:
    s_waitcnt vmcnt(0)
    s_mov_b64 exec, 1
    v_mov_b32 v56, 1
    v_mov_b32 v57, 64
    buffer_atomic_add v56, v57, s[12:15], 0 offen
    s_mov_b64 exec, -1
    v_mbcnt_lo_u32_b32 v57, -1, 0
    v_and_b32 v57, 3, v57
    v_lshlrev_b32 v57, 7, v57
    s_mov_b32 s41, 15237632
    s_mov_b64 exec, 15
WD_39:
    buffer_load_dword v56, v57, s[4:7], s41 offen sc1
    s_waitcnt vmcnt(0)
    v_cmp_gt_u32 vcc, 0x40, v56
    s_cbranch_vccz WD_39_ok
    s_sub_u32 s35, s35, 1
    s_cmp_lg_u32 s35, 0
    s_cbranch_scc1 WD_39
    s_branch L_team_done
WD_39_ok:
    s_mov_b64 exec, -1
    v_mov_b32 v56, 2
    v_mov_b32 v57, 16512
    ds_write_b32 v57, v56
    v_mbcnt_lo_u32_b32 v57, -1, 0
    v_and_b32 v57, 1, v57
    v_lshlrev_b32 v57, 7, v57
    s_mov_b32 s41, 15238144
    s_mov_b64 exec, 3
WD_40:
    buffer_load_dword v56, v57, s[4:7], s41 offen sc1
    s_waitcnt vmcnt(0)
    v_cmp_gt_u32 vcc, 0x40, v56
    s_cbranch_vccz WD_40_ok
    s_sleep 4
    s_sub_u32 s35, s35, 1
    s_cmp_lg_u32 s35, 0
    s_cbranch_scc1 WD_40
    s_branch L_team_done
WD_40_ok:
    s_mov_b64 exec, -1
    v_mov_b32 v56, 3
    v_mov_b32 v57, 16512
    ds_write_b32 v57, v56
    s_mul_i32 s36, s16, 200704
    s_add_u32 s36, s36, 172032
    buffer_load_dwordx4 a[0:3], v0, s[4:7], s36 offen offset:0 sc1
    buffer_load_dwordx4 a[4:7], v0, s[4:7], s36 offen offset:1024 sc1
    buffer_load_dwordx4 a[8:11], v0, s[4:7], s36 offen offset:2048 sc1
    buffer_load_dwordx4 a[12:15], v0, s[4:7], s36 offen offset:3072 sc1
    s_add_u32 s36, s36, 4096
    buffer_load_dwordx4 a[16:19], v0, s[4:7], s36 offen offset:0 sc1
    buffer_load_dwordx4 a[20:23], v0, s[4:7], s36 offen offset:1024 sc1
    buffer_load_dwordx4 a[24:27], v0, s[4:7], s36 offen offset:2048 sc1
    buffer_load_dwordx4 a[28:31], v0, s[4:7], s36 offen offset:3072 sc1
    s_add_u32 s36, s36, 4096
    buffer_load_dwordx4 a[32:35], v0, s[4:7], s36 offen offset:0 sc1
    buffer_load_dwordx4 a[36:39], v0, s[4:7], s36 offen offset:1024 sc1
    buffer_load_dwordx4 a[40:43], v0, s[4:7], s36 offen offset:2048 sc1
    buffer_load_dwordx4 a[44:47], v0, s[4:7], s36 offen offset:3072 sc1
    s_add_u32 s36, s36, 4096
    buffer_load_dwordx4 a[48:51], v0, s[4:7], s36 offen offset:0 sc1
    buffer_load_dwordx4 a[52:55], v0, s[4:7], s36 offen offset:1024 sc1
    buffer_load_dwordx4 a[56:59], v0, s[4:7], s36 offen offset:2048 sc1
    buffer_load_dwordx4 a[60:63], v0, s[4:7], s36 offen offset:3072 sc1
    s_add_u32 s36, s36, 4096
    buffer_load_dwordx4 a[64:67], v0, s[4:7], s36 offen offset:0 sc1
    buffer_load_dwordx4 a[68:71], v0, s[4:7], s36 offen offset:1024 sc1
    buffer_load_dwordx4 a[72:75], v0, s[4:7], s36 offen offset:2048 sc1
    buffer_load_dwordx4 a[76:79], v0, s[4:7], s36 offen offset:3072 sc1
    s_add_u32 s36, s36, 4096
    buffer_load_dwordx4 a[80:83], v0, s[4:7], s36 offen offset:0 sc1
    buffer_load_dwordx4 a[84:87], v0, s[4:7], s36 offen offset:1024 sc1
    buffer_load_dwordx4 a[88:91], v0, s[4:7], s36 offen offset:2048 sc1
    buffer_load_dwordx4 a[92:95], v0, s[4:7], s36 offen offset:3072 sc1
    s_add_u32 s36, s36, 4096
    buffer_load_dwordx4 a[96:99], v0, s[4:7], s36 offen offset:0 sc1
    buffer_load_dwordx4 a[100:103], v0, s[4:7], s36 offen offset:1024 sc1
    buffer_load_dwordx4 a[104:107], v0, s[4:7], s36 offen offset:2048 sc1
    buffer_load_dwordx4 a[108:111], v0, s[4:7], s36 offen offset:3072 sc1
    s_mov_b64 exec, 1
    v_mov_b32 v57, 64
W3_tsync:
    buffer_load_dword v56, v57, s[12:15], 0 offen sc0 sc1
    s_waitcnt vmcnt(0)
    v_readfirstlane_b32 s36, v56
    s_and_b32 s37, s36, 0xffff
    s_cmp_ge_u32 s37, 32
    s_cbranch_scc1 W3_tsync_ok
    s_sub_u32 s35, s35, 1
    s_cmp_lg_u32 s35, 0
    s_cbranch_scc1 W3_tsync
    s_branch L_team_done
W3_tsync_ok:
    s_mov_b64 exec, -1
W3_vo0:
    buffer_load_dword v159, v184, s[4:7], s32 offen sc1
    s_waitcnt vmcnt(0)
    v_cmp_gt_u32 vcc, 56, v159
    s_cbranch_vccz W3_vo0_ok
    s_sub_u32 s35, s35, 1
    s_cmp_lg_u32 s35, 0
    s_cbranch_scc1 W3_vo0
    s_branch L_team_done
W3_vo0_ok:
    s_mov_b32 s28, 0
    s_lshr_b32 s36, s20, 1
    s_add_u32 s36, s36, s20
    s_add_u32 s36, s36, 3
    s_min_u32 s36, s36, 63
    s_lshl_b32 s32, s36, 11
    s_add_u32 s32, s32, 15269888
    s_add_u32 s37, s20, 1
    s_cmp_le_u32 s37, s28
    s_cselect_b32 s32, 2146435072, s32
    s_cselect_b32 s50, 0, s51
    s_cselect_b32 s29, s28, s36
    s_getpc_b64 s[40:41]
W3_ref:
    v_lshlrev_b32 v64, 2, v0
    v_add_u32 v64, W3_loop - W3_ref, v64
    global_load_dword v65, v64, s[40:41]
    v_add_u32 v64, 4096, v64
    global_load_dword v65, v64, s[40:41]
    s_waitcnt vmcnt(0) lgkmcnt(0)
    s_barrier
    s_cmp_lg_u32 s23, 0
    s_cbranch_scc1 W3_far
    s_add_u32 s45, s24, 6144
    s_mov_b32 s39, 0
W3_loop:
    s_mov_b32 m0, 6144
    s_barrier
    buffer_load_dwordx4 v0, s[4:7], s45 offen sc1 lds
    s_barrier
    s_add_u32 s47, s47, 28672
    s_add_u32 s39, s39, 0x01010101
    v_add_u32 v144, 1, v144
    s_nop 1
    buffer_store_dword v157, v158, s[4:7], s33 offen sc1
    buffer_load_dword v159, v187, s[4:7], s32 offen sc1
    buffer_load_dword v146, v145, s[4:7], s47 offen sc1
    buffer_store_dword v60, v5, s[4:7], s26 offen
    buffer_store_dwordx2 v[60:61], v4, s[4:7], s27 offen
    buffer_store_dwordx4 v[60:63], v10, s[4:7], s26 offen
    buffer_load_dwordx4 a[128:131], v176, s[4:7], s30 offen sc1
    buffer_load_dwordx4 a[132:135], v176, s[4:7], s30 offen offset:1024 sc1
    buffer_load_dwordx4 a[136:139], v177, s[4:7], s30 offen sc1
    buffer_load_dwordx4 a[140:143], v177, s[4:7], s30 offen offset:1024 sc1
    buffer_load_dwordx4 a[144:147], v178, s[4:7], s30 offen sc1
    ds_read_b128 a[192:195], v186 offset:0
    ds_read_b128 a[196:199], v186 offset:2048
    ds_read_b128 a[200:203], v186 offset:4096
    ds_read_b128 a[204:207], v186 offset:1024
    ds_read_b128 a[208:211], v186 offset:3072
    ds_read_b128 a[212:215], v186 offset:5120
    ds_read_b128 a[216:219], v186 offset:6144
    ds_read_b128 a[220:223], v186 offset:7168
    ds_read_b128 a[224:227], v186 offset:9216
    ds_read_b128 a[228:231], v186 offset:11264
    ds_read_b128 a[232:235], v186 offset:8192
    ds_read_b128 a[236:239], v186 offset:10240
    ds_read_b128 a[240:243], v186 offset:12288
    ds_read_b128 a[244:247], v186 offset:13312
    s_barrier
    s_waitcnt vmcnt(11)
    s_barrier
    ds_read_b128 v[32:35], v0 offset:0
    ds_read_b128 v[36:39], v0 offset:1024
    ds_read_b128 v[40:43], v0 offset:2048
    ds_read_b128 v[56:59], v0 offset:6144
    s_barrier
    ds_read_b128 v[44:47], v0 offset:3072
    ds_read_b128 v[48:51], v0 offset:4096
    ds_read_b128 v[52:55], v0 offset:5120
    buffer_load_dwordx4 a[148:151], v178, s[4:7], s30 offen offset:1024 sc1
    buffer_load_dwordx4 a[152:155], v179, s[4:7], s30 offen sc1
    buffer_load_dwordx4 a[156:159], v179, s[4:7], s30 offen offset:1024 sc1
    buffer_load_dwordx4 a[160:163], v180, s[4:7], s30 offen sc1
    buffer_load_dwordx4 a[164:167], v180, s[4:7], s30 offen offset:1024 sc1
    buffer_load_dwordx4 a[168:171], v181, s[4:7], s30 offen sc1
    buffer_load_dwordx4 a[172:175], v181, s[4:7], s30 offen offset:1024 sc1
    buffer_load_dwordx4 a[176:179], v182, s[4:7], s30 offen sc1
    buffer_load_dwordx4 a[180:183], v182, s[4:7], s30 offen offset:1024 sc1
    buffer_load_dwordx4 a[184:187], v183, s[4:7], s30 offen sc1
    buffer_load_dwordx4 a[188:191], v183, s[4:7], s30 offen offset:1024 sc1
W3_y:
    s_waitcnt lgkmcnt(6)
    v_smfmac_f32_16x16x64_bf16 v[12:15], v[32:35], a[0:7], v1
    v_smfmac_f32_16x16x64_bf16 v[16:19], v[32:35], a[56:63], v1
    s_waitcnt lgkmcnt(5)
    v_smfmac_f32_16x16x64_bf16 v[12:15], v[36:39], a[8:15], v1
    v_smfmac_f32_16x16x64_bf16 v[16:19], v[36:39], a[64:71], v1
    s_waitcnt lgkmcnt(4)
    v_smfmac_f32_16x16x64_bf16 v[12:15], v[40:43], a[16:23], v1
    v_smfmac_f32_16x16x64_bf16 v[16:19], v[40:43], a[72:79], v1
    s_waitcnt lgkmcnt(3)
    v_smfmac_f32_16x16x64_bf16 v[12:15], v[56:59], a[48:55], v1
    v_smfmac_f32_16x16x64_bf16 v[16:19], v[56:59], a[104:111], v1
    s_waitcnt lgkmcnt(0)
    v_smfmac_f32_16x16x64_bf16 v[12:15], v[44:47], a[24:31], v1
    v_smfmac_f32_16x16x64_bf16 v[16:19], v[44:47], a[80:87], v1
    ds_read2_b64 v[208:211], v173 offset0:0 offset1:2
    ds_read2_b64 v[212:215], v173 offset0:128 offset1:130
    v_smfmac_f32_16x16x64_bf16 v[12:15], v[48:51], a[32:39], v1
    v_smfmac_f32_16x16x64_bf16 v[16:19], v[48:51], a[88:95], v1
    ds_read2_b64 v[216:219], v174 offset0:0 offset1:2
    ds_read2_b64 v[220:223], v173 offset0:64 offset1:66
    v_smfmac_f32_16x16x64_bf16 v[12:15], v[52:55], a[40:47], v1
    v_smfmac_f32_16x16x64_bf16 v[16:19], v[52:55], a[96:103], v1
    ds_read2_b64 v[224:227], v173 offset0:192 offset1:194
    ds_read2_b64 v[228:231], v174 offset0:64 offset1:66
    ds_read2_b64 v[232:235], v174 offset0:128 offset1:130
    v_mov_b32 v240, -1
    v_mov_b32 v244, -1
    v_mov_b32 v248, -1
    v_mov_b32 v252, -1
    v_add_f32 v12, v12, v13
    v_add_f32 v14, v14, v15
    v_cmp_u_f32 vcc, v12, v14
    v_add_f32 v16, v16, v17
    v_add_f32 v18, v18, v19
    v_cvt_pk_bf16_f32 v12, v12, v16
    v_cvt_pk_bf16_f32 v14, v14, v18
    ds_write2_b32 v3, v12, v14 offset0:0 offset1:8
    s_barrier
    ds_read_b128 v[192:195], v0 offset:8192
    ds_read_b128 v[196:199], v0 offset:9216
    s_cbranch_vccnz W3_fail
W3_yok:
    s_waitcnt lgkmcnt(1)
    v_smfmac_f32_16x16x64_bf16 v[20:23], v[192:195], v[208:215], v1
    v_smfmac_f32_16x16x64_bf16 v[24:27], v[192:195], a[192:199], v1
    v_smfmac_f32_16x16x64_bf16 v[28:31], v[192:195], a[220:227], v1
    s_waitcnt lgkmcnt(0)
    v_smfmac_f32_16x16x64_bf16 v[20:23], v[196:199], v[216:223], v1
    v_smfmac_f32_16x16x64_bf16 v[24:27], v[196:199], a[200:207], v1
    v_smfmac_f32_16x16x64_bf16 v[28:31], v[196:199], a[228:235], v1
    s_barrier
    ds_read_b128 v[200:203], v0 offset:10240
    ds_read_b128 v[204:207], v0 offset:11264
    s_waitcnt lgkmcnt(1)
    v_smfmac_f32_16x16x64_bf16 v[20:23], v[200:203], v[220:227], v1
    s_waitcnt lgkmcnt(0)
    v_smfmac_f32_16x16x64_bf16 v[20:23], v[204:207], v[228:235], v1
    v_smfmac_f32_16x16x64_bf16 v[24:27], v[200:203], a[204:211], v1
    v_smfmac_f32_16x16x64_bf16 v[24:27], v[204:207], a[212:219], v1
    v_smfmac_f32_16x16x64_bf16 v[28:31], v[200:203], a[232:239], v1
    v_smfmac_f32_16x16x64_bf16 v[28:31], v[204:207], a[240:247], v1
    s_nop 3
    v_add_f32 v20, v20, v21
    v_add_f32 v22, v22, v23
    v_add_f32 v24, v24, v25
    v_add_f32 v26, v26, v27
    v_add_f32 v28, v28, v29
    v_add_f32 v30, v30, v31
    s_mov_b64 exec, s[48:49]
    buffer_store_dword v20, v171, s[4:7], s24 offen offset:0
    buffer_store_dword v22, v171, s[4:7], s24 offen offset:160
    buffer_store_dword v24, v170, s[4:7], s24 offen offset:32
    buffer_store_dword v26, v170, s[4:7], s24 offen offset:192
    buffer_store_dword v28, v170, s[4:7], s24 offen offset:96
    buffer_store_dword v30, v170, s[4:7], s24 offen offset:256
    s_mov_b64 exec, -1
    ds_write2_b32 v172, v20, v22 offset0:0 offset1:40
    ds_write2_b32 v6, v24, v26 offset0:8 offset1:48
    ds_write2_b32 v6, v28, v30 offset0:24 offset1:64
    ds_read_b128 v[76:79], v2
    v_mov_b32 v12, 0
    v_mov_b32 v13, 0
    v_mov_b32 v14, 0
    v_mov_b32 v15, 0
    v_mov_b32 v16, 0
    v_mov_b32 v17, 0
    v_mov_b32 v18, 0
    v_mov_b32 v19, 0
    v_mov_b32 v20, 0
    v_mov_b32 v21, 0
    v_mov_b32 v22, 0
    v_mov_b32 v23, 0
    v_mov_b32 v24, 0
    v_mov_b32 v25, 0
    v_mov_b32 v26, 0
    v_mov_b32 v27, 0
    v_mov_b32 v28, 0
    v_mov_b32 v29, 0
    v_mov_b32 v30, 0
    v_mov_b32 v31, 0
    s_waitcnt lgkmcnt(0)
    v_mul_f32 v76, s44, v76
    v_mul_f32 v77, s44, v77
    v_mul_f32 v78, s44, v78
    v_mul_f32 v79, s44, v79
    buffer_load_dwordx4 v[236:239], v147, s[4:7], s24 offen sc1
    v_cmp_eq_u32 vcc, -1, v240
    s_cbranch_vccz W3_sok0
    buffer_load_dwordx4 v[240:243], v147, s[4:7], s24 offen sc1
    v_cmp_eq_u32 vcc, -1, v244
    s_cbranch_vccz W3_sok1
    buffer_load_dwordx4 v[244:247], v147, s[4:7], s24 offen sc1
    v_cmp_eq_u32 vcc, -1, v248
    s_cbranch_vccz W3_sok2
    buffer_load_dwordx4 v[248:251], v147, s[4:7], s24 offen sc1
    v_cmp_eq_u32 vcc, -1, v252
    s_cbranch_vccz W3_sok3
    buffer_load_dwordx4 v[252:255], v147, s[4:7], s24 offen sc1
    s_waitcnt vmcnt(4)
    v_cmp_eq_u32 vcc, -1, v236
    s_cbranch_vccz W3_sok4
W3_spoll:
    buffer_load_dwordx4 v[236:239], v147, s[4:7], s24 offen sc1
    s_waitcnt vmcnt(4)
    v_cmp_eq_u32 vcc, -1, v240
    s_cbranch_vccz W3_sok0
    buffer_load_dwordx4 v[240:243], v147, s[4:7], s24 offen sc1
    s_waitcnt vmcnt(4)
    v_cmp_eq_u32 vcc, -1, v244
    s_cbranch_vccz W3_sok1
    buffer_load_dwordx4 v[244:247], v147, s[4:7], s24 offen sc1
    s_waitcnt vmcnt(4)
    v_cmp_eq_u32 vcc, -1, v248
    s_cbranch_vccz W3_sok2
    buffer_load_dwordx4 v[248:251], v147, s[4:7], s24 offen sc1
    s_waitcnt vmcnt(4)
    v_cmp_eq_u32 vcc, -1, v252
    s_cbranch_vccz W3_sok3
    buffer_load_dwordx4 v[252:255], v147, s[4:7], s24 offen sc1
    s_waitcnt vmcnt(4)
    v_cmp_eq_u32 vcc, -1, v236
    s_cbranch_vccz W3_sok4
    s_sub_u32 s35, s35, 1
    s_cmp_lg_u32 s35, 0
    s_cbranch_scc1 W3_spoll
    s_branch L_team_done
W3_sok0:
    buffer_store_byte v144, v143, s[4:7], s22 offen offset:2048
    v_fma_f32 v68, v240, s44, v76
    v_fma_f32 v69, v241, s44, v77
    v_fma_f32 v70, v242, s44, v78
    v_fma_f32 v71, v243, s44, v79
    v_maximum3_f32 v7, |v68|, |v69|, |v70|
    v_exp_f32 v64, v68
    v_maximum3_f32 v7, v7, |v71|, |v71|
    v_exp_f32 v65, v69
    v_cmp_nle_f32 vcc, v7, v9
    v_exp_f32 v66, v70
    v_exp_f32 v67, v71
    v_add_f32 v7, v64, v65
    v_add_f32 v11, v66, v67
    s_cbranch_vccnz W3_smax
    v_add_f32 v7, v7, v11
    s_nop 1
    v_add_f32_dpp v7, v7, v7 row_ror:8 row_mask:0xf bank_mask:0xf
    s_nop 1
    v_add_f32_dpp v7, v7, v7 row_ror:4 row_mask:0xf bank_mask:0xf
    s_nop 1
    v_add_f32_dpp v7, v7, v7 row_ror:2 row_mask:0xf bank_mask:0xf
    s_nop 1
    v_add_f32_dpp v7, v7, v7 row_ror:1 row_mask:0xf bank_mask:0xf
    v_rcp_f32 v74, v7
    s_nop 0
    v_pk_mul_f32 v[68:69], v[64:65], v[74:75] op_sel_hi:[1,0]
    v_pk_mul_f32 v[70:71], v[66:67], v[74:75] op_sel_hi:[1,0]
    v_cvt_pk_bf16_f32 v72, v68, v69
    v_cvt_pk_bf16_f32 v73, v70, v71
    buffer_load_dword v80, v142, s[4:7], s22 offen offset:2048 sc1
    buffer_store_dwordx2 v[72:73], v4, s[4:7], s24 offen
    s_branch W3_pub
W3_sok1:
    buffer_store_byte v144, v143, s[4:7], s22 offen offset:2048
    v_fma_f32 v68, v244, s44, v76
    v_fma_f32 v69, v245, s44, v77
    v_fma_f32 v70, v246, s44, v78
    v_fma_f32 v71, v247, s44, v79
    v_maximum3_f32 v7, |v68|, |v69|, |v70|
    v_exp_f32 v64, v68
    v_maximum3_f32 v7, v7, |v71|, |v71|
    v_exp_f32 v65, v69
    v_cmp_nle_f32 vcc, v7, v9
    v_exp_f32 v66, v70
    v_exp_f32 v67, v71
    v_add_f32 v7, v64, v65
    v_add_f32 v11, v66, v67
    s_cbranch_vccnz W3_smax
    v_add_f32 v7, v7, v11
    s_nop 1
    v_add_f32_dpp v7, v7, v7 row_ror:8 row_mask:0xf bank_mask:0xf
    s_nop 1
    v_add_f32_dpp v7, v7, v7 row_ror:4 row_mask:0xf bank_mask:0xf
    s_nop 1
    v_add_f32_dpp v7, v7, v7 row_ror:2 row_mask:0xf bank_mask:0xf
    s_nop 1
    v_add_f32_dpp v7, v7, v7 row_ror:1 row_mask:0xf bank_mask:0xf
    v_rcp_f32 v74, v7
    s_nop 0
    v_pk_mul_f32 v[68:69], v[64:65], v[74:75] op_sel_hi:[1,0]
    v_pk_mul_f32 v[70:71], v[66:67], v[74:75] op_sel_hi:[1,0]
    v_cvt_pk_bf16_f32 v72, v68, v69
    v_cvt_pk_bf16_f32 v73, v70, v71
    buffer_load_dword v80, v142, s[4:7], s22 offen offset:2048 sc1
    buffer_store_dwordx2 v[72:73], v4, s[4:7], s24 offen
    s_branch W3_pub
W3_sok2:
    buffer_store_byte v144, v143, s[4:7], s22 offen offset:2048
    v_fma_f32 v68, v248, s44, v76
    v_fma_f32 v69, v249, s44, v77
    v_fma_f32 v70, v250, s44, v78
    v_fma_f32 v71, v251, s44, v79
    v_maximum3_f32 v7, |v68|, |v69|, |v70|
    v_exp_f32 v64, v68
    v_maximum3_f32 v7, v7, |v71|, |v71|
    v_exp_f32 v65, v69
    v_cmp_nle_f32 vcc, v7, v9
    v_exp_f32 v66, v70
    v_exp_f32 v67, v71
    v_add_f32 v7, v64, v65
    v_add_f32 v11, v66, v67
    s_cbranch_vccnz W3_smax
    v_add_f32 v7, v7, v11
    s_nop 1
    v_add_f32_dpp v7, v7, v7 row_ror:8 row_mask:0xf bank_mask:0xf
    s_nop 1
    v_add_f32_dpp v7, v7, v7 row_ror:4 row_mask:0xf bank_mask:0xf
    s_nop 1
    v_add_f32_dpp v7, v7, v7 row_ror:2 row_mask:0xf bank_mask:0xf
    s_nop 1
    v_add_f32_dpp v7, v7, v7 row_ror:1 row_mask:0xf bank_mask:0xf
    v_rcp_f32 v74, v7
    s_nop 0
    v_pk_mul_f32 v[68:69], v[64:65], v[74:75] op_sel_hi:[1,0]
    v_pk_mul_f32 v[70:71], v[66:67], v[74:75] op_sel_hi:[1,0]
    v_cvt_pk_bf16_f32 v72, v68, v69
    v_cvt_pk_bf16_f32 v73, v70, v71
    buffer_load_dword v80, v142, s[4:7], s22 offen offset:2048 sc1
    buffer_store_dwordx2 v[72:73], v4, s[4:7], s24 offen
    s_branch W3_pub
W3_sok3:
    buffer_store_byte v144, v143, s[4:7], s22 offen offset:2048
    v_fma_f32 v68, v252, s44, v76
    v_fma_f32 v69, v253, s44, v77
    v_fma_f32 v70, v254, s44, v78
    v_fma_f32 v71, v255, s44, v79
    v_maximum3_f32 v7, |v68|, |v69|, |v70|
    v_exp_f32 v64, v68
    v_maximum3_f32 v7, v7, |v71|, |v71|
    v_exp_f32 v65, v69
    v_cmp_nle_f32 vcc, v7, v9
    v_exp_f32 v66, v70
    v_exp_f32 v67, v71
    v_add_f32 v7, v64, v65
    v_add_f32 v11, v66, v67
    s_cbranch_vccnz W3_smax
    v_add_f32 v7, v7, v11
    s_nop 1
    v_add_f32_dpp v7, v7, v7 row_ror:8 row_mask:0xf bank_mask:0xf
    s_nop 1
    v_add_f32_dpp v7, v7, v7 row_ror:4 row_mask:0xf bank_mask:0xf
    s_nop 1
    v_add_f32_dpp v7, v7, v7 row_ror:2 row_mask:0xf bank_mask:0xf
    s_nop 1
    v_add_f32_dpp v7, v7, v7 row_ror:1 row_mask:0xf bank_mask:0xf
    v_rcp_f32 v74, v7
    s_nop 0
    v_pk_mul_f32 v[68:69], v[64:65], v[74:75] op_sel_hi:[1,0]
    v_pk_mul_f32 v[70:71], v[66:67], v[74:75] op_sel_hi:[1,0]
    v_cvt_pk_bf16_f32 v72, v68, v69
    v_cvt_pk_bf16_f32 v73, v70, v71
    buffer_load_dword v80, v142, s[4:7], s22 offen offset:2048 sc1
    buffer_store_dwordx2 v[72:73], v4, s[4:7], s24 offen
    s_branch W3_pub
W3_sok4:
    buffer_store_byte v144, v143, s[4:7], s22 offen offset:2048
    v_fma_f32 v68, v236, s44, v76
    v_fma_f32 v69, v237, s44, v77
    v_fma_f32 v70, v238, s44, v78
    v_fma_f32 v71, v239, s44, v79
    v_maximum3_f32 v7, |v68|, |v69|, |v70|
    v_exp_f32 v64, v68
    v_maximum3_f32 v7, v7, |v71|, |v71|
    v_exp_f32 v65, v69
    v_cmp_nle_f32 vcc, v7, v9
    v_exp_f32 v66, v70
    v_exp_f32 v67, v71
    v_add_f32 v7, v64, v65
    v_add_f32 v11, v66, v67
    s_cbranch_vccnz W3_smax
W3_sexp:
    v_add_f32 v7, v7, v11
    s_nop 1
    v_add_f32_dpp v7, v7, v7 row_ror:8 row_mask:0xf bank_mask:0xf
    s_nop 1
    v_add_f32_dpp v7, v7, v7 row_ror:4 row_mask:0xf bank_mask:0xf
    s_nop 1
    v_add_f32_dpp v7, v7, v7 row_ror:2 row_mask:0xf bank_mask:0xf
    s_nop 1
    v_add_f32_dpp v7, v7, v7 row_ror:1 row_mask:0xf bank_mask:0xf
    v_rcp_f32 v74, v7
    s_nop 0
    v_pk_mul_f32 v[68:69], v[64:65], v[74:75] op_sel_hi:[1,0]
    v_pk_mul_f32 v[70:71], v[66:67], v[74:75] op_sel_hi:[1,0]
    v_cvt_pk_bf16_f32 v72, v68, v69
    v_cvt_pk_bf16_f32 v73, v70, v71
    buffer_load_dword v80, v142, s[4:7], s22 offen offset:2048 sc1
    buffer_store_dwordx2 v[72:73], v4, s[4:7], s24 offen
W3_pub:
    s_mov_b64 exec, 0xff
    buffer_load_dword v136, v142, s[4:7], s22 offen offset:2048 sc1
    v_cmp_ne_u32 vcc, s39, v137
    s_cbranch_vccz W3_fok
    buffer_load_dword v137, v142, s[4:7], s22 offen offset:2048 sc1
    v_cmp_ne_u32 vcc, s39, v138
    s_cbranch_vccz W3_fok
    buffer_load_dword v138, v142, s[4:7], s22 offen offset:2048 sc1
    v_cmp_ne_u32 vcc, s39, v139
    s_cbranch_vccz W3_fok
    buffer_load_dword v139, v142, s[4:7], s22 offen offset:2048 sc1
    s_waitcnt vmcnt(5)
    v_cmp_ne_u32 vcc, s39, v80
    s_cbranch_vccz W3_fok
    buffer_load_dword v140, v142, s[4:7], s22 offen offset:2048 sc1
    s_waitcnt vmcnt(4)
    v_cmp_ne_u32 vcc, s39, v136
    s_cbranch_vccz W3_fok
W3_fpoll:
    buffer_load_dword v136, v142, s[4:7], s22 offen offset:2048 sc1
    s_waitcnt vmcnt(4)
    v_cmp_ne_u32 vcc, s39, v137
    s_cbranch_vccz W3_fok
    buffer_load_dword v137, v142, s[4:7], s22 offen offset:2048 sc1
    s_waitcnt vmcnt(4)
    v_cmp_ne_u32 vcc, s39, v138
    s_cbranch_vccz W3_fok
    buffer_load_dword v138, v142, s[4:7], s22 offen offset:2048 sc1
    s_waitcnt vmcnt(4)
    v_cmp_ne_u32 vcc, s39, v139
    s_cbranch_vccz W3_fok
    buffer_load_dword v139, v142, s[4:7], s22 offen offset:2048 sc1
    s_waitcnt vmcnt(4)
    v_cmp_ne_u32 vcc, s39, v140
    s_cbranch_vccz W3_fok
    buffer_load_dword v140, v142, s[4:7], s22 offen offset:2048 sc1
    s_waitcnt vmcnt(4)
    v_cmp_ne_u32 vcc, s39, v136
    s_cbranch_vccz W3_fok
    buffer_load_dword v136, v142, s[4:7], s22 offen offset:2048 sc1
    s_waitcnt vmcnt(4)
    v_cmp_ne_u32 vcc, s39, v137
    s_cbranch_vccz W3_fok
    buffer_load_dword v137, v142, s[4:7], s22 offen offset:2048 sc1
    s_waitcnt vmcnt(4)
    v_cmp_ne_u32 vcc, s39, v138
    s_cbranch_vccz W3_fok
    buffer_load_dword v138, v142, s[4:7], s22 offen offset:2048 sc1
    s_waitcnt vmcnt(4)
    v_cmp_ne_u32 vcc, s39, v139
    s_cbranch_vccz W3_fok
    buffer_load_dword v139, v142, s[4:7], s22 offen offset:2048 sc1
    s_waitcnt vmcnt(4)
    v_cmp_ne_u32 vcc, s39, v140
    s_cbranch_vccz W3_fok
    buffer_load_dword v140, v142, s[4:7], s22 offen offset:2048 sc1
    s_waitcnt vmcnt(4)
    v_cmp_ne_u32 vcc, s39, v136
    s_cbranch_vccz W3_fok
    s_sub_u32 s35, s35, 1
    s_cmp_lg_u32 s35, 0
    s_cbranch_scc1 W3_fpoll
    s_branch L_team_done
W3_fok:
    s_mov_b64 exec, -1
    buffer_load_dwordx4 v[104:107], v148, s[4:7], s24 offen sc1
    buffer_load_dwordx4 v[108:111], v149, s[4:7], s24 offen sc1
    buffer_load_dwordx4 v[112:115], v150, s[4:7], s24 offen sc1
    buffer_load_dwordx4 v[116:119], v151, s[4:7], s24 offen sc1
    buffer_load_dwordx4 v[120:123], v152, s[4:7], s24 offen sc1
    buffer_load_dwordx4 v[124:127], v153, s[4:7], s24 offen sc1
    buffer_load_dwordx4 v[128:131], v154, s[4:7], s24 offen sc1
    buffer_load_dwordx4 v[132:135], v155, s[4:7], s24 offen sc1
    buffer_load_dwordx4 v[96:99], v156, s[4:7], s24 offen offset:0 sc1
    buffer_load_dwordx4 v[100:103], v156, s[4:7], s24 offen offset:1024 sc1
    s_barrier
    ds_read_b128 a[112:115], v0 offset:12288
    ds_read_b128 a[116:119], v0 offset:13312
    ds_read_b128 a[120:123], v0 offset:14336
    ds_read_b128 a[124:127], v0 offset:15360
    s_add_u32 s30, s30, 458752
    s_add_u32 s45, s25, 6144
    s_add_u32 s33, s33, 8192
    v_cmp_gt_u32 vcc, s50, v159
    s_cbranch_vccnz W3_vo
    s_mov_b32 s28, s29
W3_vo_ok:
    s_lshr_b32 s36, s20, 1
    s_add_u32 s36, s36, s20
    s_add_u32 s36, s36, 4
    s_min_u32 s36, s36, 63
    s_lshl_b32 s32, s36, 11
    s_add_u32 s32, s32, 15269888
    s_add_u32 s37, s20, 2
    s_cmp_le_u32 s37, s28
    s_cselect_b32 s32, 2146435072, s32
    s_cselect_b32 s50, 0, s51
    s_cselect_b32 s29, s28, s36
    s_waitcnt vmcnt(9)
    v_smfmac_f32_16x16x64_bf16 v[84:87], v[104:107], a[128:135], v1
    s_waitcnt vmcnt(8)
    v_smfmac_f32_16x16x64_bf16 v[84:87], v[108:111], a[136:143], v1
    s_waitcnt vmcnt(7)
    v_smfmac_f32_16x16x64_bf16 v[84:87], v[112:115], a[144:151], v1
    s_waitcnt vmcnt(6)
    v_smfmac_f32_16x16x64_bf16 v[84:87], v[116:119], a[152:159], v1
    buffer_store_byte v144, v143, s[4:7], s22 offen
    ds_write_b32 v185, v144
    s_waitcnt vmcnt(6)
    v_smfmac_f32_16x16x64_bf16 v[84:87], v[120:123], a[160:167], v1
    s_waitcnt vmcnt(5)
    v_smfmac_f32_16x16x64_bf16 v[84:87], v[124:127], a[168:175], v1
    s_waitcnt vmcnt(4)
    v_smfmac_f32_16x16x64_bf16 v[84:87], v[128:131], a[176:183], v1
    s_waitcnt vmcnt(3)
    v_smfmac_f32_16x16x64_bf16 v[84:87], v[132:135], a[184:191], v1
    s_waitcnt vmcnt(2) lgkmcnt(0)
    v_smfmac_f32_16x16x64_bf16 v[84:87], v[96:99], a[112:119], v1
    s_waitcnt vmcnt(1) lgkmcnt(0)
    v_smfmac_f32_16x16x64_bf16 v[84:87], v[100:103], a[120:127], v1
    s_nop 7
W3_pchk:
    v_add_f32 v84, v84, v85
    v_add_f32 v86, v86, v87
    v_cvt_pk_bf16_f32 v7, v84, v86
    v_cmp_u_f32 vcc, v84, v86
    s_nop 0
    v_mov_b32_dpp v11, v7 quad_perm:[1,0,3,2] row_mask:0xf bank_mask:0xf
    v_perm_b32 v157, v7, v11, v8
    v_cndmask_b32 v7, v157, v60, vcc
    buffer_store_dword v7, v5, s[4:7], s25 offen
    s_cbranch_vccnz W3_pfail
W3_pok:
    s_mov_b32 s27, s26
    v_xor_b32 v186, 0x1c000, v186
    v_mov_b32 v84, 0
    v_mov_b32 v85, 0
    v_mov_b32 v86, 0
    v_mov_b32 v87, 0
    s_mov_b32 s26, s24
    s_mov_b32 s24, s25
    s_add_u32 s25, s25, 0x10000
    s_and_b32 s25, s25, 14876672
    s_add_u32 s20, s20, 1
    s_cmp_lt_u32 s20, 63
    s_cbranch_scc1 W3_loop
    buffer_store_dword v157, v158, s[4:7], s33 offen sc1
    s_branch L_team_done
W3_vo:
    s_add_u32 s28, s20, 1
    s_lshl_b32 s32, s28, 11
    s_add_u32 s32, s32, 15269888
W3_vos:
    buffer_load_dword v159, v184, s[4:7], s32 offen sc1
    s_waitcnt vmcnt(0)
    v_cmp_gt_u32 vcc, 56, v159
    s_cbranch_vccz W3_vo_ok
    s_sub_u32 s35, s35, 1
    s_cmp_lg_u32 s35, 0
    s_cbranch_scc1 W3_vos
    s_branch L_team_done
W3_fail:
    v_max_u32 v7, v32, v33
    v_max3_u32 v7, v7, v34, v35
    v_max3_u32 v7, v7, v36, v37
    v_max3_u32 v7, v7, v38, v39
    v_max3_u32 v7, v7, v40, v41
    v_max3_u32 v7, v7, v42, v43
    v_max3_u32 v7, v7, v44, v45
    v_max3_u32 v7, v7, v46, v47
    v_max3_u32 v7, v7, v48, v49
    v_max3_u32 v7, v7, v50, v51
    v_max3_u32 v7, v7, v52, v53
    v_max3_u32 v7, v7, v54, v55
    v_max3_u32 v7, v7, v56, v57
    v_max3_u32 v7, v7, v58, v59
    v_cmp_eq_u32 vcc, -1, v7
    s_cbranch_vccz W3_yok
    s_waitcnt lgkmcnt(0)
    s_sub_u32 s35, s35, 1
    s_cmp_eq_u32 s35, 0
    s_cbranch_scc1 L_team_done
    v_mov_b32 v12, 0
    v_mov_b32 v13, 0
    v_mov_b32 v14, 0
    v_mov_b32 v15, 0
    v_mov_b32 v16, 0
    v_mov_b32 v17, 0
    v_mov_b32 v18, 0
    v_mov_b32 v19, 0
    s_mov_b32 m0, 6144
    s_barrier
    buffer_load_dwordx4 v0, s[4:7], s45 offen sc1 lds
    s_waitcnt vmcnt(0)
    s_barrier
    ds_read_b128 v[32:35], v0 offset:0
    ds_read_b128 v[36:39], v0 offset:1024
    ds_read_b128 v[40:43], v0 offset:2048
    ds_read_b128 v[56:59], v0 offset:6144
    ds_read_b128 v[44:47], v0 offset:3072
    ds_read_b128 v[48:51], v0 offset:4096
    ds_read_b128 v[52:55], v0 offset:5120
    s_branch W3_y
W3_smax:
    s_waitcnt vmcnt(0)
    buffer_load_dwordx4 v[236:239], v147, s[4:7], s24 offen sc1
    s_waitcnt vmcnt(0)
    v_max3_u32 v7, v236, v237, v238
    v_max_u32 v7, v7, v239
    v_cmp_eq_u32 vcc, -1, v7
    s_cbranch_vccz W3_smax2
    s_sub_u32 s35, s35, 1
    s_cmp_eq_u32 s35, 0
    s_cbranch_scc1 L_team_done
    s_branch W3_smax
W3_smax2:
    v_fma_f32 v68, v236, s44, v76
    v_fma_f32 v69, v237, s44, v77
    v_fma_f32 v70, v238, s44, v78
    v_fma_f32 v71, v239, s44, v79
    v_max3_f32 v7, v68, v69, v70
    v_max_f32 v7, v7, v71
    s_nop 1
    v_max_f32_dpp v7, v7, v7 row_ror:8 row_mask:0xf bank_mask:0xf
    s_nop 1
    v_max_f32_dpp v7, v7, v7 row_ror:4 row_mask:0xf bank_mask:0xf
    s_nop 1
    v_max_f32_dpp v7, v7, v7 row_ror:2 row_mask:0xf bank_mask:0xf
    s_nop 1
    v_max_f32_dpp v7, v7, v7 row_ror:1 row_mask:0xf bank_mask:0xf
    v_sub_f32 v68, v68, v7
    v_sub_f32 v69, v69, v7
    v_sub_f32 v70, v70, v7
    v_sub_f32 v71, v71, v7
    v_exp_f32 v64, v68
    v_exp_f32 v65, v69
    v_exp_f32 v66, v70
    v_exp_f32 v67, v71
    v_add_f32 v7, v64, v65
    v_add_f32 v11, v66, v67
    s_branch W3_sexp
W3_pfail:
    v_mov_b32 v7, 0
    v_max3_u32 v7, v96, v97, v7
    v_max3_u32 v7, v98, v99, v7
    v_max3_u32 v7, v100, v101, v7
    v_max3_u32 v7, v102, v103, v7
    v_max3_u32 v7, v104, v105, v7
    v_max3_u32 v7, v106, v107, v7
    v_max3_u32 v7, v108, v109, v7
    v_max3_u32 v7, v110, v111, v7
    v_max3_u32 v7, v112, v113, v7
    v_max3_u32 v7, v114, v115, v7
    v_max3_u32 v7, v116, v117, v7
    v_max3_u32 v7, v118, v119, v7
    v_max3_u32 v7, v120, v121, v7
    v_max3_u32 v7, v122, v123, v7
    v_max3_u32 v7, v124, v125, v7
    v_max3_u32 v7, v126, v127, v7
    v_max3_u32 v7, v128, v129, v7
    v_max3_u32 v7, v130, v131, v7
    v_max3_u32 v7, v132, v133, v7
    v_max3_u32 v7, v134, v135, v7
    v_cmp_eq_u32 vcc, -1, v7
    s_cbranch_vccnz W3_pagain
    buffer_store_dword v157, v5, s[4:7], s25 offen
    s_branch W3_pok
W3_pagain:
    s_sub_u32 s35, s35, 1
    s_cmp_eq_u32 s35, 0
    s_cbranch_scc1 L_team_done
    v_mov_b32 v84, 0
    v_mov_b32 v85, 0
    v_mov_b32 v86, 0
    v_mov_b32 v87, 0
    buffer_load_dwordx4 v[104:107], v148, s[4:7], s24 offen sc1
    buffer_load_dwordx4 v[108:111], v149, s[4:7], s24 offen sc1
    buffer_load_dwordx4 v[112:115], v150, s[4:7], s24 offen sc1
    buffer_load_dwordx4 v[116:119], v151, s[4:7], s24 offen sc1
    buffer_load_dwordx4 v[120:123], v152, s[4:7], s24 offen sc1
    buffer_load_dwordx4 v[124:127], v153, s[4:7], s24 offen sc1
    buffer_load_dwordx4 v[128:131], v154, s[4:7], s24 offen sc1
    buffer_load_dwordx4 v[132:135], v155, s[4:7], s24 offen sc1
    buffer_load_dwordx4 v[96:99], v156, s[4:7], s24 offen offset:0 sc1
    buffer_load_dwordx4 v[100:103], v156, s[4:7], s24 offen offset:1024 sc1
    s_waitcnt vmcnt(9)
    v_smfmac_f32_16x16x64_bf16 v[84:87], v[104:107], a[128:135], v1
    s_waitcnt vmcnt(8)
    v_smfmac_f32_16x16x64_bf16 v[84:87], v[108:111], a[136:143], v1
    s_waitcnt vmcnt(7)
    v_smfmac_f32_16x16x64_bf16 v[84:87], v[112:115], a[144:151], v1
    s_waitcnt vmcnt(6)
    v_smfmac_f32_16x16x64_bf16 v[84:87], v[116:119], a[152:159], v1
    s_waitcnt vmcnt(5)
    v_smfmac_f32_16x16x64_bf16 v[84:87], v[120:123], a[160:167], v1
    s_waitcnt vmcnt(4)
    v_smfmac_f32_16x16x64_bf16 v[84:87], v[124:127], a[168:175], v1
    s_waitcnt vmcnt(3)
    v_smfmac_f32_16x16x64_bf16 v[84:87], v[128:131], a[176:183], v1
    s_waitcnt vmcnt(2)
    v_smfmac_f32_16x16x64_bf16 v[84:87], v[132:135], a[184:191], v1
    s_waitcnt vmcnt(1) lgkmcnt(0)
    v_smfmac_f32_16x16x64_bf16 v[84:87], v[96:99], a[112:119], v1
    s_waitcnt vmcnt(0) lgkmcnt(0)
    v_smfmac_f32_16x16x64_bf16 v[84:87], v[100:103], a[120:127], v1
    s_nop 7
    s_branch W3_pchk
W3_far:
    s_add_u32 s45, s24, 6144
    s_mov_b32 s39, 0
W3f_loop:
    s_mov_b32 m0, 6144
    s_barrier
    buffer_load_dwordx4 v0, s[4:7], s45 offen sc1 lds
    s_barrier
    s_add_u32 s47, s47, 28672
    s_add_u32 s39, s39, 0x01010101
    v_add_u32 v144, 1, v144
    s_nop 1
    buffer_store_dword v157, v158, s[4:7], s33 offen sc1
    buffer_load_dword v159, v187, s[4:7], s32 offen sc1
    buffer_load_dword v146, v145, s[4:7], s47 offen sc1
    buffer_store_dword v60, v5, s[4:7], s26 offen sc1
    buffer_store_dwordx2 v[60:61], v4, s[4:7], s27 offen sc1
    buffer_store_dwordx4 v[60:63], v10, s[4:7], s26 offen sc1
    buffer_load_dwordx4 a[128:131], v176, s[4:7], s30 offen sc1
    buffer_load_dwordx4 a[132:135], v176, s[4:7], s30 offen offset:1024 sc1
    buffer_load_dwordx4 a[136:139], v177, s[4:7], s30 offen sc1
    buffer_load_dwordx4 a[140:143], v177, s[4:7], s30 offen offset:1024 sc1
    buffer_load_dwordx4 a[144:147], v178, s[4:7], s30 offen sc1
    ds_read_b128 a[192:195], v186 offset:0
    ds_read_b128 a[196:199], v186 offset:2048
    ds_read_b128 a[200:203], v186 offset:4096
    ds_read_b128 a[204:207], v186 offset:1024
    ds_read_b128 a[208:211], v186 offset:3072
    ds_read_b128 a[212:215], v186 offset:5120
    ds_read_b128 a[216:219], v186 offset:6144
    ds_read_b128 a[220:223], v186 offset:7168
    ds_read_b128 a[224:227], v186 offset:9216
    ds_read_b128 a[228:231], v186 offset:11264
    ds_read_b128 a[232:235], v186 offset:8192
    ds_read_b128 a[236:239], v186 offset:10240
    ds_read_b128 a[240:243], v186 offset:12288
    ds_read_b128 a[244:247], v186 offset:13312
    s_barrier
    s_waitcnt vmcnt(11)
    s_barrier
    ds_read_b128 v[32:35], v0 offset:0
    ds_read_b128 v[36:39], v0 offset:1024
    ds_read_b128 v[40:43], v0 offset:2048
    ds_read_b128 v[56:59], v0 offset:6144
    s_barrier
    ds_read_b128 v[44:47], v0 offset:3072
    ds_read_b128 v[48:51], v0 offset:4096
    ds_read_b128 v[52:55], v0 offset:5120
    buffer_load_dwordx4 a[148:151], v178, s[4:7], s30 offen offset:1024 sc1
    buffer_load_dwordx4 a[152:155], v179, s[4:7], s30 offen sc1
    buffer_load_dwordx4 a[156:159], v179, s[4:7], s30 offen offset:1024 sc1
    buffer_load_dwordx4 a[160:163], v180, s[4:7], s30 offen sc1
    buffer_load_dwordx4 a[164:167], v180, s[4:7], s30 offen offset:1024 sc1
    buffer_load_dwordx4 a[168:171], v181, s[4:7], s30 offen sc1
    buffer_load_dwordx4 a[172:175], v181, s[4:7], s30 offen offset:1024 sc1
    buffer_load_dwordx4 a[176:179], v182, s[4:7], s30 offen sc1
    buffer_load_dwordx4 a[180:183], v182, s[4:7], s30 offen offset:1024 sc1
    buffer_load_dwordx4 a[184:187], v183, s[4:7], s30 offen sc1
    buffer_load_dwordx4 a[188:191], v183, s[4:7], s30 offen offset:1024 sc1
W3f_y:
    s_waitcnt lgkmcnt(6)
    v_smfmac_f32_16x16x64_bf16 v[12:15], v[32:35], a[0:7], v1
    v_smfmac_f32_16x16x64_bf16 v[16:19], v[32:35], a[56:63], v1
    s_waitcnt lgkmcnt(5)
    v_smfmac_f32_16x16x64_bf16 v[12:15], v[36:39], a[8:15], v1
    v_smfmac_f32_16x16x64_bf16 v[16:19], v[36:39], a[64:71], v1
    s_waitcnt lgkmcnt(4)
    v_smfmac_f32_16x16x64_bf16 v[12:15], v[40:43], a[16:23], v1
    v_smfmac_f32_16x16x64_bf16 v[16:19], v[40:43], a[72:79], v1
    s_waitcnt lgkmcnt(3)
    v_smfmac_f32_16x16x64_bf16 v[12:15], v[56:59], a[48:55], v1
    v_smfmac_f32_16x16x64_bf16 v[16:19], v[56:59], a[104:111], v1
    s_waitcnt lgkmcnt(0)
    v_smfmac_f32_16x16x64_bf16 v[12:15], v[44:47], a[24:31], v1
    v_smfmac_f32_16x16x64_bf16 v[16:19], v[44:47], a[80:87], v1
    ds_read2_b64 v[208:211], v173 offset0:0 offset1:2
    ds_read2_b64 v[212:215], v173 offset0:128 offset1:130
    v_smfmac_f32_16x16x64_bf16 v[12:15], v[48:51], a[32:39], v1
    v_smfmac_f32_16x16x64_bf16 v[16:19], v[48:51], a[88:95], v1
    ds_read2_b64 v[216:219], v174 offset0:0 offset1:2
    ds_read2_b64 v[220:223], v173 offset0:64 offset1:66
    v_smfmac_f32_16x16x64_bf16 v[12:15], v[52:55], a[40:47], v1
    v_smfmac_f32_16x16x64_bf16 v[16:19], v[52:55], a[96:103], v1
    ds_read2_b64 v[224:227], v173 offset0:192 offset1:194
    ds_read2_b64 v[228:231], v174 offset0:64 offset1:66
    ds_read2_b64 v[232:235], v174 offset0:128 offset1:130
    v_mov_b32 v240, -1
    v_mov_b32 v244, -1
    v_mov_b32 v248, -1
    v_mov_b32 v252, -1
    v_add_f32 v12, v12, v13
    v_add_f32 v14, v14, v15
    v_cmp_u_f32 vcc, v12, v14
    v_add_f32 v16, v16, v17
    v_add_f32 v18, v18, v19
    v_cvt_pk_bf16_f32 v12, v12, v16
    v_cvt_pk_bf16_f32 v14, v14, v18
    ds_write2_b32 v3, v12, v14 offset0:0 offset1:8
    s_barrier
    ds_read_b128 v[192:195], v0 offset:8192
    ds_read_b128 v[196:199], v0 offset:9216
    s_cbranch_vccnz W3f_fail
W3f_yok:
    s_waitcnt lgkmcnt(1)
    v_smfmac_f32_16x16x64_bf16 v[20:23], v[192:195], v[208:215], v1
    v_smfmac_f32_16x16x64_bf16 v[24:27], v[192:195], a[192:199], v1
    v_smfmac_f32_16x16x64_bf16 v[28:31], v[192:195], a[220:227], v1
    s_waitcnt lgkmcnt(0)
    v_smfmac_f32_16x16x64_bf16 v[20:23], v[196:199], v[216:223], v1
    v_smfmac_f32_16x16x64_bf16 v[24:27], v[196:199], a[200:207], v1
    v_smfmac_f32_16x16x64_bf16 v[28:31], v[196:199], a[228:235], v1
    s_barrier
    ds_read_b128 v[200:203], v0 offset:10240
    ds_read_b128 v[204:207], v0 offset:11264
    s_waitcnt lgkmcnt(1)
    v_smfmac_f32_16x16x64_bf16 v[20:23], v[200:203], v[220:227], v1
    s_waitcnt lgkmcnt(0)
    v_smfmac_f32_16x16x64_bf16 v[20:23], v[204:207], v[228:235], v1
    v_smfmac_f32_16x16x64_bf16 v[24:27], v[200:203], a[204:211], v1
    v_smfmac_f32_16x16x64_bf16 v[24:27], v[204:207], a[212:219], v1
    v_smfmac_f32_16x16x64_bf16 v[28:31], v[200:203], a[232:239], v1
    v_smfmac_f32_16x16x64_bf16 v[28:31], v[204:207], a[240:247], v1
    s_nop 3
    v_add_f32 v20, v20, v21
    v_add_f32 v22, v22, v23
    v_add_f32 v24, v24, v25
    v_add_f32 v26, v26, v27
    v_add_f32 v28, v28, v29
    v_add_f32 v30, v30, v31
    s_mov_b64 exec, s[48:49]
    buffer_store_dword v20, v171, s[4:7], s24 offen offset:0 sc1
    buffer_store_dword v22, v171, s[4:7], s24 offen offset:160 sc1
    buffer_store_dword v24, v170, s[4:7], s24 offen offset:32 sc1
    buffer_store_dword v26, v170, s[4:7], s24 offen offset:192 sc1
    buffer_store_dword v28, v170, s[4:7], s24 offen offset:96 sc1
    buffer_store_dword v30, v170, s[4:7], s24 offen offset:256 sc1
    s_mov_b64 exec, -1
    ds_write2_b32 v172, v20, v22 offset0:0 offset1:40
    ds_write2_b32 v6, v24, v26 offset0:8 offset1:48
    ds_write2_b32 v6, v28, v30 offset0:24 offset1:64
    ds_read_b128 v[76:79], v2
    v_mov_b32 v12, 0
    v_mov_b32 v13, 0
    v_mov_b32 v14, 0
    v_mov_b32 v15, 0
    v_mov_b32 v16, 0
    v_mov_b32 v17, 0
    v_mov_b32 v18, 0
    v_mov_b32 v19, 0
    v_mov_b32 v20, 0
    v_mov_b32 v21, 0
    v_mov_b32 v22, 0
    v_mov_b32 v23, 0
    v_mov_b32 v24, 0
    v_mov_b32 v25, 0
    v_mov_b32 v26, 0
    v_mov_b32 v27, 0
    v_mov_b32 v28, 0
    v_mov_b32 v29, 0
    v_mov_b32 v30, 0
    v_mov_b32 v31, 0
    s_waitcnt lgkmcnt(0)
    v_mul_f32 v76, s44, v76
    v_mul_f32 v77, s44, v77
    v_mul_f32 v78, s44, v78
    v_mul_f32 v79, s44, v79
    buffer_load_dwordx4 v[236:239], v147, s[4:7], s24 offen sc1
    v_cmp_eq_u32 vcc, -1, v240
    s_cbranch_vccz W3f_sok0
    buffer_load_dwordx4 v[240:243], v147, s[4:7], s24 offen sc1
    v_cmp_eq_u32 vcc, -1, v244
    s_cbranch_vccz W3f_sok1
    buffer_load_dwordx4 v[244:247], v147, s[4:7], s24 offen sc1
    v_cmp_eq_u32 vcc, -1, v248
    s_cbranch_vccz W3f_sok2
    buffer_load_dwordx4 v[248:251], v147, s[4:7], s24 offen sc1
    v_cmp_eq_u32 vcc, -1, v252
    s_cbranch_vccz W3f_sok3
    buffer_load_dwordx4 v[252:255], v147, s[4:7], s24 offen sc1
    s_waitcnt vmcnt(4)
    v_cmp_eq_u32 vcc, -1, v236
    s_cbranch_vccz W3f_sok4
W3f_spoll:
    buffer_load_dwordx4 v[236:239], v147, s[4:7], s24 offen sc1
    s_waitcnt vmcnt(4)
    v_cmp_eq_u32 vcc, -1, v240
    s_cbranch_vccz W3f_sok0
    buffer_load_dwordx4 v[240:243], v147, s[4:7], s24 offen sc1
    s_waitcnt vmcnt(4)
    v_cmp_eq_u32 vcc, -1, v244
    s_cbranch_vccz W3f_sok1
    buffer_load_dwordx4 v[244:247], v147, s[4:7], s24 offen sc1
    s_waitcnt vmcnt(4)
    v_cmp_eq_u32 vcc, -1, v248
    s_cbranch_vccz W3f_sok2
    buffer_load_dwordx4 v[248:251], v147, s[4:7], s24 offen sc1
    s_waitcnt vmcnt(4)
    v_cmp_eq_u32 vcc, -1, v252
    s_cbranch_vccz W3f_sok3
    buffer_load_dwordx4 v[252:255], v147, s[4:7], s24 offen sc1
    s_waitcnt vmcnt(4)
    v_cmp_eq_u32 vcc, -1, v236
    s_cbranch_vccz W3f_sok4
    s_sub_u32 s35, s35, 1
    s_cmp_lg_u32 s35, 0
    s_cbranch_scc1 W3f_spoll
    s_branch L_team_done
W3f_sok0:
    buffer_store_byte v144, v143, s[4:7], s22 offen offset:2048 sc1
    v_fma_f32 v68, v240, s44, v76
    v_fma_f32 v69, v241, s44, v77
    v_fma_f32 v70, v242, s44, v78
    v_fma_f32 v71, v243, s44, v79
    v_maximum3_f32 v7, |v68|, |v69|, |v70|
    v_exp_f32 v64, v68
    v_maximum3_f32 v7, v7, |v71|, |v71|
    v_exp_f32 v65, v69
    v_cmp_nle_f32 vcc, v7, v9
    v_exp_f32 v66, v70
    v_exp_f32 v67, v71
    v_add_f32 v7, v64, v65
    v_add_f32 v11, v66, v67
    s_cbranch_vccnz W3f_smax
    v_add_f32 v7, v7, v11
    s_nop 1
    v_add_f32_dpp v7, v7, v7 row_ror:8 row_mask:0xf bank_mask:0xf
    s_nop 1
    v_add_f32_dpp v7, v7, v7 row_ror:4 row_mask:0xf bank_mask:0xf
    s_nop 1
    v_add_f32_dpp v7, v7, v7 row_ror:2 row_mask:0xf bank_mask:0xf
    s_nop 1
    v_add_f32_dpp v7, v7, v7 row_ror:1 row_mask:0xf bank_mask:0xf
    v_rcp_f32 v74, v7
    s_nop 0
    v_pk_mul_f32 v[68:69], v[64:65], v[74:75] op_sel_hi:[1,0]
    v_pk_mul_f32 v[70:71], v[66:67], v[74:75] op_sel_hi:[1,0]
    v_cvt_pk_bf16_f32 v72, v68, v69
    v_cvt_pk_bf16_f32 v73, v70, v71
    buffer_load_dword v80, v142, s[4:7], s22 offen offset:2048 sc1
    buffer_store_dwordx2 v[72:73], v4, s[4:7], s24 offen sc1
    s_branch W3f_pub
W3f_sok1:
    buffer_store_byte v144, v143, s[4:7], s22 offen offset:2048 sc1
    v_fma_f32 v68, v244, s44, v76
    v_fma_f32 v69, v245, s44, v77
    v_fma_f32 v70, v246, s44, v78
    v_fma_f32 v71, v247, s44, v79
    v_maximum3_f32 v7, |v68|, |v69|, |v70|
    v_exp_f32 v64, v68
    v_maximum3_f32 v7, v7, |v71|, |v71|
    v_exp_f32 v65, v69
    v_cmp_nle_f32 vcc, v7, v9
    v_exp_f32 v66, v70
    v_exp_f32 v67, v71
    v_add_f32 v7, v64, v65
    v_add_f32 v11, v66, v67
    s_cbranch_vccnz W3f_smax
    v_add_f32 v7, v7, v11
    s_nop 1
    v_add_f32_dpp v7, v7, v7 row_ror:8 row_mask:0xf bank_mask:0xf
    s_nop 1
    v_add_f32_dpp v7, v7, v7 row_ror:4 row_mask:0xf bank_mask:0xf
    s_nop 1
    v_add_f32_dpp v7, v7, v7 row_ror:2 row_mask:0xf bank_mask:0xf
    s_nop 1
    v_add_f32_dpp v7, v7, v7 row_ror:1 row_mask:0xf bank_mask:0xf
    v_rcp_f32 v74, v7
    s_nop 0
    v_pk_mul_f32 v[68:69], v[64:65], v[74:75] op_sel_hi:[1,0]
    v_pk_mul_f32 v[70:71], v[66:67], v[74:75] op_sel_hi:[1,0]
    v_cvt_pk_bf16_f32 v72, v68, v69
    v_cvt_pk_bf16_f32 v73, v70, v71
    buffer_load_dword v80, v142, s[4:7], s22 offen offset:2048 sc1
    buffer_store_dwordx2 v[72:73], v4, s[4:7], s24 offen sc1
    s_branch W3f_pub
W3f_sok2:
    buffer_store_byte v144, v143, s[4:7], s22 offen offset:2048 sc1
    v_fma_f32 v68, v248, s44, v76
    v_fma_f32 v69, v249, s44, v77
    v_fma_f32 v70, v250, s44, v78
    v_fma_f32 v71, v251, s44, v79
    v_maximum3_f32 v7, |v68|, |v69|, |v70|
    v_exp_f32 v64, v68
    v_maximum3_f32 v7, v7, |v71|, |v71|
    v_exp_f32 v65, v69
    v_cmp_nle_f32 vcc, v7, v9
    v_exp_f32 v66, v70
    v_exp_f32 v67, v71
    v_add_f32 v7, v64, v65
    v_add_f32 v11, v66, v67
    s_cbranch_vccnz W3f_smax
    v_add_f32 v7, v7, v11
    s_nop 1
    v_add_f32_dpp v7, v7, v7 row_ror:8 row_mask:0xf bank_mask:0xf
    s_nop 1
    v_add_f32_dpp v7, v7, v7 row_ror:4 row_mask:0xf bank_mask:0xf
    s_nop 1
    v_add_f32_dpp v7, v7, v7 row_ror:2 row_mask:0xf bank_mask:0xf
    s_nop 1
    v_add_f32_dpp v7, v7, v7 row_ror:1 row_mask:0xf bank_mask:0xf
    v_rcp_f32 v74, v7
    s_nop 0
    v_pk_mul_f32 v[68:69], v[64:65], v[74:75] op_sel_hi:[1,0]
    v_pk_mul_f32 v[70:71], v[66:67], v[74:75] op_sel_hi:[1,0]
    v_cvt_pk_bf16_f32 v72, v68, v69
    v_cvt_pk_bf16_f32 v73, v70, v71
    buffer_load_dword v80, v142, s[4:7], s22 offen offset:2048 sc1
    buffer_store_dwordx2 v[72:73], v4, s[4:7], s24 offen sc1
    s_branch W3f_pub
W3f_sok3:
    buffer_store_byte v144, v143, s[4:7], s22 offen offset:2048 sc1
    v_fma_f32 v68, v252, s44, v76
    v_fma_f32 v69, v253, s44, v77
    v_fma_f32 v70, v254, s44, v78
    v_fma_f32 v71, v255, s44, v79
    v_maximum3_f32 v7, |v68|, |v69|, |v70|
    v_exp_f32 v64, v68
    v_maximum3_f32 v7, v7, |v71|, |v71|
    v_exp_f32 v65, v69
    v_cmp_nle_f32 vcc, v7, v9
    v_exp_f32 v66, v70
    v_exp_f32 v67, v71
    v_add_f32 v7, v64, v65
    v_add_f32 v11, v66, v67
    s_cbranch_vccnz W3f_smax
    v_add_f32 v7, v7, v11
    s_nop 1
    v_add_f32_dpp v7, v7, v7 row_ror:8 row_mask:0xf bank_mask:0xf
    s_nop 1
    v_add_f32_dpp v7, v7, v7 row_ror:4 row_mask:0xf bank_mask:0xf
    s_nop 1
    v_add_f32_dpp v7, v7, v7 row_ror:2 row_mask:0xf bank_mask:0xf
    s_nop 1
    v_add_f32_dpp v7, v7, v7 row_ror:1 row_mask:0xf bank_mask:0xf
    v_rcp_f32 v74, v7
    s_nop 0
    v_pk_mul_f32 v[68:69], v[64:65], v[74:75] op_sel_hi:[1,0]
    v_pk_mul_f32 v[70:71], v[66:67], v[74:75] op_sel_hi:[1,0]
    v_cvt_pk_bf16_f32 v72, v68, v69
    v_cvt_pk_bf16_f32 v73, v70, v71
    buffer_load_dword v80, v142, s[4:7], s22 offen offset:2048 sc1
    buffer_store_dwordx2 v[72:73], v4, s[4:7], s24 offen sc1
    s_branch W3f_pub
W3f_sok4:
    buffer_store_byte v144, v143, s[4:7], s22 offen offset:2048 sc1
    v_fma_f32 v68, v236, s44, v76
    v_fma_f32 v69, v237, s44, v77
    v_fma_f32 v70, v238, s44, v78
    v_fma_f32 v71, v239, s44, v79
    v_maximum3_f32 v7, |v68|, |v69|, |v70|
    v_exp_f32 v64, v68
    v_maximum3_f32 v7, v7, |v71|, |v71|
    v_exp_f32 v65, v69
    v_cmp_nle_f32 vcc, v7, v9
    v_exp_f32 v66, v70
    v_exp_f32 v67, v71
    v_add_f32 v7, v64, v65
    v_add_f32 v11, v66, v67
    s_cbranch_vccnz W3f_smax
W3f_sexp:
    v_add_f32 v7, v7, v11
    s_nop 1
    v_add_f32_dpp v7, v7, v7 row_ror:8 row_mask:0xf bank_mask:0xf
    s_nop 1
    v_add_f32_dpp v7, v7, v7 row_ror:4 row_mask:0xf bank_mask:0xf
    s_nop 1
    v_add_f32_dpp v7, v7, v7 row_ror:2 row_mask:0xf bank_mask:0xf
    s_nop 1
    v_add_f32_dpp v7, v7, v7 row_ror:1 row_mask:0xf bank_mask:0xf
    v_rcp_f32 v74, v7
    s_nop 0
    v_pk_mul_f32 v[68:69], v[64:65], v[74:75] op_sel_hi:[1,0]
    v_pk_mul_f32 v[70:71], v[66:67], v[74:75] op_sel_hi:[1,0]
    v_cvt_pk_bf16_f32 v72, v68, v69
    v_cvt_pk_bf16_f32 v73, v70, v71
    buffer_load_dword v80, v142, s[4:7], s22 offen offset:2048 sc1
    buffer_store_dwordx2 v[72:73], v4, s[4:7], s24 offen sc1
W3f_pub:
    s_mov_b64 exec, 0xff
    buffer_load_dword v136, v142, s[4:7], s22 offen offset:2048 sc1
    v_cmp_ne_u32 vcc, s39, v137
    s_cbranch_vccz W3f_fok
    buffer_load_dword v137, v142, s[4:7], s22 offen offset:2048 sc1
    v_cmp_ne_u32 vcc, s39, v138
    s_cbranch_vccz W3f_fok
    buffer_load_dword v138, v142, s[4:7], s22 offen offset:2048 sc1
    v_cmp_ne_u32 vcc, s39, v139
    s_cbranch_vccz W3f_fok
    buffer_load_dword v139, v142, s[4:7], s22 offen offset:2048 sc1
    s_waitcnt vmcnt(5)
    v_cmp_ne_u32 vcc, s39, v80
    s_cbranch_vccz W3f_fok
    buffer_load_dword v140, v142, s[4:7], s22 offen offset:2048 sc1
    s_waitcnt vmcnt(4)
    v_cmp_ne_u32 vcc, s39, v136
    s_cbranch_vccz W3f_fok
W3f_fpoll:
    buffer_load_dword v136, v142, s[4:7], s22 offen offset:2048 sc1
    s_waitcnt vmcnt(4)
    v_cmp_ne_u32 vcc, s39, v137
    s_cbranch_vccz W3f_fok
    buffer_load_dword v137, v142, s[4:7], s22 offen offset:2048 sc1
    s_waitcnt vmcnt(4)
    v_cmp_ne_u32 vcc, s39, v138
    s_cbranch_vccz W3f_fok
    buffer_load_dword v138, v142, s[4:7], s22 offen offset:2048 sc1
    s_waitcnt vmcnt(4)
    v_cmp_ne_u32 vcc, s39, v139
    s_cbranch_vccz W3f_fok
    buffer_load_dword v139, v142, s[4:7], s22 offen offset:2048 sc1
    s_waitcnt vmcnt(4)
    v_cmp_ne_u32 vcc, s39, v140
    s_cbranch_vccz W3f_fok
    buffer_load_dword v140, v142, s[4:7], s22 offen offset:2048 sc1
    s_waitcnt vmcnt(4)
    v_cmp_ne_u32 vcc, s39, v136
    s_cbranch_vccz W3f_fok
    buffer_load_dword v136, v142, s[4:7], s22 offen offset:2048 sc1
    s_waitcnt vmcnt(4)
    v_cmp_ne_u32 vcc, s39, v137
    s_cbranch_vccz W3f_fok
    buffer_load_dword v137, v142, s[4:7], s22 offen offset:2048 sc1
    s_waitcnt vmcnt(4)
    v_cmp_ne_u32 vcc, s39, v138
    s_cbranch_vccz W3f_fok
    buffer_load_dword v138, v142, s[4:7], s22 offen offset:2048 sc1
    s_waitcnt vmcnt(4)
    v_cmp_ne_u32 vcc, s39, v139
    s_cbranch_vccz W3f_fok
    buffer_load_dword v139, v142, s[4:7], s22 offen offset:2048 sc1
    s_waitcnt vmcnt(4)
    v_cmp_ne_u32 vcc, s39, v140
    s_cbranch_vccz W3f_fok
    buffer_load_dword v140, v142, s[4:7], s22 offen offset:2048 sc1
    s_waitcnt vmcnt(4)
    v_cmp_ne_u32 vcc, s39, v136
    s_cbranch_vccz W3f_fok
    s_sub_u32 s35, s35, 1
    s_cmp_lg_u32 s35, 0
    s_cbranch_scc1 W3f_fpoll
    s_branch L_team_done
W3f_fok:
    s_mov_b64 exec, -1
    buffer_load_dwordx4 v[104:107], v148, s[4:7], s24 offen sc1
    buffer_load_dwordx4 v[108:111], v149, s[4:7], s24 offen sc1
    buffer_load_dwordx4 v[112:115], v150, s[4:7], s24 offen sc1
    buffer_load_dwordx4 v[116:119], v151, s[4:7], s24 offen sc1
    buffer_load_dwordx4 v[120:123], v152, s[4:7], s24 offen sc1
    buffer_load_dwordx4 v[124:127], v153, s[4:7], s24 offen sc1
    buffer_load_dwordx4 v[128:131], v154, s[4:7], s24 offen sc1
    buffer_load_dwordx4 v[132:135], v155, s[4:7], s24 offen sc1
    buffer_load_dwordx4 v[96:99], v156, s[4:7], s24 offen offset:0 sc1
    buffer_load_dwordx4 v[100:103], v156, s[4:7], s24 offen offset:1024 sc1
    s_barrier
    ds_read_b128 a[112:115], v0 offset:12288
    ds_read_b128 a[116:119], v0 offset:13312
    ds_read_b128 a[120:123], v0 offset:14336
    ds_read_b128 a[124:127], v0 offset:15360
    s_add_u32 s30, s30, 458752
    s_add_u32 s45, s25, 6144
    s_add_u32 s33, s33, 8192
    v_cmp_gt_u32 vcc, s50, v159
    s_cbranch_vccnz W3f_vo
    s_mov_b32 s28, s29
W3f_vo_ok:
    s_lshr_b32 s36, s20, 1
    s_add_u32 s36, s36, s20
    s_add_u32 s36, s36, 4
    s_min_u32 s36, s36, 63
    s_lshl_b32 s32, s36, 11
    s_add_u32 s32, s32, 15269888
    s_add_u32 s37, s20, 2
    s_cmp_le_u32 s37, s28
    s_cselect_b32 s32, 2146435072, s32
    s_cselect_b32 s50, 0, s51
    s_cselect_b32 s29, s28, s36
    s_waitcnt vmcnt(9)
    v_smfmac_f32_16x16x64_bf16 v[84:87], v[104:107], a[128:135], v1
    s_waitcnt vmcnt(8)
    v_smfmac_f32_16x16x64_bf16 v[84:87], v[108:111], a[136:143], v1
    s_waitcnt vmcnt(7)
    v_smfmac_f32_16x16x64_bf16 v[84:87], v[112:115], a[144:151], v1
    s_waitcnt vmcnt(6)
    v_smfmac_f32_16x16x64_bf16 v[84:87], v[116:119], a[152:159], v1
    buffer_store_byte v144, v143, s[4:7], s22 offen sc1
    ds_write_b32 v185, v144
    s_waitcnt vmcnt(6)
    v_smfmac_f32_16x16x64_bf16 v[84:87], v[120:123], a[160:167], v1
    s_waitcnt vmcnt(5)
    v_smfmac_f32_16x16x64_bf16 v[84:87], v[124:127], a[168:175], v1
    s_waitcnt vmcnt(4)
    v_smfmac_f32_16x16x64_bf16 v[84:87], v[128:131], a[176:183], v1
    s_waitcnt vmcnt(3)
    v_smfmac_f32_16x16x64_bf16 v[84:87], v[132:135], a[184:191], v1
    s_waitcnt vmcnt(2) lgkmcnt(0)
    v_smfmac_f32_16x16x64_bf16 v[84:87], v[96:99], a[112:119], v1
    s_waitcnt vmcnt(1) lgkmcnt(0)
    v_smfmac_f32_16x16x64_bf16 v[84:87], v[100:103], a[120:127], v1
    s_nop 7
W3f_pchk:
    v_add_f32 v84, v84, v85
    v_add_f32 v86, v86, v87
    v_cvt_pk_bf16_f32 v7, v84, v86
    v_cmp_u_f32 vcc, v84, v86
    s_nop 0
    v_mov_b32_dpp v11, v7 quad_perm:[1,0,3,2] row_mask:0xf bank_mask:0xf
    v_perm_b32 v157, v7, v11, v8
    v_cndmask_b32 v7, v157, v60, vcc
    buffer_store_dword v7, v5, s[4:7], s25 offen sc1
    s_cbranch_vccnz W3f_pfail
W3f_pok:
    s_mov_b32 s27, s26
    v_xor_b32 v186, 0x1c000, v186
    v_mov_b32 v84, 0
    v_mov_b32 v85, 0
    v_mov_b32 v86, 0
    v_mov_b32 v87, 0
    s_mov_b32 s26, s24
    s_mov_b32 s24, s25
    s_add_u32 s25, s25, 0x10000
    s_and_b32 s25, s25, 14876672
    s_add_u32 s20, s20, 1
    s_cmp_lt_u32 s20, 63
    s_cbranch_scc1 W3f_loop
    buffer_store_dword v157, v158, s[4:7], s33 offen sc1
    s_branch L_team_done
W3f_vo:
    s_add_u32 s28, s20, 1
    s_lshl_b32 s32, s28, 11
    s_add_u32 s32, s32, 15269888
W3f_vos:
    buffer_load_dword v159, v184, s[4:7], s32 offen sc1
    s_waitcnt vmcnt(0)
    v_cmp_gt_u32 vcc, 56, v159
    s_cbranch_vccz W3f_vo_ok
    s_sub_u32 s35, s35, 1
    s_cmp_lg_u32 s35, 0
    s_cbranch_scc1 W3f_vos
    s_branch L_team_done
W3f_fail:
    v_max_u32 v7, v32, v33
    v_max3_u32 v7, v7, v34, v35
    v_max3_u32 v7, v7, v36, v37
    v_max3_u32 v7, v7, v38, v39
    v_max3_u32 v7, v7, v40, v41
    v_max3_u32 v7, v7, v42, v43
    v_max3_u32 v7, v7, v44, v45
    v_max3_u32 v7, v7, v46, v47
    v_max3_u32 v7, v7, v48, v49
    v_max3_u32 v7, v7, v50, v51
    v_max3_u32 v7, v7, v52, v53
    v_max3_u32 v7, v7, v54, v55
    v_max3_u32 v7, v7, v56, v57
    v_max3_u32 v7, v7, v58, v59
    v_cmp_eq_u32 vcc, -1, v7
    s_cbranch_vccz W3f_yok
    s_waitcnt lgkmcnt(0)
    s_sub_u32 s35, s35, 1
    s_cmp_eq_u32 s35, 0
    s_cbranch_scc1 L_team_done
    v_mov_b32 v12, 0
    v_mov_b32 v13, 0
    v_mov_b32 v14, 0
    v_mov_b32 v15, 0
    v_mov_b32 v16, 0
    v_mov_b32 v17, 0
    v_mov_b32 v18, 0
    v_mov_b32 v19, 0
    s_mov_b32 m0, 6144
    s_barrier
    buffer_load_dwordx4 v0, s[4:7], s45 offen sc1 lds
    s_waitcnt vmcnt(0)
    s_barrier
    ds_read_b128 v[32:35], v0 offset:0
    ds_read_b128 v[36:39], v0 offset:1024
    ds_read_b128 v[40:43], v0 offset:2048
    ds_read_b128 v[56:59], v0 offset:6144
    ds_read_b128 v[44:47], v0 offset:3072
    ds_read_b128 v[48:51], v0 offset:4096
    ds_read_b128 v[52:55], v0 offset:5120
    s_branch W3f_y
W3f_smax:
    s_waitcnt vmcnt(0)
    buffer_load_dwordx4 v[236:239], v147, s[4:7], s24 offen sc1
    s_waitcnt vmcnt(0)
    v_max3_u32 v7, v236, v237, v238
    v_max_u32 v7, v7, v239
    v_cmp_eq_u32 vcc, -1, v7
    s_cbranch_vccz W3f_smax2
    s_sub_u32 s35, s35, 1
    s_cmp_eq_u32 s35, 0
    s_cbranch_scc1 L_team_done
    s_branch W3f_smax
W3f_smax2:
    v_fma_f32 v68, v236, s44, v76
    v_fma_f32 v69, v237, s44, v77
    v_fma_f32 v70, v238, s44, v78
    v_fma_f32 v71, v239, s44, v79
    v_max3_f32 v7, v68, v69, v70
    v_max_f32 v7, v7, v71
    s_nop 1
    v_max_f32_dpp v7, v7, v7 row_ror:8 row_mask:0xf bank_mask:0xf
    s_nop 1
    v_max_f32_dpp v7, v7, v7 row_ror:4 row_mask:0xf bank_mask:0xf
    s_nop 1
    v_max_f32_dpp v7, v7, v7 row_ror:2 row_mask:0xf bank_mask:0xf
    s_nop 1
    v_max_f32_dpp v7, v7, v7 row_ror:1 row_mask:0xf bank_mask:0xf
    v_sub_f32 v68, v68, v7
    v_sub_f32 v69, v69, v7
    v_sub_f32 v70, v70, v7
    v_sub_f32 v71, v71, v7
    v_exp_f32 v64, v68
    v_exp_f32 v65, v69
    v_exp_f32 v66, v70
    v_exp_f32 v67, v71
    v_add_f32 v7, v64, v65
    v_add_f32 v11, v66, v67
    s_branch W3f_sexp
W3f_pfail:
    v_mov_b32 v7, 0
    v_max3_u32 v7, v96, v97, v7
    v_max3_u32 v7, v98, v99, v7
    v_max3_u32 v7, v100, v101, v7
    v_max3_u32 v7, v102, v103, v7
    v_max3_u32 v7, v104, v105, v7
    v_max3_u32 v7, v106, v107, v7
    v_max3_u32 v7, v108, v109, v7
    v_max3_u32 v7, v110, v111, v7
    v_max3_u32 v7, v112, v113, v7
    v_max3_u32 v7, v114, v115, v7
    v_max3_u32 v7, v116, v117, v7
    v_max3_u32 v7, v118, v119, v7
    v_max3_u32 v7, v120, v121, v7
    v_max3_u32 v7, v122, v123, v7
    v_max3_u32 v7, v124, v125, v7
    v_max3_u32 v7, v126, v127, v7
    v_max3_u32 v7, v128, v129, v7
    v_max3_u32 v7, v130, v131, v7
    v_max3_u32 v7, v132, v133, v7
    v_max3_u32 v7, v134, v135, v7
    v_cmp_eq_u32 vcc, -1, v7
    s_cbranch_vccnz W3f_pagain
    buffer_store_dword v157, v5, s[4:7], s25 offen sc1
    s_branch W3f_pok
W3f_pagain:
    s_sub_u32 s35, s35, 1
    s_cmp_eq_u32 s35, 0
    s_cbranch_scc1 L_team_done
    v_mov_b32 v84, 0
    v_mov_b32 v85, 0
    v_mov_b32 v86, 0
    v_mov_b32 v87, 0
    buffer_load_dwordx4 v[104:107], v148, s[4:7], s24 offen sc1
    buffer_load_dwordx4 v[108:111], v149, s[4:7], s24 offen sc1
    buffer_load_dwordx4 v[112:115], v150, s[4:7], s24 offen sc1
    buffer_load_dwordx4 v[116:119], v151, s[4:7], s24 offen sc1
    buffer_load_dwordx4 v[120:123], v152, s[4:7], s24 offen sc1
    buffer_load_dwordx4 v[124:127], v153, s[4:7], s24 offen sc1
    buffer_load_dwordx4 v[128:131], v154, s[4:7], s24 offen sc1
    buffer_load_dwordx4 v[132:135], v155, s[4:7], s24 offen sc1
    buffer_load_dwordx4 v[96:99], v156, s[4:7], s24 offen offset:0 sc1
    buffer_load_dwordx4 v[100:103], v156, s[4:7], s24 offen offset:1024 sc1
    s_waitcnt vmcnt(9)
    v_smfmac_f32_16x16x64_bf16 v[84:87], v[104:107], a[128:135], v1
    s_waitcnt vmcnt(8)
    v_smfmac_f32_16x16x64_bf16 v[84:87], v[108:111], a[136:143], v1
    s_waitcnt vmcnt(7)
    v_smfmac_f32_16x16x64_bf16 v[84:87], v[112:115], a[144:151], v1
    s_waitcnt vmcnt(6)
    v_smfmac_f32_16x16x64_bf16 v[84:87], v[116:119], a[152:159], v1
    s_waitcnt vmcnt(5)
    v_smfmac_f32_16x16x64_bf16 v[84:87], v[120:123], a[160:167], v1
    s_waitcnt vmcnt(4)
    v_smfmac_f32_16x16x64_bf16 v[84:87], v[124:127], a[168:175], v1
    s_waitcnt vmcnt(3)
    v_smfmac_f32_16x16x64_bf16 v[84:87], v[128:131], a[176:183], v1
    s_waitcnt vmcnt(2)
    v_smfmac_f32_16x16x64_bf16 v[84:87], v[132:135], a[184:191], v1
    s_waitcnt vmcnt(1) lgkmcnt(0)
    v_smfmac_f32_16x16x64_bf16 v[84:87], v[96:99], a[112:119], v1
    s_waitcnt vmcnt(0) lgkmcnt(0)
    v_smfmac_f32_16x16x64_bf16 v[84:87], v[100:103], a[120:127], v1
    s_nop 7
    s_branch W3f_pchk
L_code_end:
    s_endpgm
.fill 2048, 4, 0xbf810000
.section .rodata,"a"
.p2align 6
.amdhsa_kernel gated_mix__memory_aug_recurrent_mem_tr__dense_activation_silu__prompt_kernel
  .amdhsa_next_free_vgpr 512
  .amdhsa_next_free_sgpr 102
  .amdhsa_accum_offset 256
  .amdhsa_group_segment_fixed_size 0
  .amdhsa_kernarg_size 112
  .amdhsa_user_sgpr_count 2
  .amdhsa_user_sgpr_kernarg_segment_ptr 1
  .amdhsa_system_sgpr_workgroup_id_x 1
  .amdhsa_float_denorm_mode_32 3
.end_amdhsa_kernel
.text
```
